```python
import torch

def _softmax(x, axis=-1):
    return torch.softmax(x, dim=axis)
def _gelu(x):
    return torch.nn.functional.gelu(x, approximate="tanh")
def _silu(x):
    return torch.nn.functional.silu(x)
def _sigmoid(x):
    return torch.sigmoid(x)
def _layernorm(x, axis=-1, eps=1e-5):
    m = x.mean(dim=axis, keepdim=True)
    v = x.var(dim=axis, keepdim=True, unbiased=False)
    return (x - m) / torch.sqrt(v + eps)
def _scatter_add(tgt, idx, src, axis=0):
    return tgt.clone().index_add_(axis, idx, src)
def _segment_sum(src, seg, n):
    out = torch.zeros((n,) + src.shape[1:], dtype=src.dtype)
    return out.index_add_(0, seg, src)
def _pad(x, pw):
    flat = tuple(v for pair in reversed(pw) for v in pair)
    return torch.nn.functional.pad(x, flat)

kernel_name = 'sequential_preLN__softmax_full_mha__glu_gated_reglu__prompt'

def setup_inputs():

    _w = (lambda a: (lambda t: t.to(torch.bfloat16) if t.is_floating_point() else t)(torch.as_tensor(a)))
    def _A_setup():
        B, S, D = 1, 2048, 640
        return {
            "x": _w((lambda *s: torch.randn(*s, dtype=torch.bfloat16) * 0.05)(B, S, D)),
            "wqkv": _w((lambda *s: torch.randn(*s, dtype=torch.bfloat16) * 0.05)(D, 3 * D)),
            "wo": _w((lambda *s: torch.randn(*s, dtype=torch.bfloat16) * 0.05)(D, D)),
        }
    _A_in = _A_setup()

    def _B_setup():
        B, S, D, F = 1, 2048, 640, 1536
        return {
            "x": _w((lambda *s: torch.randn(*s, dtype=torch.bfloat16) * 0.05)(B, S, D)),
            "W_gate": _w((lambda *s: torch.randn(*s, dtype=torch.bfloat16) * 0.4)(D, F) * (2.0 / D) ** 0.5),
            "W_up": _w((lambda *s: torch.randn(*s, dtype=torch.bfloat16) * 0.4)(D, F) * (2.0 / D) ** 0.5),
            "W_down": _w((lambda *s: torch.randn(*s, dtype=torch.bfloat16) * 0.4)(F, D) * (1.0 / F) ** 0.5),
        }
    _B_in = _B_setup()

    return {
        "A_x": _A_in["x"],
        "A_wqkv": _A_in["wqkv"],
        "A_wo": _A_in["wo"],
        "B_x": _B_in["x"],
        "B_W_gate": _B_in["W_gate"],
        "B_W_up": _B_in["W_up"],
        "B_W_down": _B_in["W_down"],
    }

def reference(A_x, A_wqkv, A_wo, B_x, B_W_gate, B_W_up, B_W_down):
    def _A_ref(x, wqkv, wo):
        B, S, D = x.shape
        H = 32; Dh = D // H
        qkv = (lambda x, *d: x.permute(*d))((x @ wqkv).reshape(B, S, 3, H, Dh), 2, 0, 3, 1, 4)
        q, k, v = qkv[0], qkv[1], qkv[2]
        scale = Dh ** -0.5
        scores = torch.einsum("bhqd,bhkd->bhqk", q, k) * scale
        p = _softmax(scores, axis=-1)
        o = torch.einsum("bhqk,bhkd->bhqd", p, v)
        return (lambda x, *d: x.permute(*d))(o, 0, 2, 1, 3).reshape(B, S, D) @ wo

    def _B_ref(x, W_gate, W_up, W_down):
        gate = torch.einsum("bsd,df->bsf", x, W_gate)
        up = torch.einsum("bsd,df->bsf", x, W_up)
        gate = gate * (lambda x, dt: x.to(dt))(gate > 0, gate.dtype)
        h = gate * up
        return torch.einsum("bsf,fd->bsd", h, W_down)

    x = A_x
    h = x + _A_ref(_layernorm(x, axis=-1), A_wqkv, A_wo)
    h2 = h + _B_ref(_layernorm(h, axis=-1), B_W_gate, B_W_up, B_W_down)
    return h2
```

```asm
; @launch grid=(256,1,1) block=(512,1,1) lds=163840
.amdgcn_target "amdgcn-amd-amdhsa--gfx950"
.text
.globl sequential_preLN__softmax_full_mha__glu_gated_reglu__prompt_kernel
.p2align 8
.type sequential_preLN__softmax_full_mha__glu_gated_reglu__prompt_kernel,@function
sequential_preLN__softmax_full_mha__glu_gated_reglu__prompt_kernel:
L_codestart:
    s_cmp_ge_u32 s2, 256
    s_cbranch_scc1 L_exit
    s_load_dwordx4 s[4:7], s[0:1], 0
    s_load_dwordx8 s[32:39], s[0:1], 48
    s_load_dwordx2 s[8:9], s[0:1], 16
    s_load_dwordx4 s[28:31], s[0:1], 32
    v_lshrrev_b32 v1, 6, v0
    v_and_b32 v0, 63, v0
    v_readfirstlane_b32 s42, v1
    v_and_b32 v244, 3, v0
    v_subrev_u32 v244, 1, v244
    v_lshrrev_b32 v244, 31, v244
    v_not_b32 v245, v244
    s_and_b32 s3, s2, 3
    s_lshl_b32 s3, s3, 2
    s_bfe_u32 s14, s2, 0x20003
    s_add_u32 s40, s3, s14
    s_bfe_u32 s3, s2, 0x10002
    s_lshl_b32 s3, s3, 3
    s_lshr_b32 s14, s2, 5
    s_add_u32 s41, s3, s14
    s_cmp_eq_u32 s41, 15
    s_cbranch_scc1 L1_spare
    s_cmp_ge_u32 s42, 4
    s_cbranch_scc1 L1_compute
    s_and_b32 s43, s42, 3
    v_lshrrev_b32 v5, 3, v0
    s_lshl_b32 s3, s40, 2
    s_add_u32 s3, s3, s43
    s_lshl_b32 s3, s3, 5
    v_add_u32 v5, s3, v5
    v_mul_u32_u24 v5, 1280, v5
    v_and_b32 v6, 7, v0
    v_lshrrev_b32 v7, 4, v0
    v_xor_b32 v6, v6, v7
    v_lshlrev_b32 v6, 4, v6
    v_add_u32 v2, v5, v6
    v_xor_b32 v6, 64, v6
    v_add_u32 v3, v5, v6
    s_lshl_b32 s3, s43, 4
    v_add_u32 v5, s3, v7
    v_mul_u32_u24 v5, 3840, v5
    v_bfe_u32 v6, v0, 2, 2
    v_xor_b32 v6, v6, v7
    v_lshlrev_b32 v6, 6, v6
    v_and_b32 v8, 3, v0
    v_lshlrev_b32 v8, 4, v8
    v_add3_u32 v5, v5, v6, v8
    s_lshl_b32 s3, s41, 8
    v_add_u32 v4, s3, v5
    s_lshl_b32 s44, s43, 12
    s_and_b32 s3, s41, 7
    s_mul_i32 s3, s3, 10
    s_lshr_b32 s3, s3, 3
    s_and_b32 s14, s40, 3
    s_mul_i32 s14, s14, 10
    s_lshr_b32 s14, s14, 2
    s_add_u32 s3, s3, s14
    s_cmp_ge_u32 s3, 10
    s_cselect_b32 s14, 10, 0
    s_sub_u32 s3, s3, s14
    s_mov_b32 s3, 0
    s_lshl_b32 s47, s3, 7
    s_mul_i32 s48, s3, 245760
    s_waitcnt lgkmcnt(0)
    s_mov_b32 s16, s4
    s_mov_b32 s17, s5
    s_mov_b32 s18, 2621440
    s_mov_b32 s19, 0x00020000
    s_mov_b32 s20, s6
    s_mov_b32 s21, s7
    s_mov_b32 s22, 2457600
    s_mov_b32 s23, 0x00020000
    s_mov_b32 s24, s38
    s_mov_b32 s25, s39
    s_mov_b32 s26, 18890752
    s_mov_b32 s27, 0x00020000
    s_add_u32 m0, s44, 0
    s_add_u32 s45, s47, 0
    buffer_load_dwordx4 v2, s[16:19], s45 offen lds
    s_add_u32 m0, s44, 1024
    s_add_u32 s45, s47, 10240
    buffer_load_dwordx4 v3, s[16:19], s45 offen lds
    s_add_u32 m0, s44, 2048
    s_add_u32 s45, s47, 20480
    buffer_load_dwordx4 v2, s[16:19], s45 offen lds
    s_add_u32 m0, s44, 3072
    s_add_u32 s45, s47, 30720
    buffer_load_dwordx4 v3, s[16:19], s45 offen lds
    s_add_u32 s47, s47, 128
    s_cmp_eq_u32 s47, 1280
    s_cmov_b32 s47, 0
    s_add_u32 m0, s44, 16384
    s_add_u32 s45, s48, 0
    buffer_load_dwordx4 v4, s[20:23], s45 offen lds
    s_add_u32 m0, s44, 17408
    s_add_u32 s45, s48, 15360
    buffer_load_dwordx4 v4, s[20:23], s45 offen lds
    s_add_u32 m0, s44, 18432
    s_add_u32 s45, s48, 30720
    buffer_load_dwordx4 v4, s[20:23], s45 offen lds
    s_add_u32 m0, s44, 19456
    s_add_u32 s45, s48, 46080
    buffer_load_dwordx4 v4, s[20:23], s45 offen lds
    s_add_u32 s48, s48, 245760
    s_cmp_eq_u32 s48, 2457600
    s_cmov_b32 s48, 0
    s_add_u32 m0, s44, 32768
    s_add_u32 s45, s47, 0
    buffer_load_dwordx4 v2, s[16:19], s45 offen lds
    s_add_u32 m0, s44, 33792
    s_add_u32 s45, s47, 10240
    buffer_load_dwordx4 v3, s[16:19], s45 offen lds
    s_add_u32 m0, s44, 34816
    s_add_u32 s45, s47, 20480
    buffer_load_dwordx4 v2, s[16:19], s45 offen lds
    s_add_u32 m0, s44, 35840
    s_add_u32 s45, s47, 30720
    buffer_load_dwordx4 v3, s[16:19], s45 offen lds
    s_add_u32 s47, s47, 128
    s_cmp_eq_u32 s47, 1280
    s_cmov_b32 s47, 0
    s_add_u32 m0, s44, 49152
    s_add_u32 s45, s48, 0
    buffer_load_dwordx4 v4, s[20:23], s45 offen lds
    s_add_u32 m0, s44, 50176
    s_add_u32 s45, s48, 15360
    buffer_load_dwordx4 v4, s[20:23], s45 offen lds
    s_add_u32 m0, s44, 51200
    s_add_u32 s45, s48, 30720
    buffer_load_dwordx4 v4, s[20:23], s45 offen lds
    s_add_u32 m0, s44, 52224
    s_add_u32 s45, s48, 46080
    buffer_load_dwordx4 v4, s[20:23], s45 offen lds
    s_add_u32 s48, s48, 245760
    s_cmp_eq_u32 s48, 2457600
    s_cmov_b32 s48, 0
    s_mul_i32 s3, s40, 15
    s_add_u32 s3, s3, s41
    s_lshl_b32 s3, s3, 1
    s_and_b32 s14, s43, 1
    s_add_u32 s3, s3, s14
    s_cmp_lt_u32 s43, 2
    s_cselect_b32 s14, 35, 32
    s_mul_i32 s3, s3, s14
    s_sub_u32 s14, s14, 1
    v_min_u32 v130, s14, v0
    v_add_u32 v130, s3, v130
    s_mov_b32 s14, 131072
    v_mul_lo_u32 v131, v130, s14
    v_lshrrev_b32 v131, 20, v131
    v_add_u32 v131, 1, v131
    s_cmp_lt_u32 s43, 2
    s_cselect_b32 s14, 2, 0
    s_cselect_b32 s15, 0, 3840
    v_mad_u32_u24 v130, v131, s14, v130
    v_add_u32 v130, s15, v130
    v_lshlrev_b32 v130, 7, v130
    s_cselect_b32 s96, s4, s6
    s_cselect_b32 s97, s5, s7
    s_mov_b32 s98, 2457600
    s_cmov_b32 s98, 2621440
    s_mov_b32 s99, 0x00020000
    buffer_load_dword v253, v130, s[96:99], 0 offen
    v_lshrrev_b32 v6, 5, v0
    v_bfe_u32 v5, v0, 2, 2
    v_lshl_add_u32 v7, v6, 3, v5
    v_lshlrev_b32 v7, 8, v7
    v_xor_b32 v5, s43, v5
    v_lshlrev_b32 v5, 6, v5
    v_bfe_u32 v8, v0, 4, 1
    v_lshlrev_b32 v8, 5, v8
    v_add3_u32 v7, v7, v5, v8
    v_and_b32 v8, 3, v0
    v_lshlrev_b32 v8, 3, v8
    s_mov_b32 s3, 16384
    v_add3_u32 v22, v7, v8, s3
    v_add_u32 v23, 65536, v22
    s_mov_b32 s46, 0x3f803f80
    v_mov_b32 v28, 0
    v_mov_b32 v29, 0
    s_mov_b32 s49, 0xffff0000
    s_lshl_b32 s3, s40, 2
    s_add_u32 s3, s3, 4
    v_mov_b32 v12, s3
    v_and_b32 v5, 31, v0
    s_lshl_b32 s3, s40, 2
    s_add_u32 s3, s3, s43
    s_lshl_b32 s3, s3, 8
    s_add_u32 s3, s3, 18759680
    v_lshl_add_u32 v13, v5, 3, s3
    s_lshl_b32 s3, s43, 7
    s_add_u32 s3, s3, 0
    v_lshl_add_u32 v9, v5, 2, s3
    s_waitcnt vmcnt(9)
    s_barrier
    s_add_u32 m0, s44, 65536
    s_add_u32 s45, s47, 0
    buffer_load_dwordx4 v2, s[16:19], s45 offen lds
    s_add_u32 m0, s44, 66560
    s_add_u32 s45, s47, 10240
    buffer_load_dwordx4 v3, s[16:19], s45 offen lds
    s_add_u32 m0, s44, 67584
    s_add_u32 s45, s47, 20480
    buffer_load_dwordx4 v2, s[16:19], s45 offen lds
    s_add_u32 m0, s44, 68608
    s_add_u32 s45, s47, 30720
    buffer_load_dwordx4 v3, s[16:19], s45 offen lds
    s_add_u32 s47, s47, 128
    s_cmp_eq_u32 s47, 1280
    s_cmov_b32 s47, 0
    s_add_u32 m0, s44, 81920
    s_add_u32 s45, s48, 0
    buffer_load_dwordx4 v4, s[20:23], s45 offen lds
    s_add_u32 m0, s44, 82944
    s_add_u32 s45, s48, 15360
    buffer_load_dwordx4 v4, s[20:23], s45 offen lds
    s_add_u32 m0, s44, 83968
    s_add_u32 s45, s48, 30720
    buffer_load_dwordx4 v4, s[20:23], s45 offen lds
    s_add_u32 m0, s44, 84992
    s_add_u32 s45, s48, 46080
    buffer_load_dwordx4 v4, s[20:23], s45 offen lds
    s_add_u32 s48, s48, 245760
    s_cmp_eq_u32 s48, 2457600
    s_cmov_b32 s48, 0
    ds_read_b64_tr_b16 v[32:33], v22 offset:0
    ds_read_b64_tr_b16 v[34:35], v22 offset:1024
    ds_read_b64_tr_b16 v[36:37], v22 offset:4096
    ds_read_b64_tr_b16 v[38:39], v22 offset:5120
    ds_read_b64_tr_b16 v[40:41], v22 offset:8192
    ds_read_b64_tr_b16 v[42:43], v22 offset:9216
    ds_read_b64_tr_b16 v[44:45], v22 offset:12288
    ds_read_b64_tr_b16 v[46:47], v22 offset:13312
    s_waitcnt lgkmcnt(0)
    v_dot2_f32_bf16 v28, v32, s46, v28
    v_dot2_f32_bf16 v28, v33, s46, v28
    v_dot2_f32_bf16 v28, v34, s46, v28
    v_dot2_f32_bf16 v28, v35, s46, v28
    v_dot2_f32_bf16 v28, v36, s46, v28
    v_dot2_f32_bf16 v28, v37, s46, v28
    v_dot2_f32_bf16 v28, v38, s46, v28
    v_dot2_f32_bf16 v28, v39, s46, v28
    v_dot2_f32_bf16 v28, v40, s46, v28
    v_dot2_f32_bf16 v28, v41, s46, v28
    v_dot2_f32_bf16 v28, v42, s46, v28
    v_dot2_f32_bf16 v28, v43, s46, v28
    v_dot2_f32_bf16 v28, v44, s46, v28
    v_dot2_f32_bf16 v28, v45, s46, v28
    v_dot2_f32_bf16 v28, v46, s46, v28
    v_dot2_f32_bf16 v28, v47, s46, v28
    s_waitcnt vmcnt(9)
    s_barrier
    s_add_u32 m0, s44, 98304
    s_add_u32 s45, s47, 0
    buffer_load_dwordx4 v2, s[16:19], s45 offen lds
    s_add_u32 m0, s44, 99328
    s_add_u32 s45, s47, 10240
    buffer_load_dwordx4 v3, s[16:19], s45 offen lds
    s_add_u32 m0, s44, 100352
    s_add_u32 s45, s47, 20480
    buffer_load_dwordx4 v2, s[16:19], s45 offen lds
    s_add_u32 m0, s44, 101376
    s_add_u32 s45, s47, 30720
    buffer_load_dwordx4 v3, s[16:19], s45 offen lds
    s_add_u32 s47, s47, 128
    s_cmp_eq_u32 s47, 1280
    s_cmov_b32 s47, 0
    s_add_u32 m0, s44, 114688
    s_add_u32 s45, s48, 0
    buffer_load_dwordx4 v4, s[20:23], s45 offen lds
    s_add_u32 m0, s44, 115712
    s_add_u32 s45, s48, 15360
    buffer_load_dwordx4 v4, s[20:23], s45 offen lds
    s_add_u32 m0, s44, 116736
    s_add_u32 s45, s48, 30720
    buffer_load_dwordx4 v4, s[20:23], s45 offen lds
    s_add_u32 m0, s44, 117760
    s_add_u32 s45, s48, 46080
    buffer_load_dwordx4 v4, s[20:23], s45 offen lds
    s_add_u32 s48, s48, 245760
    s_cmp_eq_u32 s48, 2457600
    s_cmov_b32 s48, 0
    ds_read_b64_tr_b16 v[32:33], v22 offset:32768
    ds_read_b64_tr_b16 v[34:35], v22 offset:33792
    ds_read_b64_tr_b16 v[36:37], v22 offset:36864
    ds_read_b64_tr_b16 v[38:39], v22 offset:37888
    ds_read_b64_tr_b16 v[40:41], v22 offset:40960
    ds_read_b64_tr_b16 v[42:43], v22 offset:41984
    ds_read_b64_tr_b16 v[44:45], v22 offset:45056
    ds_read_b64_tr_b16 v[46:47], v22 offset:46080
    s_waitcnt lgkmcnt(0)
    v_dot2_f32_bf16 v28, v32, s46, v28
    v_dot2_f32_bf16 v28, v33, s46, v28
    v_dot2_f32_bf16 v28, v34, s46, v28
    v_dot2_f32_bf16 v28, v35, s46, v28
    v_dot2_f32_bf16 v28, v36, s46, v28
    v_dot2_f32_bf16 v28, v37, s46, v28
    v_dot2_f32_bf16 v28, v38, s46, v28
    v_dot2_f32_bf16 v28, v39, s46, v28
    v_dot2_f32_bf16 v28, v40, s46, v28
    v_dot2_f32_bf16 v28, v41, s46, v28
    v_dot2_f32_bf16 v28, v42, s46, v28
    v_dot2_f32_bf16 v28, v43, s46, v28
    v_dot2_f32_bf16 v28, v44, s46, v28
    v_dot2_f32_bf16 v28, v45, s46, v28
    v_dot2_f32_bf16 v28, v46, s46, v28
    v_dot2_f32_bf16 v28, v47, s46, v28
    s_waitcnt vmcnt(8)
    s_barrier
    s_add_u32 m0, s44, 0
    s_add_u32 s45, s47, 0
    buffer_load_dwordx4 v2, s[16:19], s45 offen lds
    s_add_u32 m0, s44, 1024
    s_add_u32 s45, s47, 10240
    buffer_load_dwordx4 v3, s[16:19], s45 offen lds
    s_add_u32 m0, s44, 2048
    s_add_u32 s45, s47, 20480
    buffer_load_dwordx4 v2, s[16:19], s45 offen lds
    s_add_u32 m0, s44, 3072
    s_add_u32 s45, s47, 30720
    buffer_load_dwordx4 v3, s[16:19], s45 offen lds
    s_add_u32 s47, s47, 128
    s_cmp_eq_u32 s47, 1280
    s_cmov_b32 s47, 0
    s_add_u32 m0, s44, 16384
    s_add_u32 s45, s48, 0
    buffer_load_dwordx4 v4, s[20:23], s45 offen lds
    s_add_u32 m0, s44, 17408
    s_add_u32 s45, s48, 15360
    buffer_load_dwordx4 v4, s[20:23], s45 offen lds
    s_add_u32 m0, s44, 18432
    s_add_u32 s45, s48, 30720
    buffer_load_dwordx4 v4, s[20:23], s45 offen lds
    s_add_u32 m0, s44, 19456
    s_add_u32 s45, s48, 46080
    buffer_load_dwordx4 v4, s[20:23], s45 offen lds
    s_add_u32 s48, s48, 245760
    s_cmp_eq_u32 s48, 2457600
    s_cmov_b32 s48, 0
    ds_read_b64_tr_b16 v[32:33], v23 offset:0
    ds_read_b64_tr_b16 v[34:35], v23 offset:1024
    ds_read_b64_tr_b16 v[36:37], v23 offset:4096
    ds_read_b64_tr_b16 v[38:39], v23 offset:5120
    ds_read_b64_tr_b16 v[40:41], v23 offset:8192
    ds_read_b64_tr_b16 v[42:43], v23 offset:9216
    ds_read_b64_tr_b16 v[44:45], v23 offset:12288
    ds_read_b64_tr_b16 v[46:47], v23 offset:13312
    s_waitcnt lgkmcnt(0)
    v_dot2_f32_bf16 v28, v32, s46, v28
    v_dot2_f32_bf16 v28, v33, s46, v28
    v_dot2_f32_bf16 v28, v34, s46, v28
    v_dot2_f32_bf16 v28, v35, s46, v28
    v_dot2_f32_bf16 v28, v36, s46, v28
    v_dot2_f32_bf16 v28, v37, s46, v28
    v_dot2_f32_bf16 v28, v38, s46, v28
    v_dot2_f32_bf16 v28, v39, s46, v28
    v_dot2_f32_bf16 v28, v40, s46, v28
    v_dot2_f32_bf16 v28, v41, s46, v28
    v_dot2_f32_bf16 v28, v42, s46, v28
    v_dot2_f32_bf16 v28, v43, s46, v28
    v_dot2_f32_bf16 v28, v44, s46, v28
    v_dot2_f32_bf16 v28, v45, s46, v28
    v_dot2_f32_bf16 v28, v46, s46, v28
    v_dot2_f32_bf16 v28, v47, s46, v28
    s_waitcnt vmcnt(8)
    s_barrier
    s_add_u32 m0, s44, 32768
    s_add_u32 s45, s47, 0
    buffer_load_dwordx4 v2, s[16:19], s45 offen lds
    s_add_u32 m0, s44, 33792
    s_add_u32 s45, s47, 10240
    buffer_load_dwordx4 v3, s[16:19], s45 offen lds
    s_add_u32 m0, s44, 34816
    s_add_u32 s45, s47, 20480
    buffer_load_dwordx4 v2, s[16:19], s45 offen lds
    s_add_u32 m0, s44, 35840
    s_add_u32 s45, s47, 30720
    buffer_load_dwordx4 v3, s[16:19], s45 offen lds
    s_add_u32 s47, s47, 128
    s_cmp_eq_u32 s47, 1280
    s_cmov_b32 s47, 0
    s_add_u32 m0, s44, 49152
    s_add_u32 s45, s48, 0
    buffer_load_dwordx4 v4, s[20:23], s45 offen lds
    s_add_u32 m0, s44, 50176
    s_add_u32 s45, s48, 15360
    buffer_load_dwordx4 v4, s[20:23], s45 offen lds
    s_add_u32 m0, s44, 51200
    s_add_u32 s45, s48, 30720
    buffer_load_dwordx4 v4, s[20:23], s45 offen lds
    s_add_u32 m0, s44, 52224
    s_add_u32 s45, s48, 46080
    buffer_load_dwordx4 v4, s[20:23], s45 offen lds
    s_add_u32 s48, s48, 245760
    s_cmp_eq_u32 s48, 2457600
    s_cmov_b32 s48, 0
    ds_read_b64_tr_b16 v[32:33], v23 offset:32768
    ds_read_b64_tr_b16 v[34:35], v23 offset:33792
    ds_read_b64_tr_b16 v[36:37], v23 offset:36864
    ds_read_b64_tr_b16 v[38:39], v23 offset:37888
    ds_read_b64_tr_b16 v[40:41], v23 offset:40960
    ds_read_b64_tr_b16 v[42:43], v23 offset:41984
    ds_read_b64_tr_b16 v[44:45], v23 offset:45056
    ds_read_b64_tr_b16 v[46:47], v23 offset:46080
    s_waitcnt lgkmcnt(0)
    v_dot2_f32_bf16 v28, v32, s46, v28
    v_dot2_f32_bf16 v28, v33, s46, v28
    v_dot2_f32_bf16 v28, v34, s46, v28
    v_dot2_f32_bf16 v28, v35, s46, v28
    v_dot2_f32_bf16 v28, v36, s46, v28
    v_dot2_f32_bf16 v28, v37, s46, v28
    v_dot2_f32_bf16 v28, v38, s46, v28
    v_dot2_f32_bf16 v28, v39, s46, v28
    v_dot2_f32_bf16 v28, v40, s46, v28
    v_dot2_f32_bf16 v28, v41, s46, v28
    v_dot2_f32_bf16 v28, v42, s46, v28
    v_dot2_f32_bf16 v28, v43, s46, v28
    v_dot2_f32_bf16 v28, v44, s46, v28
    v_dot2_f32_bf16 v28, v45, s46, v28
    v_dot2_f32_bf16 v28, v46, s46, v28
    v_dot2_f32_bf16 v28, v47, s46, v28
    s_waitcnt vmcnt(8)
    s_barrier
    s_add_u32 m0, s44, 65536
    s_add_u32 s45, s47, 0
    buffer_load_dwordx4 v2, s[16:19], s45 offen lds
    s_add_u32 m0, s44, 66560
    s_add_u32 s45, s47, 10240
    buffer_load_dwordx4 v3, s[16:19], s45 offen lds
    s_add_u32 m0, s44, 67584
    s_add_u32 s45, s47, 20480
    buffer_load_dwordx4 v2, s[16:19], s45 offen lds
    s_add_u32 m0, s44, 68608
    s_add_u32 s45, s47, 30720
    buffer_load_dwordx4 v3, s[16:19], s45 offen lds
    s_add_u32 s47, s47, 128
    s_cmp_eq_u32 s47, 1280
    s_cmov_b32 s47, 0
    s_add_u32 m0, s44, 81920
    s_add_u32 s45, s48, 0
    buffer_load_dwordx4 v4, s[20:23], s45 offen lds
    s_add_u32 m0, s44, 82944
    s_add_u32 s45, s48, 15360
    buffer_load_dwordx4 v4, s[20:23], s45 offen lds
    s_add_u32 m0, s44, 83968
    s_add_u32 s45, s48, 30720
    buffer_load_dwordx4 v4, s[20:23], s45 offen lds
    s_add_u32 m0, s44, 84992
    s_add_u32 s45, s48, 46080
    buffer_load_dwordx4 v4, s[20:23], s45 offen lds
    s_add_u32 s48, s48, 245760
    s_cmp_eq_u32 s48, 2457600
    s_cmov_b32 s48, 0
    ds_read_b64_tr_b16 v[32:33], v22 offset:0
    ds_read_b64_tr_b16 v[34:35], v22 offset:1024
    ds_read_b64_tr_b16 v[36:37], v22 offset:4096
    ds_read_b64_tr_b16 v[38:39], v22 offset:5120
    ds_read_b64_tr_b16 v[40:41], v22 offset:8192
    ds_read_b64_tr_b16 v[42:43], v22 offset:9216
    ds_read_b64_tr_b16 v[44:45], v22 offset:12288
    ds_read_b64_tr_b16 v[46:47], v22 offset:13312
    s_waitcnt lgkmcnt(0)
    v_dot2_f32_bf16 v28, v32, s46, v28
    v_dot2_f32_bf16 v28, v33, s46, v28
    v_dot2_f32_bf16 v28, v34, s46, v28
    v_dot2_f32_bf16 v28, v35, s46, v28
    v_dot2_f32_bf16 v28, v36, s46, v28
    v_dot2_f32_bf16 v28, v37, s46, v28
    v_dot2_f32_bf16 v28, v38, s46, v28
    v_dot2_f32_bf16 v28, v39, s46, v28
    v_dot2_f32_bf16 v28, v40, s46, v28
    v_dot2_f32_bf16 v28, v41, s46, v28
    v_dot2_f32_bf16 v28, v42, s46, v28
    v_dot2_f32_bf16 v28, v43, s46, v28
    v_dot2_f32_bf16 v28, v44, s46, v28
    v_dot2_f32_bf16 v28, v45, s46, v28
    v_dot2_f32_bf16 v28, v46, s46, v28
    v_dot2_f32_bf16 v28, v47, s46, v28
    s_waitcnt vmcnt(8)
    s_barrier
    s_add_u32 m0, s44, 98304
    s_add_u32 s45, s47, 0
    buffer_load_dwordx4 v2, s[16:19], s45 offen lds
    s_add_u32 m0, s44, 99328
    s_add_u32 s45, s47, 10240
    buffer_load_dwordx4 v3, s[16:19], s45 offen lds
    s_add_u32 m0, s44, 100352
    s_add_u32 s45, s47, 20480
    buffer_load_dwordx4 v2, s[16:19], s45 offen lds
    s_add_u32 m0, s44, 101376
    s_add_u32 s45, s47, 30720
    buffer_load_dwordx4 v3, s[16:19], s45 offen lds
    s_add_u32 s47, s47, 128
    s_cmp_eq_u32 s47, 1280
    s_cmov_b32 s47, 0
    s_add_u32 m0, s44, 114688
    s_add_u32 s45, s48, 0
    buffer_load_dwordx4 v4, s[20:23], s45 offen lds
    s_add_u32 m0, s44, 115712
    s_add_u32 s45, s48, 15360
    buffer_load_dwordx4 v4, s[20:23], s45 offen lds
    s_add_u32 m0, s44, 116736
    s_add_u32 s45, s48, 30720
    buffer_load_dwordx4 v4, s[20:23], s45 offen lds
    s_add_u32 m0, s44, 117760
    s_add_u32 s45, s48, 46080
    buffer_load_dwordx4 v4, s[20:23], s45 offen lds
    s_add_u32 s48, s48, 245760
    s_cmp_eq_u32 s48, 2457600
    s_cmov_b32 s48, 0
    ds_read_b64_tr_b16 v[32:33], v22 offset:32768
    ds_read_b64_tr_b16 v[34:35], v22 offset:33792
    ds_read_b64_tr_b16 v[36:37], v22 offset:36864
    ds_read_b64_tr_b16 v[38:39], v22 offset:37888
    ds_read_b64_tr_b16 v[40:41], v22 offset:40960
    ds_read_b64_tr_b16 v[42:43], v22 offset:41984
    ds_read_b64_tr_b16 v[44:45], v22 offset:45056
    ds_read_b64_tr_b16 v[46:47], v22 offset:46080
    s_waitcnt lgkmcnt(0)
    v_dot2_f32_bf16 v28, v32, s46, v28
    v_dot2_f32_bf16 v28, v33, s46, v28
    v_dot2_f32_bf16 v28, v34, s46, v28
    v_dot2_f32_bf16 v28, v35, s46, v28
    v_dot2_f32_bf16 v28, v36, s46, v28
    v_dot2_f32_bf16 v28, v37, s46, v28
    v_dot2_f32_bf16 v28, v38, s46, v28
    v_dot2_f32_bf16 v28, v39, s46, v28
    v_dot2_f32_bf16 v28, v40, s46, v28
    v_dot2_f32_bf16 v28, v41, s46, v28
    v_dot2_f32_bf16 v28, v42, s46, v28
    v_dot2_f32_bf16 v28, v43, s46, v28
    v_dot2_f32_bf16 v28, v44, s46, v28
    v_dot2_f32_bf16 v28, v45, s46, v28
    v_dot2_f32_bf16 v28, v46, s46, v28
    v_dot2_f32_bf16 v28, v47, s46, v28
    s_waitcnt vmcnt(8)
    s_barrier
    s_add_u32 m0, s44, 0
    s_add_u32 s45, s47, 0
    buffer_load_dwordx4 v2, s[16:19], s45 offen lds
    s_add_u32 m0, s44, 1024
    s_add_u32 s45, s47, 10240
    buffer_load_dwordx4 v3, s[16:19], s45 offen lds
    s_add_u32 m0, s44, 2048
    s_add_u32 s45, s47, 20480
    buffer_load_dwordx4 v2, s[16:19], s45 offen lds
    s_add_u32 m0, s44, 3072
    s_add_u32 s45, s47, 30720
    buffer_load_dwordx4 v3, s[16:19], s45 offen lds
    s_add_u32 s47, s47, 128
    s_cmp_eq_u32 s47, 1280
    s_cmov_b32 s47, 0
    s_add_u32 m0, s44, 16384
    s_add_u32 s45, s48, 0
    buffer_load_dwordx4 v4, s[20:23], s45 offen lds
    s_add_u32 m0, s44, 17408
    s_add_u32 s45, s48, 15360
    buffer_load_dwordx4 v4, s[20:23], s45 offen lds
    s_add_u32 m0, s44, 18432
    s_add_u32 s45, s48, 30720
    buffer_load_dwordx4 v4, s[20:23], s45 offen lds
    s_add_u32 m0, s44, 19456
    s_add_u32 s45, s48, 46080
    buffer_load_dwordx4 v4, s[20:23], s45 offen lds
    s_add_u32 s48, s48, 245760
    s_cmp_eq_u32 s48, 2457600
    s_cmov_b32 s48, 0
    global_load_dword v14, v12, s[36:37] sc1
    ds_read_b64_tr_b16 v[32:33], v23 offset:0
    ds_read_b64_tr_b16 v[34:35], v23 offset:1024
    ds_read_b64_tr_b16 v[36:37], v23 offset:4096
    ds_read_b64_tr_b16 v[38:39], v23 offset:5120
    ds_read_b64_tr_b16 v[40:41], v23 offset:8192
    ds_read_b64_tr_b16 v[42:43], v23 offset:9216
    ds_read_b64_tr_b16 v[44:45], v23 offset:12288
    ds_read_b64_tr_b16 v[46:47], v23 offset:13312
    s_waitcnt lgkmcnt(0)
    v_dot2_f32_bf16 v28, v32, s46, v28
    v_dot2_f32_bf16 v28, v33, s46, v28
    v_dot2_f32_bf16 v28, v34, s46, v28
    v_dot2_f32_bf16 v28, v35, s46, v28
    v_dot2_f32_bf16 v28, v36, s46, v28
    v_dot2_f32_bf16 v28, v37, s46, v28
    v_dot2_f32_bf16 v28, v38, s46, v28
    v_dot2_f32_bf16 v28, v39, s46, v28
    v_dot2_f32_bf16 v28, v40, s46, v28
    v_dot2_f32_bf16 v28, v41, s46, v28
    v_dot2_f32_bf16 v28, v42, s46, v28
    v_dot2_f32_bf16 v28, v43, s46, v28
    v_dot2_f32_bf16 v28, v44, s46, v28
    v_dot2_f32_bf16 v28, v45, s46, v28
    v_dot2_f32_bf16 v28, v46, s46, v28
    v_dot2_f32_bf16 v28, v47, s46, v28
    s_waitcnt vmcnt(9)
    s_barrier
    s_add_u32 m0, s44, 32768
    s_add_u32 s45, s47, 0
    buffer_load_dwordx4 v2, s[16:19], s45 offen lds
    s_add_u32 m0, s44, 33792
    s_add_u32 s45, s47, 10240
    buffer_load_dwordx4 v3, s[16:19], s45 offen lds
    s_add_u32 m0, s44, 34816
    s_add_u32 s45, s47, 20480
    buffer_load_dwordx4 v2, s[16:19], s45 offen lds
    s_add_u32 m0, s44, 35840
    s_add_u32 s45, s47, 30720
    buffer_load_dwordx4 v3, s[16:19], s45 offen lds
    s_add_u32 s47, s47, 128
    s_cmp_eq_u32 s47, 1280
    s_cmov_b32 s47, 0
    s_add_u32 m0, s44, 49152
    s_add_u32 s45, s48, 0
    buffer_load_dwordx4 v4, s[20:23], s45 offen lds
    s_add_u32 m0, s44, 50176
    s_add_u32 s45, s48, 15360
    buffer_load_dwordx4 v4, s[20:23], s45 offen lds
    s_add_u32 m0, s44, 51200
    s_add_u32 s45, s48, 30720
    buffer_load_dwordx4 v4, s[20:23], s45 offen lds
    s_add_u32 m0, s44, 52224
    s_add_u32 s45, s48, 46080
    buffer_load_dwordx4 v4, s[20:23], s45 offen lds
    s_add_u32 s48, s48, 245760
    s_cmp_eq_u32 s48, 2457600
    s_cmov_b32 s48, 0
    ds_read_b64_tr_b16 v[32:33], v23 offset:32768
    ds_read_b64_tr_b16 v[34:35], v23 offset:33792
    ds_read_b64_tr_b16 v[36:37], v23 offset:36864
    ds_read_b64_tr_b16 v[38:39], v23 offset:37888
    ds_read_b64_tr_b16 v[40:41], v23 offset:40960
    ds_read_b64_tr_b16 v[42:43], v23 offset:41984
    ds_read_b64_tr_b16 v[44:45], v23 offset:45056
    ds_read_b64_tr_b16 v[46:47], v23 offset:46080
    s_waitcnt lgkmcnt(0)
    v_dot2_f32_bf16 v28, v32, s46, v28
    v_dot2_f32_bf16 v28, v33, s46, v28
    v_dot2_f32_bf16 v28, v34, s46, v28
    v_dot2_f32_bf16 v28, v35, s46, v28
    v_dot2_f32_bf16 v28, v36, s46, v28
    v_dot2_f32_bf16 v28, v37, s46, v28
    v_dot2_f32_bf16 v28, v38, s46, v28
    v_dot2_f32_bf16 v28, v39, s46, v28
    v_dot2_f32_bf16 v28, v40, s46, v28
    v_dot2_f32_bf16 v28, v41, s46, v28
    v_dot2_f32_bf16 v28, v42, s46, v28
    v_dot2_f32_bf16 v28, v43, s46, v28
    v_dot2_f32_bf16 v28, v44, s46, v28
    v_dot2_f32_bf16 v28, v45, s46, v28
    v_dot2_f32_bf16 v28, v46, s46, v28
    v_dot2_f32_bf16 v28, v47, s46, v28
    s_waitcnt vmcnt(9)
    s_barrier
    ds_read_b64_tr_b16 v[32:33], v22 offset:0
    ds_read_b64_tr_b16 v[34:35], v22 offset:1024
    ds_read_b64_tr_b16 v[36:37], v22 offset:4096
    ds_read_b64_tr_b16 v[38:39], v22 offset:5120
    ds_read_b64_tr_b16 v[40:41], v22 offset:8192
    ds_read_b64_tr_b16 v[42:43], v22 offset:9216
    ds_read_b64_tr_b16 v[44:45], v22 offset:12288
    ds_read_b64_tr_b16 v[46:47], v22 offset:13312
    s_waitcnt lgkmcnt(0)
    v_dot2_f32_bf16 v28, v32, s46, v28
    v_dot2_f32_bf16 v28, v33, s46, v28
    v_dot2_f32_bf16 v28, v34, s46, v28
    v_dot2_f32_bf16 v28, v35, s46, v28
    v_dot2_f32_bf16 v28, v36, s46, v28
    v_dot2_f32_bf16 v28, v37, s46, v28
    v_dot2_f32_bf16 v28, v38, s46, v28
    v_dot2_f32_bf16 v28, v39, s46, v28
    v_dot2_f32_bf16 v28, v40, s46, v28
    v_dot2_f32_bf16 v28, v41, s46, v28
    v_dot2_f32_bf16 v28, v42, s46, v28
    v_dot2_f32_bf16 v28, v43, s46, v28
    v_dot2_f32_bf16 v28, v44, s46, v28
    v_dot2_f32_bf16 v28, v45, s46, v28
    v_dot2_f32_bf16 v28, v46, s46, v28
    v_dot2_f32_bf16 v28, v47, s46, v28
    s_waitcnt vmcnt(8)
    s_mov_b32 s14, 400000
L1_fl:
    v_readfirstlane_b32 s3, v14
    s_cmp_lg_u32 s3, 0
    s_cbranch_scc1 L1_fl2
    global_load_dword v14, v12, s[36:37] sc1
    s_waitcnt vmcnt(0)
    s_sub_u32 s14, s14, 1
    s_cmp_lg_u32 s14, 0
    s_cbranch_scc1 L1_fl
L1_fl2:
    buffer_load_dwordx2 v[16:17], v13, s[24:27], 0 offen sc1
    s_waitcnt vmcnt(1)
    s_barrier
    ds_read_b64_tr_b16 v[32:33], v22 offset:32768
    ds_read_b64_tr_b16 v[34:35], v22 offset:33792
    ds_read_b64_tr_b16 v[36:37], v22 offset:36864
    ds_read_b64_tr_b16 v[38:39], v22 offset:37888
    ds_read_b64_tr_b16 v[40:41], v22 offset:40960
    ds_read_b64_tr_b16 v[42:43], v22 offset:41984
    ds_read_b64_tr_b16 v[44:45], v22 offset:45056
    ds_read_b64_tr_b16 v[46:47], v22 offset:46080
    s_waitcnt lgkmcnt(0)
    v_dot2_f32_bf16 v28, v32, s46, v28
    v_dot2_f32_bf16 v28, v33, s46, v28
    v_dot2_f32_bf16 v28, v34, s46, v28
    v_dot2_f32_bf16 v28, v35, s46, v28
    v_dot2_f32_bf16 v28, v36, s46, v28
    v_dot2_f32_bf16 v28, v37, s46, v28
    v_dot2_f32_bf16 v28, v38, s46, v28
    v_dot2_f32_bf16 v28, v39, s46, v28
    v_dot2_f32_bf16 v28, v40, s46, v28
    v_dot2_f32_bf16 v28, v41, s46, v28
    v_dot2_f32_bf16 v28, v42, s46, v28
    v_dot2_f32_bf16 v28, v43, s46, v28
    v_dot2_f32_bf16 v28, v44, s46, v28
    v_dot2_f32_bf16 v28, v45, s46, v28
    v_dot2_f32_bf16 v28, v46, s46, v28
    v_dot2_f32_bf16 v28, v47, s46, v28
    s_nop 2
    v_add_f32 v28, v28, v29
    v_mov_b32 v31, v28
    s_nop 1
    v_permlane32_swap_b32 v31, v28
    v_add_f32 v28, v31, v28
    ds_write_b32 v9, v28 offset:1024
    s_waitcnt vmcnt(0)
    ds_write_b32 v9, v16
    ds_write_b32 v9, v17 offset:512
    s_waitcnt lgkmcnt(0)
    s_barrier
    s_branch L1_done
L1_compute:
    s_bfe_u32 s43, s42, 0x10001
    s_and_b32 s44, s42, 1
    v_and_b32 v20, 31, v0
    v_lshrrev_b32 v21, 5, v0
    v_bfe_u32 v22, v0, 1, 3
    v_xor_b32 v22, v22, v21
    v_lshlrev_b32 v22, 4, v22
    v_lshlrev_b32 v23, 7, v20
    s_lshl_b32 s3, s43, 13
    v_add3_u32 v2, v23, v22, s3
    s_getpc_b64 s[46:47]
L_pcbase:
    s_sub_u32 s46, s46, L_pcbase-L_codestart
    s_subb_u32 s47, s47, 0
    s_lshr_b32 s3, s2, 3
    s_lshl_b32 s3, s3, 2
    s_and_b32 s14, s42, 3
    s_add_u32 s3, s3, s14
    s_lshl_b32 s3, s3, 9
    v_and_b32 v128, 3, v0
    v_lshl_add_u32 v128, v128, 7, s3
    v_min_u32 v129, L_codeend-L_codestart-4, v128
    global_load_dword v254, v129, s[46:47]
    v_xor_b32 v3, 32, v2
    v_xor_b32 v4, 64, v2
    v_xor_b32 v5, 96, v2
    v_add_u32 v6, 65536, v2
    v_add_u32 v7, 65536, v3
    v_add_u32 v8, 65536, v4
    v_add_u32 v9, 65536, v5
    v_bfe_u32 v22, v0, 2, 2
    v_lshl_add_u32 v23, v21, 3, v22
    v_lshlrev_b32 v23, 8, v23
    s_lshl_b32 s3, s44, 1
    v_xor_b32 v22, s3, v22
    v_lshlrev_b32 v22, 6, v22
    v_bfe_u32 v24, v0, 4, 1
    v_lshlrev_b32 v24, 5, v24
    v_add3_u32 v23, v23, v22, v24
    v_and_b32 v24, 3, v0
    v_lshlrev_b32 v24, 3, v24
    s_mov_b32 s3, 16384
    v_add3_u32 v14, v23, v24, s3
    v_xor_b32 v15, 64, v14
    v_add_u32 v16, 65536, v14
    v_add_u32 v17, 65536, v15
    s_waitcnt lgkmcnt(0)
    s_mov_b32 s24, s38
    s_mov_b32 s25, s39
    s_mov_b32 s26, 18890752
    s_mov_b32 s27, 0x00020000
    s_cmp_ge_u32 s41, 10
    s_cbranch_scc1 L1_vpath
    s_barrier
    ds_read_b128 v[32:35], v2 offset:0
    ds_read_b64_tr_b16 v[40:41], v14 offset:0
    ds_read_b64_tr_b16 v[42:43], v14 offset:1024
    ds_read_b128 v[36:39], v2 offset:4096
    ds_read_b64_tr_b16 v[44:45], v15 offset:0
    ds_read_b64_tr_b16 v[46:47], v15 offset:1024
    s_waitcnt lgkmcnt(3)
    v_mfma_f32_32x32x16_bf16 v[64:79], v[40:43], v[32:35], 0
    ds_read_b128 v[48:51], v3 offset:0
    ds_read_b64_tr_b16 v[56:57], v14 offset:4096
    ds_read_b64_tr_b16 v[58:59], v14 offset:5120
    s_waitcnt lgkmcnt(3)
    v_mfma_f32_32x32x16_bf16 v[96:111], v[40:43], v[36:39], 0
    ds_read_b128 v[52:55], v3 offset:4096
    ds_read_b64_tr_b16 v[60:61], v15 offset:4096
    ds_read_b64_tr_b16 v[62:63], v15 offset:5120
    v_mfma_f32_32x32x16_bf16 v[80:95], v[44:47], v[32:35], 0
    v_mfma_f32_32x32x16_bf16 v[112:127], v[44:47], v[36:39], 0
    s_waitcnt lgkmcnt(3)
    v_mfma_f32_32x32x16_bf16 v[64:79], v[56:59], v[48:51], v[64:79]
    ds_read_b128 v[32:35], v4 offset:0
    ds_read_b64_tr_b16 v[40:41], v14 offset:8192
    ds_read_b64_tr_b16 v[42:43], v14 offset:9216
    s_waitcnt lgkmcnt(3)
    v_mfma_f32_32x32x16_bf16 v[96:111], v[56:59], v[52:55], v[96:111]
    ds_read_b128 v[36:39], v4 offset:4096
    ds_read_b64_tr_b16 v[44:45], v15 offset:8192
    ds_read_b64_tr_b16 v[46:47], v15 offset:9216
    v_mfma_f32_32x32x16_bf16 v[80:95], v[60:63], v[48:51], v[80:95]
    v_mfma_f32_32x32x16_bf16 v[112:127], v[60:63], v[52:55], v[112:127]
    s_waitcnt lgkmcnt(3)
    v_mfma_f32_32x32x16_bf16 v[64:79], v[40:43], v[32:35], v[64:79]
    ds_read_b128 v[48:51], v5 offset:0
    ds_read_b64_tr_b16 v[56:57], v14 offset:12288
    ds_read_b64_tr_b16 v[58:59], v14 offset:13312
    s_waitcnt lgkmcnt(3)
    v_mfma_f32_32x32x16_bf16 v[96:111], v[40:43], v[36:39], v[96:111]
    ds_read_b128 v[52:55], v5 offset:4096
    ds_read_b64_tr_b16 v[60:61], v15 offset:12288
    ds_read_b64_tr_b16 v[62:63], v15 offset:13312
    v_mfma_f32_32x32x16_bf16 v[80:95], v[44:47], v[32:35], v[80:95]
    v_mfma_f32_32x32x16_bf16 v[112:127], v[44:47], v[36:39], v[112:127]
    s_waitcnt lgkmcnt(0)
    s_barrier
    v_mfma_f32_32x32x16_bf16 v[64:79], v[56:59], v[48:51], v[64:79]
    ds_read_b128 v[32:35], v2 offset:32768
    ds_read_b64_tr_b16 v[40:41], v14 offset:32768
    ds_read_b64_tr_b16 v[42:43], v14 offset:33792
    v_mfma_f32_32x32x16_bf16 v[96:111], v[56:59], v[52:55], v[96:111]
    ds_read_b128 v[36:39], v2 offset:36864
    ds_read_b64_tr_b16 v[44:45], v15 offset:32768
    ds_read_b64_tr_b16 v[46:47], v15 offset:33792
    v_mfma_f32_32x32x16_bf16 v[80:95], v[60:63], v[48:51], v[80:95]
    v_mfma_f32_32x32x16_bf16 v[112:127], v[60:63], v[52:55], v[112:127]
    s_waitcnt lgkmcnt(3)
    v_mfma_f32_32x32x16_bf16 v[64:79], v[40:43], v[32:35], v[64:79]
    ds_read_b128 v[48:51], v3 offset:32768
    ds_read_b64_tr_b16 v[56:57], v14 offset:36864
    ds_read_b64_tr_b16 v[58:59], v14 offset:37888
    s_waitcnt lgkmcnt(3)
    v_mfma_f32_32x32x16_bf16 v[96:111], v[40:43], v[36:39], v[96:111]
    ds_read_b128 v[52:55], v3 offset:36864
    ds_read_b64_tr_b16 v[60:61], v15 offset:36864
    ds_read_b64_tr_b16 v[62:63], v15 offset:37888
    v_mfma_f32_32x32x16_bf16 v[80:95], v[44:47], v[32:35], v[80:95]
    v_mfma_f32_32x32x16_bf16 v[112:127], v[44:47], v[36:39], v[112:127]
    s_waitcnt lgkmcnt(3)
    v_mfma_f32_32x32x16_bf16 v[64:79], v[56:59], v[48:51], v[64:79]
    ds_read_b128 v[32:35], v4 offset:32768
    ds_read_b64_tr_b16 v[40:41], v14 offset:40960
    ds_read_b64_tr_b16 v[42:43], v14 offset:41984
    s_waitcnt lgkmcnt(3)
    v_mfma_f32_32x32x16_bf16 v[96:111], v[56:59], v[52:55], v[96:111]
    ds_read_b128 v[36:39], v4 offset:36864
    ds_read_b64_tr_b16 v[44:45], v15 offset:40960
    ds_read_b64_tr_b16 v[46:47], v15 offset:41984
    v_mfma_f32_32x32x16_bf16 v[80:95], v[60:63], v[48:51], v[80:95]
    v_mfma_f32_32x32x16_bf16 v[112:127], v[60:63], v[52:55], v[112:127]
    s_waitcnt lgkmcnt(3)
    v_mfma_f32_32x32x16_bf16 v[64:79], v[40:43], v[32:35], v[64:79]
    ds_read_b128 v[48:51], v5 offset:32768
    ds_read_b64_tr_b16 v[56:57], v14 offset:45056
    ds_read_b64_tr_b16 v[58:59], v14 offset:46080
    s_waitcnt lgkmcnt(3)
    v_mfma_f32_32x32x16_bf16 v[96:111], v[40:43], v[36:39], v[96:111]
    ds_read_b128 v[52:55], v5 offset:36864
    ds_read_b64_tr_b16 v[60:61], v15 offset:45056
    ds_read_b64_tr_b16 v[62:63], v15 offset:46080
    v_mfma_f32_32x32x16_bf16 v[80:95], v[44:47], v[32:35], v[80:95]
    v_mfma_f32_32x32x16_bf16 v[112:127], v[44:47], v[36:39], v[112:127]
    s_waitcnt lgkmcnt(0)
    s_barrier
    v_mfma_f32_32x32x16_bf16 v[64:79], v[56:59], v[48:51], v[64:79]
    ds_read_b128 v[32:35], v6 offset:0
    ds_read_b64_tr_b16 v[40:41], v16 offset:0
    ds_read_b64_tr_b16 v[42:43], v16 offset:1024
    v_mfma_f32_32x32x16_bf16 v[96:111], v[56:59], v[52:55], v[96:111]
    ds_read_b128 v[36:39], v6 offset:4096
    ds_read_b64_tr_b16 v[44:45], v17 offset:0
    ds_read_b64_tr_b16 v[46:47], v17 offset:1024
    v_mfma_f32_32x32x16_bf16 v[80:95], v[60:63], v[48:51], v[80:95]
    v_mfma_f32_32x32x16_bf16 v[112:127], v[60:63], v[52:55], v[112:127]
    s_waitcnt lgkmcnt(3)
    v_mfma_f32_32x32x16_bf16 v[64:79], v[40:43], v[32:35], v[64:79]
    ds_read_b128 v[48:51], v7 offset:0
    ds_read_b64_tr_b16 v[56:57], v16 offset:4096
    ds_read_b64_tr_b16 v[58:59], v16 offset:5120
    s_waitcnt lgkmcnt(3)
    v_mfma_f32_32x32x16_bf16 v[96:111], v[40:43], v[36:39], v[96:111]
    ds_read_b128 v[52:55], v7 offset:4096
    ds_read_b64_tr_b16 v[60:61], v17 offset:4096
    ds_read_b64_tr_b16 v[62:63], v17 offset:5120
    v_mfma_f32_32x32x16_bf16 v[80:95], v[44:47], v[32:35], v[80:95]
    v_mfma_f32_32x32x16_bf16 v[112:127], v[44:47], v[36:39], v[112:127]
    s_waitcnt lgkmcnt(3)
    v_mfma_f32_32x32x16_bf16 v[64:79], v[56:59], v[48:51], v[64:79]
    ds_read_b128 v[32:35], v8 offset:0
    ds_read_b64_tr_b16 v[40:41], v16 offset:8192
    ds_read_b64_tr_b16 v[42:43], v16 offset:9216
    s_waitcnt lgkmcnt(3)
    v_mfma_f32_32x32x16_bf16 v[96:111], v[56:59], v[52:55], v[96:111]
    ds_read_b128 v[36:39], v8 offset:4096
    ds_read_b64_tr_b16 v[44:45], v17 offset:8192
    ds_read_b64_tr_b16 v[46:47], v17 offset:9216
    v_mfma_f32_32x32x16_bf16 v[80:95], v[60:63], v[48:51], v[80:95]
    v_mfma_f32_32x32x16_bf16 v[112:127], v[60:63], v[52:55], v[112:127]
    s_waitcnt lgkmcnt(3)
    v_mfma_f32_32x32x16_bf16 v[64:79], v[40:43], v[32:35], v[64:79]
    ds_read_b128 v[48:51], v9 offset:0
    ds_read_b64_tr_b16 v[56:57], v16 offset:12288
    ds_read_b64_tr_b16 v[58:59], v16 offset:13312
    s_waitcnt lgkmcnt(3)
    v_mfma_f32_32x32x16_bf16 v[96:111], v[40:43], v[36:39], v[96:111]
    ds_read_b128 v[52:55], v9 offset:4096
    ds_read_b64_tr_b16 v[60:61], v17 offset:12288
    ds_read_b64_tr_b16 v[62:63], v17 offset:13312
    v_mfma_f32_32x32x16_bf16 v[80:95], v[44:47], v[32:35], v[80:95]
    v_mfma_f32_32x32x16_bf16 v[112:127], v[44:47], v[36:39], v[112:127]
    s_waitcnt lgkmcnt(0)
    s_barrier
    v_mfma_f32_32x32x16_bf16 v[64:79], v[56:59], v[48:51], v[64:79]
    ds_read_b128 v[32:35], v6 offset:32768
    ds_read_b64_tr_b16 v[40:41], v16 offset:32768
    ds_read_b64_tr_b16 v[42:43], v16 offset:33792
    v_mfma_f32_32x32x16_bf16 v[96:111], v[56:59], v[52:55], v[96:111]
    ds_read_b128 v[36:39], v6 offset:36864
    ds_read_b64_tr_b16 v[44:45], v17 offset:32768
    ds_read_b64_tr_b16 v[46:47], v17 offset:33792
    v_mfma_f32_32x32x16_bf16 v[80:95], v[60:63], v[48:51], v[80:95]
    v_mfma_f32_32x32x16_bf16 v[112:127], v[60:63], v[52:55], v[112:127]
    s_waitcnt lgkmcnt(3)
    v_mfma_f32_32x32x16_bf16 v[64:79], v[40:43], v[32:35], v[64:79]
    ds_read_b128 v[48:51], v7 offset:32768
    ds_read_b64_tr_b16 v[56:57], v16 offset:36864
    ds_read_b64_tr_b16 v[58:59], v16 offset:37888
    s_waitcnt lgkmcnt(3)
    v_mfma_f32_32x32x16_bf16 v[96:111], v[40:43], v[36:39], v[96:111]
    ds_read_b128 v[52:55], v7 offset:36864
    ds_read_b64_tr_b16 v[60:61], v17 offset:36864
    ds_read_b64_tr_b16 v[62:63], v17 offset:37888
    v_mfma_f32_32x32x16_bf16 v[80:95], v[44:47], v[32:35], v[80:95]
    v_mfma_f32_32x32x16_bf16 v[112:127], v[44:47], v[36:39], v[112:127]
    s_waitcnt lgkmcnt(3)
    v_mfma_f32_32x32x16_bf16 v[64:79], v[56:59], v[48:51], v[64:79]
    ds_read_b128 v[32:35], v8 offset:32768
    ds_read_b64_tr_b16 v[40:41], v16 offset:40960
    ds_read_b64_tr_b16 v[42:43], v16 offset:41984
    s_waitcnt lgkmcnt(3)
    v_mfma_f32_32x32x16_bf16 v[96:111], v[56:59], v[52:55], v[96:111]
    ds_read_b128 v[36:39], v8 offset:36864
    ds_read_b64_tr_b16 v[44:45], v17 offset:40960
    ds_read_b64_tr_b16 v[46:47], v17 offset:41984
    v_mfma_f32_32x32x16_bf16 v[80:95], v[60:63], v[48:51], v[80:95]
    v_mfma_f32_32x32x16_bf16 v[112:127], v[60:63], v[52:55], v[112:127]
    s_waitcnt lgkmcnt(3)
    v_mfma_f32_32x32x16_bf16 v[64:79], v[40:43], v[32:35], v[64:79]
    ds_read_b128 v[48:51], v9 offset:32768
    ds_read_b64_tr_b16 v[56:57], v16 offset:45056
    ds_read_b64_tr_b16 v[58:59], v16 offset:46080
    s_waitcnt lgkmcnt(3)
    v_mfma_f32_32x32x16_bf16 v[96:111], v[40:43], v[36:39], v[96:111]
    ds_read_b128 v[52:55], v9 offset:36864
    ds_read_b64_tr_b16 v[60:61], v17 offset:45056
    ds_read_b64_tr_b16 v[62:63], v17 offset:46080
    v_mfma_f32_32x32x16_bf16 v[80:95], v[44:47], v[32:35], v[80:95]
    v_mfma_f32_32x32x16_bf16 v[112:127], v[44:47], v[36:39], v[112:127]
    s_waitcnt lgkmcnt(0)
    s_barrier
    v_mfma_f32_32x32x16_bf16 v[64:79], v[56:59], v[48:51], v[64:79]
    ds_read_b128 v[32:35], v2 offset:0
    ds_read_b64_tr_b16 v[40:41], v14 offset:0
    ds_read_b64_tr_b16 v[42:43], v14 offset:1024
    v_mfma_f32_32x32x16_bf16 v[96:111], v[56:59], v[52:55], v[96:111]
    ds_read_b128 v[36:39], v2 offset:4096
    ds_read_b64_tr_b16 v[44:45], v15 offset:0
    ds_read_b64_tr_b16 v[46:47], v15 offset:1024
    v_mfma_f32_32x32x16_bf16 v[80:95], v[60:63], v[48:51], v[80:95]
    v_mfma_f32_32x32x16_bf16 v[112:127], v[60:63], v[52:55], v[112:127]
    s_waitcnt lgkmcnt(3)
    v_mfma_f32_32x32x16_bf16 v[64:79], v[40:43], v[32:35], v[64:79]
    ds_read_b128 v[48:51], v3 offset:0
    ds_read_b64_tr_b16 v[56:57], v14 offset:4096
    ds_read_b64_tr_b16 v[58:59], v14 offset:5120
    s_waitcnt lgkmcnt(3)
    v_mfma_f32_32x32x16_bf16 v[96:111], v[40:43], v[36:39], v[96:111]
    ds_read_b128 v[52:55], v3 offset:4096
    ds_read_b64_tr_b16 v[60:61], v15 offset:4096
    ds_read_b64_tr_b16 v[62:63], v15 offset:5120
    v_mfma_f32_32x32x16_bf16 v[80:95], v[44:47], v[32:35], v[80:95]
    v_mfma_f32_32x32x16_bf16 v[112:127], v[44:47], v[36:39], v[112:127]
    s_waitcnt lgkmcnt(3)
    v_mfma_f32_32x32x16_bf16 v[64:79], v[56:59], v[48:51], v[64:79]
    ds_read_b128 v[32:35], v4 offset:0
    ds_read_b64_tr_b16 v[40:41], v14 offset:8192
    ds_read_b64_tr_b16 v[42:43], v14 offset:9216
    s_waitcnt lgkmcnt(3)
    v_mfma_f32_32x32x16_bf16 v[96:111], v[56:59], v[52:55], v[96:111]
    ds_read_b128 v[36:39], v4 offset:4096
    ds_read_b64_tr_b16 v[44:45], v15 offset:8192
    ds_read_b64_tr_b16 v[46:47], v15 offset:9216
    v_mfma_f32_32x32x16_bf16 v[80:95], v[60:63], v[48:51], v[80:95]
    v_mfma_f32_32x32x16_bf16 v[112:127], v[60:63], v[52:55], v[112:127]
    s_waitcnt lgkmcnt(3)
    v_mfma_f32_32x32x16_bf16 v[64:79], v[40:43], v[32:35], v[64:79]
    ds_read_b128 v[48:51], v5 offset:0
    ds_read_b64_tr_b16 v[56:57], v14 offset:12288
    ds_read_b64_tr_b16 v[58:59], v14 offset:13312
    s_waitcnt lgkmcnt(3)
    v_mfma_f32_32x32x16_bf16 v[96:111], v[40:43], v[36:39], v[96:111]
    ds_read_b128 v[52:55], v5 offset:4096
    ds_read_b64_tr_b16 v[60:61], v15 offset:12288
    ds_read_b64_tr_b16 v[62:63], v15 offset:13312
    v_mfma_f32_32x32x16_bf16 v[80:95], v[44:47], v[32:35], v[80:95]
    v_mfma_f32_32x32x16_bf16 v[112:127], v[44:47], v[36:39], v[112:127]
    s_waitcnt lgkmcnt(0)
    s_barrier
    v_mfma_f32_32x32x16_bf16 v[64:79], v[56:59], v[48:51], v[64:79]
    ds_read_b128 v[32:35], v2 offset:32768
    ds_read_b64_tr_b16 v[40:41], v14 offset:32768
    ds_read_b64_tr_b16 v[42:43], v14 offset:33792
    v_mfma_f32_32x32x16_bf16 v[96:111], v[56:59], v[52:55], v[96:111]
    ds_read_b128 v[36:39], v2 offset:36864
    ds_read_b64_tr_b16 v[44:45], v15 offset:32768
    ds_read_b64_tr_b16 v[46:47], v15 offset:33792
    v_mfma_f32_32x32x16_bf16 v[80:95], v[60:63], v[48:51], v[80:95]
    v_mfma_f32_32x32x16_bf16 v[112:127], v[60:63], v[52:55], v[112:127]
    s_waitcnt lgkmcnt(3)
    v_mfma_f32_32x32x16_bf16 v[64:79], v[40:43], v[32:35], v[64:79]
    ds_read_b128 v[48:51], v3 offset:32768
    ds_read_b64_tr_b16 v[56:57], v14 offset:36864
    ds_read_b64_tr_b16 v[58:59], v14 offset:37888
    s_waitcnt lgkmcnt(3)
    v_mfma_f32_32x32x16_bf16 v[96:111], v[40:43], v[36:39], v[96:111]
    ds_read_b128 v[52:55], v3 offset:36864
    ds_read_b64_tr_b16 v[60:61], v15 offset:36864
    ds_read_b64_tr_b16 v[62:63], v15 offset:37888
    v_mfma_f32_32x32x16_bf16 v[80:95], v[44:47], v[32:35], v[80:95]
    v_mfma_f32_32x32x16_bf16 v[112:127], v[44:47], v[36:39], v[112:127]
    s_waitcnt lgkmcnt(3)
    v_mfma_f32_32x32x16_bf16 v[64:79], v[56:59], v[48:51], v[64:79]
    ds_read_b128 v[32:35], v4 offset:32768
    ds_read_b64_tr_b16 v[40:41], v14 offset:40960
    ds_read_b64_tr_b16 v[42:43], v14 offset:41984
    s_waitcnt lgkmcnt(3)
    v_mfma_f32_32x32x16_bf16 v[96:111], v[56:59], v[52:55], v[96:111]
    ds_read_b128 v[36:39], v4 offset:36864
    ds_read_b64_tr_b16 v[44:45], v15 offset:40960
    ds_read_b64_tr_b16 v[46:47], v15 offset:41984
    v_mfma_f32_32x32x16_bf16 v[80:95], v[60:63], v[48:51], v[80:95]
    v_mfma_f32_32x32x16_bf16 v[112:127], v[60:63], v[52:55], v[112:127]
    s_waitcnt lgkmcnt(3)
    v_mfma_f32_32x32x16_bf16 v[64:79], v[40:43], v[32:35], v[64:79]
    ds_read_b128 v[48:51], v5 offset:32768
    ds_read_b64_tr_b16 v[56:57], v14 offset:45056
    ds_read_b64_tr_b16 v[58:59], v14 offset:46080
    s_waitcnt lgkmcnt(3)
    v_mfma_f32_32x32x16_bf16 v[96:111], v[40:43], v[36:39], v[96:111]
    ds_read_b128 v[52:55], v5 offset:36864
    ds_read_b64_tr_b16 v[60:61], v15 offset:45056
    ds_read_b64_tr_b16 v[62:63], v15 offset:46080
    v_mfma_f32_32x32x16_bf16 v[80:95], v[44:47], v[32:35], v[80:95]
    v_mfma_f32_32x32x16_bf16 v[112:127], v[44:47], v[36:39], v[112:127]
    s_waitcnt lgkmcnt(0)
    s_barrier
    v_mfma_f32_32x32x16_bf16 v[64:79], v[56:59], v[48:51], v[64:79]
    ds_read_b128 v[32:35], v6 offset:0
    ds_read_b64_tr_b16 v[40:41], v16 offset:0
    ds_read_b64_tr_b16 v[42:43], v16 offset:1024
    v_mfma_f32_32x32x16_bf16 v[96:111], v[56:59], v[52:55], v[96:111]
    ds_read_b128 v[36:39], v6 offset:4096
    ds_read_b64_tr_b16 v[44:45], v17 offset:0
    ds_read_b64_tr_b16 v[46:47], v17 offset:1024
    v_mfma_f32_32x32x16_bf16 v[80:95], v[60:63], v[48:51], v[80:95]
    v_mfma_f32_32x32x16_bf16 v[112:127], v[60:63], v[52:55], v[112:127]
    s_waitcnt lgkmcnt(3)
    v_mfma_f32_32x32x16_bf16 v[64:79], v[40:43], v[32:35], v[64:79]
    ds_read_b128 v[48:51], v7 offset:0
    ds_read_b64_tr_b16 v[56:57], v16 offset:4096
    ds_read_b64_tr_b16 v[58:59], v16 offset:5120
    s_waitcnt lgkmcnt(3)
    v_mfma_f32_32x32x16_bf16 v[96:111], v[40:43], v[36:39], v[96:111]
    ds_read_b128 v[52:55], v7 offset:4096
    ds_read_b64_tr_b16 v[60:61], v17 offset:4096
    ds_read_b64_tr_b16 v[62:63], v17 offset:5120
    v_mfma_f32_32x32x16_bf16 v[80:95], v[44:47], v[32:35], v[80:95]
    v_mfma_f32_32x32x16_bf16 v[112:127], v[44:47], v[36:39], v[112:127]
    s_waitcnt lgkmcnt(3)
    v_mfma_f32_32x32x16_bf16 v[64:79], v[56:59], v[48:51], v[64:79]
    ds_read_b128 v[32:35], v8 offset:0
    ds_read_b64_tr_b16 v[40:41], v16 offset:8192
    ds_read_b64_tr_b16 v[42:43], v16 offset:9216
    s_waitcnt lgkmcnt(3)
    v_mfma_f32_32x32x16_bf16 v[96:111], v[56:59], v[52:55], v[96:111]
    ds_read_b128 v[36:39], v8 offset:4096
    ds_read_b64_tr_b16 v[44:45], v17 offset:8192
    ds_read_b64_tr_b16 v[46:47], v17 offset:9216
    v_mfma_f32_32x32x16_bf16 v[80:95], v[60:63], v[48:51], v[80:95]
    v_mfma_f32_32x32x16_bf16 v[112:127], v[60:63], v[52:55], v[112:127]
    s_waitcnt lgkmcnt(3)
    v_mfma_f32_32x32x16_bf16 v[64:79], v[40:43], v[32:35], v[64:79]
    ds_read_b128 v[48:51], v9 offset:0
    ds_read_b64_tr_b16 v[56:57], v16 offset:12288
    ds_read_b64_tr_b16 v[58:59], v16 offset:13312
    s_waitcnt lgkmcnt(3)
    v_mfma_f32_32x32x16_bf16 v[96:111], v[40:43], v[36:39], v[96:111]
    ds_read_b128 v[52:55], v9 offset:4096
    ds_read_b64_tr_b16 v[60:61], v17 offset:12288
    ds_read_b64_tr_b16 v[62:63], v17 offset:13312
    v_mfma_f32_32x32x16_bf16 v[80:95], v[44:47], v[32:35], v[80:95]
    v_mfma_f32_32x32x16_bf16 v[112:127], v[44:47], v[36:39], v[112:127]
    s_waitcnt lgkmcnt(0)
    s_barrier
    v_mfma_f32_32x32x16_bf16 v[64:79], v[56:59], v[48:51], v[64:79]
    ds_read_b128 v[32:35], v6 offset:32768
    ds_read_b64_tr_b16 v[40:41], v16 offset:32768
    ds_read_b64_tr_b16 v[42:43], v16 offset:33792
    v_mfma_f32_32x32x16_bf16 v[96:111], v[56:59], v[52:55], v[96:111]
    ds_read_b128 v[36:39], v6 offset:36864
    ds_read_b64_tr_b16 v[44:45], v17 offset:32768
    ds_read_b64_tr_b16 v[46:47], v17 offset:33792
    v_mfma_f32_32x32x16_bf16 v[80:95], v[60:63], v[48:51], v[80:95]
    v_mfma_f32_32x32x16_bf16 v[112:127], v[60:63], v[52:55], v[112:127]
    s_waitcnt lgkmcnt(3)
    v_mfma_f32_32x32x16_bf16 v[64:79], v[40:43], v[32:35], v[64:79]
    ds_read_b128 v[48:51], v7 offset:32768
    ds_read_b64_tr_b16 v[56:57], v16 offset:36864
    ds_read_b64_tr_b16 v[58:59], v16 offset:37888
    s_waitcnt lgkmcnt(3)
    v_mfma_f32_32x32x16_bf16 v[96:111], v[40:43], v[36:39], v[96:111]
    ds_read_b128 v[52:55], v7 offset:36864
    ds_read_b64_tr_b16 v[60:61], v17 offset:36864
    ds_read_b64_tr_b16 v[62:63], v17 offset:37888
    v_mfma_f32_32x32x16_bf16 v[80:95], v[44:47], v[32:35], v[80:95]
    v_mfma_f32_32x32x16_bf16 v[112:127], v[44:47], v[36:39], v[112:127]
    s_waitcnt lgkmcnt(3)
    v_mfma_f32_32x32x16_bf16 v[64:79], v[56:59], v[48:51], v[64:79]
    ds_read_b128 v[32:35], v8 offset:32768
    ds_read_b64_tr_b16 v[40:41], v16 offset:40960
    ds_read_b64_tr_b16 v[42:43], v16 offset:41984
    s_waitcnt lgkmcnt(3)
    v_mfma_f32_32x32x16_bf16 v[96:111], v[56:59], v[52:55], v[96:111]
    ds_read_b128 v[36:39], v8 offset:36864
    ds_read_b64_tr_b16 v[44:45], v17 offset:40960
    ds_read_b64_tr_b16 v[46:47], v17 offset:41984
    v_mfma_f32_32x32x16_bf16 v[80:95], v[60:63], v[48:51], v[80:95]
    v_mfma_f32_32x32x16_bf16 v[112:127], v[60:63], v[52:55], v[112:127]
    s_waitcnt lgkmcnt(3)
    v_mfma_f32_32x32x16_bf16 v[64:79], v[40:43], v[32:35], v[64:79]
    ds_read_b128 v[48:51], v9 offset:32768
    ds_read_b64_tr_b16 v[56:57], v16 offset:45056
    ds_read_b64_tr_b16 v[58:59], v16 offset:46080
    s_waitcnt lgkmcnt(3)
    v_mfma_f32_32x32x16_bf16 v[96:111], v[40:43], v[36:39], v[96:111]
    ds_read_b128 v[52:55], v9 offset:36864
    ds_read_b64_tr_b16 v[60:61], v17 offset:45056
    ds_read_b64_tr_b16 v[62:63], v17 offset:46080
    v_mfma_f32_32x32x16_bf16 v[80:95], v[44:47], v[32:35], v[80:95]
    v_mfma_f32_32x32x16_bf16 v[112:127], v[44:47], v[36:39], v[112:127]
    s_waitcnt lgkmcnt(0)
    s_barrier
    v_mfma_f32_32x32x16_bf16 v[64:79], v[56:59], v[48:51], v[64:79]
    ds_read_b128 v[32:35], v2 offset:0
    ds_read_b64_tr_b16 v[40:41], v14 offset:0
    ds_read_b64_tr_b16 v[42:43], v14 offset:1024
    v_mfma_f32_32x32x16_bf16 v[96:111], v[56:59], v[52:55], v[96:111]
    ds_read_b128 v[36:39], v2 offset:4096
    ds_read_b64_tr_b16 v[44:45], v15 offset:0
    ds_read_b64_tr_b16 v[46:47], v15 offset:1024
    v_mfma_f32_32x32x16_bf16 v[80:95], v[60:63], v[48:51], v[80:95]
    v_mfma_f32_32x32x16_bf16 v[112:127], v[60:63], v[52:55], v[112:127]
    s_waitcnt lgkmcnt(3)
    v_mfma_f32_32x32x16_bf16 v[64:79], v[40:43], v[32:35], v[64:79]
    ds_read_b128 v[48:51], v3 offset:0
    ds_read_b64_tr_b16 v[56:57], v14 offset:4096
    ds_read_b64_tr_b16 v[58:59], v14 offset:5120
    s_waitcnt lgkmcnt(3)
    v_mfma_f32_32x32x16_bf16 v[96:111], v[40:43], v[36:39], v[96:111]
    ds_read_b128 v[52:55], v3 offset:4096
    ds_read_b64_tr_b16 v[60:61], v15 offset:4096
    ds_read_b64_tr_b16 v[62:63], v15 offset:5120
    v_mfma_f32_32x32x16_bf16 v[80:95], v[44:47], v[32:35], v[80:95]
    v_mfma_f32_32x32x16_bf16 v[112:127], v[44:47], v[36:39], v[112:127]
    s_waitcnt lgkmcnt(3)
    v_mfma_f32_32x32x16_bf16 v[64:79], v[56:59], v[48:51], v[64:79]
    ds_read_b128 v[32:35], v4 offset:0
    ds_read_b64_tr_b16 v[40:41], v14 offset:8192
    ds_read_b64_tr_b16 v[42:43], v14 offset:9216
    s_waitcnt lgkmcnt(3)
    v_mfma_f32_32x32x16_bf16 v[96:111], v[56:59], v[52:55], v[96:111]
    ds_read_b128 v[36:39], v4 offset:4096
    ds_read_b64_tr_b16 v[44:45], v15 offset:8192
    ds_read_b64_tr_b16 v[46:47], v15 offset:9216
    v_mfma_f32_32x32x16_bf16 v[80:95], v[60:63], v[48:51], v[80:95]
    v_mfma_f32_32x32x16_bf16 v[112:127], v[60:63], v[52:55], v[112:127]
    s_waitcnt lgkmcnt(3)
    v_mfma_f32_32x32x16_bf16 v[64:79], v[40:43], v[32:35], v[64:79]
    ds_read_b128 v[48:51], v5 offset:0
    ds_read_b64_tr_b16 v[56:57], v14 offset:12288
    ds_read_b64_tr_b16 v[58:59], v14 offset:13312
    s_waitcnt lgkmcnt(3)
    v_mfma_f32_32x32x16_bf16 v[96:111], v[40:43], v[36:39], v[96:111]
    ds_read_b128 v[52:55], v5 offset:4096
    ds_read_b64_tr_b16 v[60:61], v15 offset:12288
    ds_read_b64_tr_b16 v[62:63], v15 offset:13312
    v_mfma_f32_32x32x16_bf16 v[80:95], v[44:47], v[32:35], v[80:95]
    v_mfma_f32_32x32x16_bf16 v[112:127], v[44:47], v[36:39], v[112:127]
    s_waitcnt lgkmcnt(0)
    s_barrier
    v_mfma_f32_32x32x16_bf16 v[64:79], v[56:59], v[48:51], v[64:79]
    ds_read_b128 v[32:35], v2 offset:32768
    ds_read_b64_tr_b16 v[40:41], v14 offset:32768
    ds_read_b64_tr_b16 v[42:43], v14 offset:33792
    v_mfma_f32_32x32x16_bf16 v[96:111], v[56:59], v[52:55], v[96:111]
    ds_read_b128 v[36:39], v2 offset:36864
    ds_read_b64_tr_b16 v[44:45], v15 offset:32768
    ds_read_b64_tr_b16 v[46:47], v15 offset:33792
    v_mfma_f32_32x32x16_bf16 v[80:95], v[60:63], v[48:51], v[80:95]
    v_mfma_f32_32x32x16_bf16 v[112:127], v[60:63], v[52:55], v[112:127]
    s_waitcnt lgkmcnt(3)
    v_mfma_f32_32x32x16_bf16 v[64:79], v[40:43], v[32:35], v[64:79]
    ds_read_b128 v[48:51], v3 offset:32768
    ds_read_b64_tr_b16 v[56:57], v14 offset:36864
    ds_read_b64_tr_b16 v[58:59], v14 offset:37888
    s_waitcnt lgkmcnt(3)
    v_mfma_f32_32x32x16_bf16 v[96:111], v[40:43], v[36:39], v[96:111]
    ds_read_b128 v[52:55], v3 offset:36864
    ds_read_b64_tr_b16 v[60:61], v15 offset:36864
    ds_read_b64_tr_b16 v[62:63], v15 offset:37888
    v_mfma_f32_32x32x16_bf16 v[80:95], v[44:47], v[32:35], v[80:95]
    v_mfma_f32_32x32x16_bf16 v[112:127], v[44:47], v[36:39], v[112:127]
    s_waitcnt lgkmcnt(3)
    v_mfma_f32_32x32x16_bf16 v[64:79], v[56:59], v[48:51], v[64:79]
    ds_read_b128 v[32:35], v4 offset:32768
    ds_read_b64_tr_b16 v[40:41], v14 offset:40960
    ds_read_b64_tr_b16 v[42:43], v14 offset:41984
    s_waitcnt lgkmcnt(3)
    v_mfma_f32_32x32x16_bf16 v[96:111], v[56:59], v[52:55], v[96:111]
    ds_read_b128 v[36:39], v4 offset:36864
    ds_read_b64_tr_b16 v[44:45], v15 offset:40960
    ds_read_b64_tr_b16 v[46:47], v15 offset:41984
    v_mfma_f32_32x32x16_bf16 v[80:95], v[60:63], v[48:51], v[80:95]
    v_mfma_f32_32x32x16_bf16 v[112:127], v[60:63], v[52:55], v[112:127]
    s_waitcnt lgkmcnt(3)
    v_mfma_f32_32x32x16_bf16 v[64:79], v[40:43], v[32:35], v[64:79]
    ds_read_b128 v[48:51], v5 offset:32768
    ds_read_b64_tr_b16 v[56:57], v14 offset:45056
    ds_read_b64_tr_b16 v[58:59], v14 offset:46080
    s_waitcnt lgkmcnt(3)
    v_mfma_f32_32x32x16_bf16 v[96:111], v[40:43], v[36:39], v[96:111]
    ds_read_b128 v[52:55], v5 offset:36864
    ds_read_b64_tr_b16 v[60:61], v15 offset:45056
    ds_read_b64_tr_b16 v[62:63], v15 offset:46080
    v_mfma_f32_32x32x16_bf16 v[80:95], v[44:47], v[32:35], v[80:95]
    v_mfma_f32_32x32x16_bf16 v[112:127], v[44:47], v[36:39], v[112:127]
    s_waitcnt lgkmcnt(0)
    v_mfma_f32_32x32x16_bf16 v[64:79], v[56:59], v[48:51], v[64:79]
    v_mfma_f32_32x32x16_bf16 v[96:111], v[56:59], v[52:55], v[96:111]
    v_mfma_f32_32x32x16_bf16 v[80:95], v[60:63], v[48:51], v[80:95]
    v_mfma_f32_32x32x16_bf16 v[112:127], v[60:63], v[52:55], v[112:127]
    s_setprio 2
    s_cmp_ge_u32 s41, 5
    s_cselect_b32 s46, 1.0, 0x3ea52b5c
    s_cselect_b32 s47, 2457600, 0
    s_cselect_b64 vcc, -1, 0
    v_and_b32 v6, 19, v20
    v_bfe_u32 v7, v20, 2, 1
    v_lshl_or_b32 v6, v7, 3, v6
    v_bfe_u32 v7, v20, 3, 1
    v_lshl_or_b32 v6, v7, 2, v6
    v_cndmask_b32 v6, v20, v6, vcc
    v_lshlrev_b32 v6, 4, v6
    v_lshl_add_u32 v6, v21, 11, v6
    s_mul_i32 s3, s40, 163840
    s_add_u32 s47, s47, s3
    s_lshl_b32 s3, s41, 15
    s_add_u32 s47, s47, s3
    s_lshl_b32 s3, s44, 14
    s_add_u32 s47, s47, s3
    s_lshl_b32 s3, s43, 10
    s_add_u32 s47, s47, s3
    v_add_u32 v2, s47, v6
    v_xor_b32 v4, 1, v21
    v_and_b32 v4, v244, v4
    v_mul_u32_u24 v3, 0xffff, v4
    v_not_b32 v3, v3
    s_barrier
    s_lshl_b32 s3, s43, 8
    s_add_u32 s3, s3, 0
    v_lshl_add_u32 v18, v20, 2, s3
    ds_read_b32 v14, v18
    ds_read_b32 v15, v18 offset:128
    ds_read_b32 v16, v18 offset:512
    ds_read_b32 v17, v18 offset:640
    s_lshl_b32 s3, s44, 8
    s_add_u32 s3, s3, 1024
    v_lshl_add_u32 v19, v21, 4, s3
    ds_read_b128 v[32:35], v19 offset:0
    ds_read_b128 v[36:39], v19 offset:32
    ds_read_b128 v[40:43], v19 offset:64
    ds_read_b128 v[44:47], v19 offset:96
    ds_read_b128 v[48:51], v19 offset:128
    ds_read_b128 v[52:55], v19 offset:160
    ds_read_b128 v[56:59], v19 offset:192
    ds_read_b128 v[60:63], v19 offset:224
    s_waitcnt lgkmcnt(8)
    v_mul_f32 v16, s46, v16
    v_mul_f32 v17, s46, v17
    s_waitcnt lgkmcnt(0)
    v_pk_fma_f32 v[64:65], v[14:15], v[32:33], v[64:65] op_sel:[0,0,0] op_sel_hi:[0,1,1] neg_lo:[1,0,0] neg_hi:[1,0,0]
    v_pk_fma_f32 v[66:67], v[14:15], v[34:35], v[66:67] op_sel:[0,0,0] op_sel_hi:[0,1,1] neg_lo:[1,0,0] neg_hi:[1,0,0]
    v_pk_fma_f32 v[68:69], v[14:15], v[36:37], v[68:69] op_sel:[0,0,0] op_sel_hi:[0,1,1] neg_lo:[1,0,0] neg_hi:[1,0,0]
    v_pk_fma_f32 v[70:71], v[14:15], v[38:39], v[70:71] op_sel:[0,0,0] op_sel_hi:[0,1,1] neg_lo:[1,0,0] neg_hi:[1,0,0]
    v_pk_fma_f32 v[72:73], v[14:15], v[40:41], v[72:73] op_sel:[0,0,0] op_sel_hi:[0,1,1] neg_lo:[1,0,0] neg_hi:[1,0,0]
    v_pk_fma_f32 v[74:75], v[14:15], v[42:43], v[74:75] op_sel:[0,0,0] op_sel_hi:[0,1,1] neg_lo:[1,0,0] neg_hi:[1,0,0]
    v_pk_fma_f32 v[76:77], v[14:15], v[44:45], v[76:77] op_sel:[0,0,0] op_sel_hi:[0,1,1] neg_lo:[1,0,0] neg_hi:[1,0,0]
    v_pk_fma_f32 v[78:79], v[14:15], v[46:47], v[78:79] op_sel:[0,0,0] op_sel_hi:[0,1,1] neg_lo:[1,0,0] neg_hi:[1,0,0]
    v_pk_mul_f32 v[64:65], v[16:17], v[64:65] op_sel:[0,0] op_sel_hi:[0,1]
    v_pk_mul_f32 v[66:67], v[16:17], v[66:67] op_sel:[0,0] op_sel_hi:[0,1]
    v_pk_mul_f32 v[68:69], v[16:17], v[68:69] op_sel:[0,0] op_sel_hi:[0,1]
    v_pk_mul_f32 v[70:71], v[16:17], v[70:71] op_sel:[0,0] op_sel_hi:[0,1]
    v_pk_mul_f32 v[72:73], v[16:17], v[72:73] op_sel:[0,0] op_sel_hi:[0,1]
    v_pk_mul_f32 v[74:75], v[16:17], v[74:75] op_sel:[0,0] op_sel_hi:[0,1]
    v_pk_mul_f32 v[76:77], v[16:17], v[76:77] op_sel:[0,0] op_sel_hi:[0,1]
    v_pk_mul_f32 v[78:79], v[16:17], v[78:79] op_sel:[0,0] op_sel_hi:[0,1]
    v_and_b32 v64, v64, v3
    v_and_b32 v68, v68, v3
    v_and_b32 v72, v72, v3
    v_and_b32 v76, v76, v3
    v_cvt_pk_bf16_f32 v64, v64, v65
    v_cvt_pk_bf16_f32 v65, v66, v67
    v_cvt_pk_bf16_f32 v66, v68, v69
    v_cvt_pk_bf16_f32 v67, v70, v71
    v_cvt_pk_bf16_f32 v68, v72, v73
    v_cvt_pk_bf16_f32 v69, v74, v75
    v_cvt_pk_bf16_f32 v70, v76, v77
    v_cvt_pk_bf16_f32 v71, v78, v79
    s_mov_b32 s3, 0
    s_mov_b32 s14, 4096
    v_permlane32_swap_b32 v64, v66
    v_permlane32_swap_b32 v65, v67
    v_permlane32_swap_b32 v68, v70
    v_permlane32_swap_b32 v69, v71
    v_or_b32 v64, v244, v64
    buffer_store_dwordx4 v[64:67], v2, s[24:27], s3 offen sc1
    v_or_b32 v68, v244, v68
    buffer_store_dwordx4 v[68:71], v2, s[24:27], s14 offen sc1
    v_pk_fma_f32 v[96:97], v[14:15], v[32:33], v[96:97] op_sel:[1,0,0] op_sel_hi:[1,1,1] neg_lo:[1,0,0] neg_hi:[1,0,0]
    v_pk_fma_f32 v[98:99], v[14:15], v[34:35], v[98:99] op_sel:[1,0,0] op_sel_hi:[1,1,1] neg_lo:[1,0,0] neg_hi:[1,0,0]
    v_pk_fma_f32 v[100:101], v[14:15], v[36:37], v[100:101] op_sel:[1,0,0] op_sel_hi:[1,1,1] neg_lo:[1,0,0] neg_hi:[1,0,0]
    v_pk_fma_f32 v[102:103], v[14:15], v[38:39], v[102:103] op_sel:[1,0,0] op_sel_hi:[1,1,1] neg_lo:[1,0,0] neg_hi:[1,0,0]
    v_pk_fma_f32 v[104:105], v[14:15], v[40:41], v[104:105] op_sel:[1,0,0] op_sel_hi:[1,1,1] neg_lo:[1,0,0] neg_hi:[1,0,0]
    v_pk_fma_f32 v[106:107], v[14:15], v[42:43], v[106:107] op_sel:[1,0,0] op_sel_hi:[1,1,1] neg_lo:[1,0,0] neg_hi:[1,0,0]
    v_pk_fma_f32 v[108:109], v[14:15], v[44:45], v[108:109] op_sel:[1,0,0] op_sel_hi:[1,1,1] neg_lo:[1,0,0] neg_hi:[1,0,0]
    v_pk_fma_f32 v[110:111], v[14:15], v[46:47], v[110:111] op_sel:[1,0,0] op_sel_hi:[1,1,1] neg_lo:[1,0,0] neg_hi:[1,0,0]
    v_pk_mul_f32 v[96:97], v[16:17], v[96:97] op_sel:[1,0] op_sel_hi:[1,1]
    v_pk_mul_f32 v[98:99], v[16:17], v[98:99] op_sel:[1,0] op_sel_hi:[1,1]
    v_pk_mul_f32 v[100:101], v[16:17], v[100:101] op_sel:[1,0] op_sel_hi:[1,1]
    v_pk_mul_f32 v[102:103], v[16:17], v[102:103] op_sel:[1,0] op_sel_hi:[1,1]
    v_pk_mul_f32 v[104:105], v[16:17], v[104:105] op_sel:[1,0] op_sel_hi:[1,1]
    v_pk_mul_f32 v[106:107], v[16:17], v[106:107] op_sel:[1,0] op_sel_hi:[1,1]
    v_pk_mul_f32 v[108:109], v[16:17], v[108:109] op_sel:[1,0] op_sel_hi:[1,1]
    v_pk_mul_f32 v[110:111], v[16:17], v[110:111] op_sel:[1,0] op_sel_hi:[1,1]
    v_and_b32 v96, v96, v3
    v_and_b32 v100, v100, v3
    v_and_b32 v104, v104, v3
    v_and_b32 v108, v108, v3
    v_cvt_pk_bf16_f32 v96, v96, v97
    v_cvt_pk_bf16_f32 v97, v98, v99
    v_cvt_pk_bf16_f32 v98, v100, v101
    v_cvt_pk_bf16_f32 v99, v102, v103
    v_cvt_pk_bf16_f32 v100, v104, v105
    v_cvt_pk_bf16_f32 v101, v106, v107
    v_cvt_pk_bf16_f32 v102, v108, v109
    v_cvt_pk_bf16_f32 v103, v110, v111
    s_mov_b32 s3, 512
    s_mov_b32 s14, 4608
    v_permlane32_swap_b32 v96, v98
    v_permlane32_swap_b32 v97, v99
    v_permlane32_swap_b32 v100, v102
    v_permlane32_swap_b32 v101, v103
    v_or_b32 v96, v244, v96
    buffer_store_dwordx4 v[96:99], v2, s[24:27], s3 offen sc1
    v_or_b32 v100, v244, v100
    buffer_store_dwordx4 v[100:103], v2, s[24:27], s14 offen sc1
    v_pk_fma_f32 v[80:81], v[14:15], v[48:49], v[80:81] op_sel:[0,0,0] op_sel_hi:[0,1,1] neg_lo:[1,0,0] neg_hi:[1,0,0]
    v_pk_fma_f32 v[82:83], v[14:15], v[50:51], v[82:83] op_sel:[0,0,0] op_sel_hi:[0,1,1] neg_lo:[1,0,0] neg_hi:[1,0,0]
    v_pk_fma_f32 v[84:85], v[14:15], v[52:53], v[84:85] op_sel:[0,0,0] op_sel_hi:[0,1,1] neg_lo:[1,0,0] neg_hi:[1,0,0]
    v_pk_fma_f32 v[86:87], v[14:15], v[54:55], v[86:87] op_sel:[0,0,0] op_sel_hi:[0,1,1] neg_lo:[1,0,0] neg_hi:[1,0,0]
    v_pk_fma_f32 v[88:89], v[14:15], v[56:57], v[88:89] op_sel:[0,0,0] op_sel_hi:[0,1,1] neg_lo:[1,0,0] neg_hi:[1,0,0]
    v_pk_fma_f32 v[90:91], v[14:15], v[58:59], v[90:91] op_sel:[0,0,0] op_sel_hi:[0,1,1] neg_lo:[1,0,0] neg_hi:[1,0,0]
    v_pk_fma_f32 v[92:93], v[14:15], v[60:61], v[92:93] op_sel:[0,0,0] op_sel_hi:[0,1,1] neg_lo:[1,0,0] neg_hi:[1,0,0]
    v_pk_fma_f32 v[94:95], v[14:15], v[62:63], v[94:95] op_sel:[0,0,0] op_sel_hi:[0,1,1] neg_lo:[1,0,0] neg_hi:[1,0,0]
    v_pk_mul_f32 v[80:81], v[16:17], v[80:81] op_sel:[0,0] op_sel_hi:[0,1]
    v_pk_mul_f32 v[82:83], v[16:17], v[82:83] op_sel:[0,0] op_sel_hi:[0,1]
    v_pk_mul_f32 v[84:85], v[16:17], v[84:85] op_sel:[0,0] op_sel_hi:[0,1]
    v_pk_mul_f32 v[86:87], v[16:17], v[86:87] op_sel:[0,0] op_sel_hi:[0,1]
    v_pk_mul_f32 v[88:89], v[16:17], v[88:89] op_sel:[0,0] op_sel_hi:[0,1]
    v_pk_mul_f32 v[90:91], v[16:17], v[90:91] op_sel:[0,0] op_sel_hi:[0,1]
    v_pk_mul_f32 v[92:93], v[16:17], v[92:93] op_sel:[0,0] op_sel_hi:[0,1]
    v_pk_mul_f32 v[94:95], v[16:17], v[94:95] op_sel:[0,0] op_sel_hi:[0,1]
    v_and_b32 v80, v80, v3
    v_and_b32 v84, v84, v3
    v_and_b32 v88, v88, v3
    v_and_b32 v92, v92, v3
    v_cvt_pk_bf16_f32 v80, v80, v81
    v_cvt_pk_bf16_f32 v81, v82, v83
    v_cvt_pk_bf16_f32 v82, v84, v85
    v_cvt_pk_bf16_f32 v83, v86, v87
    v_cvt_pk_bf16_f32 v84, v88, v89
    v_cvt_pk_bf16_f32 v85, v90, v91
    v_cvt_pk_bf16_f32 v86, v92, v93
    v_cvt_pk_bf16_f32 v87, v94, v95
    s_mov_b32 s3, 8192
    s_mov_b32 s14, 12288
    v_permlane32_swap_b32 v80, v82
    v_permlane32_swap_b32 v81, v83
    v_permlane32_swap_b32 v84, v86
    v_permlane32_swap_b32 v85, v87
    v_or_b32 v80, v244, v80
    buffer_store_dwordx4 v[80:83], v2, s[24:27], s3 offen sc1
    v_or_b32 v84, v244, v84
    buffer_store_dwordx4 v[84:87], v2, s[24:27], s14 offen sc1
    v_pk_fma_f32 v[112:113], v[14:15], v[48:49], v[112:113] op_sel:[1,0,0] op_sel_hi:[1,1,1] neg_lo:[1,0,0] neg_hi:[1,0,0]
    v_pk_fma_f32 v[114:115], v[14:15], v[50:51], v[114:115] op_sel:[1,0,0] op_sel_hi:[1,1,1] neg_lo:[1,0,0] neg_hi:[1,0,0]
    v_pk_fma_f32 v[116:117], v[14:15], v[52:53], v[116:117] op_sel:[1,0,0] op_sel_hi:[1,1,1] neg_lo:[1,0,0] neg_hi:[1,0,0]
    v_pk_fma_f32 v[118:119], v[14:15], v[54:55], v[118:119] op_sel:[1,0,0] op_sel_hi:[1,1,1] neg_lo:[1,0,0] neg_hi:[1,0,0]
    v_pk_fma_f32 v[120:121], v[14:15], v[56:57], v[120:121] op_sel:[1,0,0] op_sel_hi:[1,1,1] neg_lo:[1,0,0] neg_hi:[1,0,0]
    v_pk_fma_f32 v[122:123], v[14:15], v[58:59], v[122:123] op_sel:[1,0,0] op_sel_hi:[1,1,1] neg_lo:[1,0,0] neg_hi:[1,0,0]
    v_pk_fma_f32 v[124:125], v[14:15], v[60:61], v[124:125] op_sel:[1,0,0] op_sel_hi:[1,1,1] neg_lo:[1,0,0] neg_hi:[1,0,0]
    v_pk_fma_f32 v[126:127], v[14:15], v[62:63], v[126:127] op_sel:[1,0,0] op_sel_hi:[1,1,1] neg_lo:[1,0,0] neg_hi:[1,0,0]
    v_pk_mul_f32 v[112:113], v[16:17], v[112:113] op_sel:[1,0] op_sel_hi:[1,1]
    v_pk_mul_f32 v[114:115], v[16:17], v[114:115] op_sel:[1,0] op_sel_hi:[1,1]
    v_pk_mul_f32 v[116:117], v[16:17], v[116:117] op_sel:[1,0] op_sel_hi:[1,1]
    v_pk_mul_f32 v[118:119], v[16:17], v[118:119] op_sel:[1,0] op_sel_hi:[1,1]
    v_pk_mul_f32 v[120:121], v[16:17], v[120:121] op_sel:[1,0] op_sel_hi:[1,1]
    v_pk_mul_f32 v[122:123], v[16:17], v[122:123] op_sel:[1,0] op_sel_hi:[1,1]
    v_pk_mul_f32 v[124:125], v[16:17], v[124:125] op_sel:[1,0] op_sel_hi:[1,1]
    v_pk_mul_f32 v[126:127], v[16:17], v[126:127] op_sel:[1,0] op_sel_hi:[1,1]
    v_and_b32 v112, v112, v3
    v_and_b32 v116, v116, v3
    v_and_b32 v120, v120, v3
    v_and_b32 v124, v124, v3
    v_cvt_pk_bf16_f32 v112, v112, v113
    v_cvt_pk_bf16_f32 v113, v114, v115
    v_cvt_pk_bf16_f32 v114, v116, v117
    v_cvt_pk_bf16_f32 v115, v118, v119
    v_cvt_pk_bf16_f32 v116, v120, v121
    v_cvt_pk_bf16_f32 v117, v122, v123
    v_cvt_pk_bf16_f32 v118, v124, v125
    v_cvt_pk_bf16_f32 v119, v126, v127
    s_mov_b32 s3, 8704
    s_mov_b32 s14, 12800
    v_permlane32_swap_b32 v112, v114
    v_permlane32_swap_b32 v113, v115
    v_permlane32_swap_b32 v116, v118
    v_permlane32_swap_b32 v117, v119
    v_or_b32 v112, v244, v112
    buffer_store_dwordx4 v[112:115], v2, s[24:27], s3 offen sc1
    v_or_b32 v116, v244, v116
    buffer_store_dwordx4 v[116:119], v2, s[24:27], s14 offen sc1
    s_branch L1_done
L1_vpath:
    s_barrier
    ds_read_b128 v[32:35], v2 offset:0
    ds_read_b64_tr_b16 v[40:41], v14 offset:0
    ds_read_b64_tr_b16 v[42:43], v14 offset:1024
    ds_read_b128 v[36:39], v2 offset:4096
    ds_read_b64_tr_b16 v[44:45], v15 offset:0
    ds_read_b64_tr_b16 v[46:47], v15 offset:1024
    s_waitcnt lgkmcnt(3)
    v_mfma_f32_32x32x16_bf16 v[64:79], v[32:35], v[40:43], 0
    ds_read_b128 v[48:51], v3 offset:0
    ds_read_b64_tr_b16 v[56:57], v14 offset:4096
    ds_read_b64_tr_b16 v[58:59], v14 offset:5120
    s_waitcnt lgkmcnt(3)
    v_mfma_f32_32x32x16_bf16 v[96:111], v[36:39], v[40:43], 0
    ds_read_b128 v[52:55], v3 offset:4096
    ds_read_b64_tr_b16 v[60:61], v15 offset:4096
    ds_read_b64_tr_b16 v[62:63], v15 offset:5120
    v_mfma_f32_32x32x16_bf16 v[80:95], v[32:35], v[44:47], 0
    v_mfma_f32_32x32x16_bf16 v[112:127], v[36:39], v[44:47], 0
    s_waitcnt lgkmcnt(3)
    v_mfma_f32_32x32x16_bf16 v[64:79], v[48:51], v[56:59], v[64:79]
    ds_read_b128 v[32:35], v4 offset:0
    ds_read_b64_tr_b16 v[40:41], v14 offset:8192
    ds_read_b64_tr_b16 v[42:43], v14 offset:9216
    s_waitcnt lgkmcnt(3)
    v_mfma_f32_32x32x16_bf16 v[96:111], v[52:55], v[56:59], v[96:111]
    ds_read_b128 v[36:39], v4 offset:4096
    ds_read_b64_tr_b16 v[44:45], v15 offset:8192
    ds_read_b64_tr_b16 v[46:47], v15 offset:9216
    v_mfma_f32_32x32x16_bf16 v[80:95], v[48:51], v[60:63], v[80:95]
    v_mfma_f32_32x32x16_bf16 v[112:127], v[52:55], v[60:63], v[112:127]
    s_waitcnt lgkmcnt(3)
    v_mfma_f32_32x32x16_bf16 v[64:79], v[32:35], v[40:43], v[64:79]
    ds_read_b128 v[48:51], v5 offset:0
    ds_read_b64_tr_b16 v[56:57], v14 offset:12288
    ds_read_b64_tr_b16 v[58:59], v14 offset:13312
    s_waitcnt lgkmcnt(3)
    v_mfma_f32_32x32x16_bf16 v[96:111], v[36:39], v[40:43], v[96:111]
    ds_read_b128 v[52:55], v5 offset:4096
    ds_read_b64_tr_b16 v[60:61], v15 offset:12288
    ds_read_b64_tr_b16 v[62:63], v15 offset:13312
    v_mfma_f32_32x32x16_bf16 v[80:95], v[32:35], v[44:47], v[80:95]
    v_mfma_f32_32x32x16_bf16 v[112:127], v[36:39], v[44:47], v[112:127]
    s_waitcnt lgkmcnt(0)
    s_barrier
    v_mfma_f32_32x32x16_bf16 v[64:79], v[48:51], v[56:59], v[64:79]
    ds_read_b128 v[32:35], v2 offset:32768
    ds_read_b64_tr_b16 v[40:41], v14 offset:32768
    ds_read_b64_tr_b16 v[42:43], v14 offset:33792
    v_mfma_f32_32x32x16_bf16 v[96:111], v[52:55], v[56:59], v[96:111]
    ds_read_b128 v[36:39], v2 offset:36864
    ds_read_b64_tr_b16 v[44:45], v15 offset:32768
    ds_read_b64_tr_b16 v[46:47], v15 offset:33792
    v_mfma_f32_32x32x16_bf16 v[80:95], v[48:51], v[60:63], v[80:95]
    v_mfma_f32_32x32x16_bf16 v[112:127], v[52:55], v[60:63], v[112:127]
    s_waitcnt lgkmcnt(3)
    v_mfma_f32_32x32x16_bf16 v[64:79], v[32:35], v[40:43], v[64:79]
    ds_read_b128 v[48:51], v3 offset:32768
    ds_read_b64_tr_b16 v[56:57], v14 offset:36864
    ds_read_b64_tr_b16 v[58:59], v14 offset:37888
    s_waitcnt lgkmcnt(3)
    v_mfma_f32_32x32x16_bf16 v[96:111], v[36:39], v[40:43], v[96:111]
    ds_read_b128 v[52:55], v3 offset:36864
    ds_read_b64_tr_b16 v[60:61], v15 offset:36864
    ds_read_b64_tr_b16 v[62:63], v15 offset:37888
    v_mfma_f32_32x32x16_bf16 v[80:95], v[32:35], v[44:47], v[80:95]
    v_mfma_f32_32x32x16_bf16 v[112:127], v[36:39], v[44:47], v[112:127]
    s_waitcnt lgkmcnt(3)
    v_mfma_f32_32x32x16_bf16 v[64:79], v[48:51], v[56:59], v[64:79]
    ds_read_b128 v[32:35], v4 offset:32768
    ds_read_b64_tr_b16 v[40:41], v14 offset:40960
    ds_read_b64_tr_b16 v[42:43], v14 offset:41984
    s_waitcnt lgkmcnt(3)
    v_mfma_f32_32x32x16_bf16 v[96:111], v[52:55], v[56:59], v[96:111]
    ds_read_b128 v[36:39], v4 offset:36864
    ds_read_b64_tr_b16 v[44:45], v15 offset:40960
    ds_read_b64_tr_b16 v[46:47], v15 offset:41984
    v_mfma_f32_32x32x16_bf16 v[80:95], v[48:51], v[60:63], v[80:95]
    v_mfma_f32_32x32x16_bf16 v[112:127], v[52:55], v[60:63], v[112:127]
    s_waitcnt lgkmcnt(3)
    v_mfma_f32_32x32x16_bf16 v[64:79], v[32:35], v[40:43], v[64:79]
    ds_read_b128 v[48:51], v5 offset:32768
    ds_read_b64_tr_b16 v[56:57], v14 offset:45056
    ds_read_b64_tr_b16 v[58:59], v14 offset:46080
    s_waitcnt lgkmcnt(3)
    v_mfma_f32_32x32x16_bf16 v[96:111], v[36:39], v[40:43], v[96:111]
    ds_read_b128 v[52:55], v5 offset:36864
    ds_read_b64_tr_b16 v[60:61], v15 offset:45056
    ds_read_b64_tr_b16 v[62:63], v15 offset:46080
    v_mfma_f32_32x32x16_bf16 v[80:95], v[32:35], v[44:47], v[80:95]
    v_mfma_f32_32x32x16_bf16 v[112:127], v[36:39], v[44:47], v[112:127]
    s_waitcnt lgkmcnt(0)
    s_barrier
    v_mfma_f32_32x32x16_bf16 v[64:79], v[48:51], v[56:59], v[64:79]
    ds_read_b128 v[32:35], v6 offset:0
    ds_read_b64_tr_b16 v[40:41], v16 offset:0
    ds_read_b64_tr_b16 v[42:43], v16 offset:1024
    v_mfma_f32_32x32x16_bf16 v[96:111], v[52:55], v[56:59], v[96:111]
    ds_read_b128 v[36:39], v6 offset:4096
    ds_read_b64_tr_b16 v[44:45], v17 offset:0
    ds_read_b64_tr_b16 v[46:47], v17 offset:1024
    v_mfma_f32_32x32x16_bf16 v[80:95], v[48:51], v[60:63], v[80:95]
    v_mfma_f32_32x32x16_bf16 v[112:127], v[52:55], v[60:63], v[112:127]
    s_waitcnt lgkmcnt(3)
    v_mfma_f32_32x32x16_bf16 v[64:79], v[32:35], v[40:43], v[64:79]
    ds_read_b128 v[48:51], v7 offset:0
    ds_read_b64_tr_b16 v[56:57], v16 offset:4096
    ds_read_b64_tr_b16 v[58:59], v16 offset:5120
    s_waitcnt lgkmcnt(3)
    v_mfma_f32_32x32x16_bf16 v[96:111], v[36:39], v[40:43], v[96:111]
    ds_read_b128 v[52:55], v7 offset:4096
    ds_read_b64_tr_b16 v[60:61], v17 offset:4096
    ds_read_b64_tr_b16 v[62:63], v17 offset:5120
    v_mfma_f32_32x32x16_bf16 v[80:95], v[32:35], v[44:47], v[80:95]
    v_mfma_f32_32x32x16_bf16 v[112:127], v[36:39], v[44:47], v[112:127]
    s_waitcnt lgkmcnt(3)
    v_mfma_f32_32x32x16_bf16 v[64:79], v[48:51], v[56:59], v[64:79]
    ds_read_b128 v[32:35], v8 offset:0
    ds_read_b64_tr_b16 v[40:41], v16 offset:8192
    ds_read_b64_tr_b16 v[42:43], v16 offset:9216
    s_waitcnt lgkmcnt(3)
    v_mfma_f32_32x32x16_bf16 v[96:111], v[52:55], v[56:59], v[96:111]
    ds_read_b128 v[36:39], v8 offset:4096
    ds_read_b64_tr_b16 v[44:45], v17 offset:8192
    ds_read_b64_tr_b16 v[46:47], v17 offset:9216
    v_mfma_f32_32x32x16_bf16 v[80:95], v[48:51], v[60:63], v[80:95]
    v_mfma_f32_32x32x16_bf16 v[112:127], v[52:55], v[60:63], v[112:127]
    s_waitcnt lgkmcnt(3)
    v_mfma_f32_32x32x16_bf16 v[64:79], v[32:35], v[40:43], v[64:79]
    ds_read_b128 v[48:51], v9 offset:0
    ds_read_b64_tr_b16 v[56:57], v16 offset:12288
    ds_read_b64_tr_b16 v[58:59], v16 offset:13312
    s_waitcnt lgkmcnt(3)
    v_mfma_f32_32x32x16_bf16 v[96:111], v[36:39], v[40:43], v[96:111]
    ds_read_b128 v[52:55], v9 offset:4096
    ds_read_b64_tr_b16 v[60:61], v17 offset:12288
    ds_read_b64_tr_b16 v[62:63], v17 offset:13312
    v_mfma_f32_32x32x16_bf16 v[80:95], v[32:35], v[44:47], v[80:95]
    v_mfma_f32_32x32x16_bf16 v[112:127], v[36:39], v[44:47], v[112:127]
    s_waitcnt lgkmcnt(0)
    s_barrier
    v_mfma_f32_32x32x16_bf16 v[64:79], v[48:51], v[56:59], v[64:79]
    ds_read_b128 v[32:35], v6 offset:32768
    ds_read_b64_tr_b16 v[40:41], v16 offset:32768
    ds_read_b64_tr_b16 v[42:43], v16 offset:33792
    v_mfma_f32_32x32x16_bf16 v[96:111], v[52:55], v[56:59], v[96:111]
    ds_read_b128 v[36:39], v6 offset:36864
    ds_read_b64_tr_b16 v[44:45], v17 offset:32768
    ds_read_b64_tr_b16 v[46:47], v17 offset:33792
    v_mfma_f32_32x32x16_bf16 v[80:95], v[48:51], v[60:63], v[80:95]
    v_mfma_f32_32x32x16_bf16 v[112:127], v[52:55], v[60:63], v[112:127]
    s_waitcnt lgkmcnt(3)
    v_mfma_f32_32x32x16_bf16 v[64:79], v[32:35], v[40:43], v[64:79]
    ds_read_b128 v[48:51], v7 offset:32768
    ds_read_b64_tr_b16 v[56:57], v16 offset:36864
    ds_read_b64_tr_b16 v[58:59], v16 offset:37888
    s_waitcnt lgkmcnt(3)
    v_mfma_f32_32x32x16_bf16 v[96:111], v[36:39], v[40:43], v[96:111]
    ds_read_b128 v[52:55], v7 offset:36864
    ds_read_b64_tr_b16 v[60:61], v17 offset:36864
    ds_read_b64_tr_b16 v[62:63], v17 offset:37888
    v_mfma_f32_32x32x16_bf16 v[80:95], v[32:35], v[44:47], v[80:95]
    v_mfma_f32_32x32x16_bf16 v[112:127], v[36:39], v[44:47], v[112:127]
    s_waitcnt lgkmcnt(3)
    v_mfma_f32_32x32x16_bf16 v[64:79], v[48:51], v[56:59], v[64:79]
    ds_read_b128 v[32:35], v8 offset:32768
    ds_read_b64_tr_b16 v[40:41], v16 offset:40960
    ds_read_b64_tr_b16 v[42:43], v16 offset:41984
    s_waitcnt lgkmcnt(3)
    v_mfma_f32_32x32x16_bf16 v[96:111], v[52:55], v[56:59], v[96:111]
    ds_read_b128 v[36:39], v8 offset:36864
    ds_read_b64_tr_b16 v[44:45], v17 offset:40960
    ds_read_b64_tr_b16 v[46:47], v17 offset:41984
    v_mfma_f32_32x32x16_bf16 v[80:95], v[48:51], v[60:63], v[80:95]
    v_mfma_f32_32x32x16_bf16 v[112:127], v[52:55], v[60:63], v[112:127]
    s_waitcnt lgkmcnt(3)
    v_mfma_f32_32x32x16_bf16 v[64:79], v[32:35], v[40:43], v[64:79]
    ds_read_b128 v[48:51], v9 offset:32768
    ds_read_b64_tr_b16 v[56:57], v16 offset:45056
    ds_read_b64_tr_b16 v[58:59], v16 offset:46080
    s_waitcnt lgkmcnt(3)
    v_mfma_f32_32x32x16_bf16 v[96:111], v[36:39], v[40:43], v[96:111]
    ds_read_b128 v[52:55], v9 offset:36864
    ds_read_b64_tr_b16 v[60:61], v17 offset:45056
    ds_read_b64_tr_b16 v[62:63], v17 offset:46080
    v_mfma_f32_32x32x16_bf16 v[80:95], v[32:35], v[44:47], v[80:95]
    v_mfma_f32_32x32x16_bf16 v[112:127], v[36:39], v[44:47], v[112:127]
    s_waitcnt lgkmcnt(0)
    s_barrier
    v_mfma_f32_32x32x16_bf16 v[64:79], v[48:51], v[56:59], v[64:79]
    ds_read_b128 v[32:35], v2 offset:0
    ds_read_b64_tr_b16 v[40:41], v14 offset:0
    ds_read_b64_tr_b16 v[42:43], v14 offset:1024
    v_mfma_f32_32x32x16_bf16 v[96:111], v[52:55], v[56:59], v[96:111]
    ds_read_b128 v[36:39], v2 offset:4096
    ds_read_b64_tr_b16 v[44:45], v15 offset:0
    ds_read_b64_tr_b16 v[46:47], v15 offset:1024
    v_mfma_f32_32x32x16_bf16 v[80:95], v[48:51], v[60:63], v[80:95]
    v_mfma_f32_32x32x16_bf16 v[112:127], v[52:55], v[60:63], v[112:127]
    s_waitcnt lgkmcnt(3)
    v_mfma_f32_32x32x16_bf16 v[64:79], v[32:35], v[40:43], v[64:79]
    ds_read_b128 v[48:51], v3 offset:0
    ds_read_b64_tr_b16 v[56:57], v14 offset:4096
    ds_read_b64_tr_b16 v[58:59], v14 offset:5120
    s_waitcnt lgkmcnt(3)
    v_mfma_f32_32x32x16_bf16 v[96:111], v[36:39], v[40:43], v[96:111]
    ds_read_b128 v[52:55], v3 offset:4096
    ds_read_b64_tr_b16 v[60:61], v15 offset:4096
    ds_read_b64_tr_b16 v[62:63], v15 offset:5120
    v_mfma_f32_32x32x16_bf16 v[80:95], v[32:35], v[44:47], v[80:95]
    v_mfma_f32_32x32x16_bf16 v[112:127], v[36:39], v[44:47], v[112:127]
    s_waitcnt lgkmcnt(3)
    v_mfma_f32_32x32x16_bf16 v[64:79], v[48:51], v[56:59], v[64:79]
    ds_read_b128 v[32:35], v4 offset:0
    ds_read_b64_tr_b16 v[40:41], v14 offset:8192
    ds_read_b64_tr_b16 v[42:43], v14 offset:9216
    s_waitcnt lgkmcnt(3)
    v_mfma_f32_32x32x16_bf16 v[96:111], v[52:55], v[56:59], v[96:111]
    ds_read_b128 v[36:39], v4 offset:4096
    ds_read_b64_tr_b16 v[44:45], v15 offset:8192
    ds_read_b64_tr_b16 v[46:47], v15 offset:9216
    v_mfma_f32_32x32x16_bf16 v[80:95], v[48:51], v[60:63], v[80:95]
    v_mfma_f32_32x32x16_bf16 v[112:127], v[52:55], v[60:63], v[112:127]
    s_waitcnt lgkmcnt(3)
    v_mfma_f32_32x32x16_bf16 v[64:79], v[32:35], v[40:43], v[64:79]
    ds_read_b128 v[48:51], v5 offset:0
    ds_read_b64_tr_b16 v[56:57], v14 offset:12288
    ds_read_b64_tr_b16 v[58:59], v14 offset:13312
    s_waitcnt lgkmcnt(3)
    v_mfma_f32_32x32x16_bf16 v[96:111], v[36:39], v[40:43], v[96:111]
    ds_read_b128 v[52:55], v5 offset:4096
    ds_read_b64_tr_b16 v[60:61], v15 offset:12288
    ds_read_b64_tr_b16 v[62:63], v15 offset:13312
    v_mfma_f32_32x32x16_bf16 v[80:95], v[32:35], v[44:47], v[80:95]
    v_mfma_f32_32x32x16_bf16 v[112:127], v[36:39], v[44:47], v[112:127]
    s_waitcnt lgkmcnt(0)
    s_barrier
    v_mfma_f32_32x32x16_bf16 v[64:79], v[48:51], v[56:59], v[64:79]
    ds_read_b128 v[32:35], v2 offset:32768
    ds_read_b64_tr_b16 v[40:41], v14 offset:32768
    ds_read_b64_tr_b16 v[42:43], v14 offset:33792
    v_mfma_f32_32x32x16_bf16 v[96:111], v[52:55], v[56:59], v[96:111]
    ds_read_b128 v[36:39], v2 offset:36864
    ds_read_b64_tr_b16 v[44:45], v15 offset:32768
    ds_read_b64_tr_b16 v[46:47], v15 offset:33792
    v_mfma_f32_32x32x16_bf16 v[80:95], v[48:51], v[60:63], v[80:95]
    v_mfma_f32_32x32x16_bf16 v[112:127], v[52:55], v[60:63], v[112:127]
    s_waitcnt lgkmcnt(3)
    v_mfma_f32_32x32x16_bf16 v[64:79], v[32:35], v[40:43], v[64:79]
    ds_read_b128 v[48:51], v3 offset:32768
    ds_read_b64_tr_b16 v[56:57], v14 offset:36864
    ds_read_b64_tr_b16 v[58:59], v14 offset:37888
    s_waitcnt lgkmcnt(3)
    v_mfma_f32_32x32x16_bf16 v[96:111], v[36:39], v[40:43], v[96:111]
    ds_read_b128 v[52:55], v3 offset:36864
    ds_read_b64_tr_b16 v[60:61], v15 offset:36864
    ds_read_b64_tr_b16 v[62:63], v15 offset:37888
    v_mfma_f32_32x32x16_bf16 v[80:95], v[32:35], v[44:47], v[80:95]
    v_mfma_f32_32x32x16_bf16 v[112:127], v[36:39], v[44:47], v[112:127]
    s_waitcnt lgkmcnt(3)
    v_mfma_f32_32x32x16_bf16 v[64:79], v[48:51], v[56:59], v[64:79]
    ds_read_b128 v[32:35], v4 offset:32768
    ds_read_b64_tr_b16 v[40:41], v14 offset:40960
    ds_read_b64_tr_b16 v[42:43], v14 offset:41984
    s_waitcnt lgkmcnt(3)
    v_mfma_f32_32x32x16_bf16 v[96:111], v[52:55], v[56:59], v[96:111]
    ds_read_b128 v[36:39], v4 offset:36864
    ds_read_b64_tr_b16 v[44:45], v15 offset:40960
    ds_read_b64_tr_b16 v[46:47], v15 offset:41984
    v_mfma_f32_32x32x16_bf16 v[80:95], v[48:51], v[60:63], v[80:95]
    v_mfma_f32_32x32x16_bf16 v[112:127], v[52:55], v[60:63], v[112:127]
    s_waitcnt lgkmcnt(3)
    v_mfma_f32_32x32x16_bf16 v[64:79], v[32:35], v[40:43], v[64:79]
    ds_read_b128 v[48:51], v5 offset:32768
    ds_read_b64_tr_b16 v[56:57], v14 offset:45056
    ds_read_b64_tr_b16 v[58:59], v14 offset:46080
    s_waitcnt lgkmcnt(3)
    v_mfma_f32_32x32x16_bf16 v[96:111], v[36:39], v[40:43], v[96:111]
    ds_read_b128 v[52:55], v5 offset:36864
    ds_read_b64_tr_b16 v[60:61], v15 offset:45056
    ds_read_b64_tr_b16 v[62:63], v15 offset:46080
    v_mfma_f32_32x32x16_bf16 v[80:95], v[32:35], v[44:47], v[80:95]
    v_mfma_f32_32x32x16_bf16 v[112:127], v[36:39], v[44:47], v[112:127]
    s_waitcnt lgkmcnt(0)
    s_barrier
    v_mfma_f32_32x32x16_bf16 v[64:79], v[48:51], v[56:59], v[64:79]
    ds_read_b128 v[32:35], v6 offset:0
    ds_read_b64_tr_b16 v[40:41], v16 offset:0
    ds_read_b64_tr_b16 v[42:43], v16 offset:1024
    v_mfma_f32_32x32x16_bf16 v[96:111], v[52:55], v[56:59], v[96:111]
    ds_read_b128 v[36:39], v6 offset:4096
    ds_read_b64_tr_b16 v[44:45], v17 offset:0
    ds_read_b64_tr_b16 v[46:47], v17 offset:1024
    v_mfma_f32_32x32x16_bf16 v[80:95], v[48:51], v[60:63], v[80:95]
    v_mfma_f32_32x32x16_bf16 v[112:127], v[52:55], v[60:63], v[112:127]
    s_waitcnt lgkmcnt(3)
    v_mfma_f32_32x32x16_bf16 v[64:79], v[32:35], v[40:43], v[64:79]
    ds_read_b128 v[48:51], v7 offset:0
    ds_read_b64_tr_b16 v[56:57], v16 offset:4096
    ds_read_b64_tr_b16 v[58:59], v16 offset:5120
    s_waitcnt lgkmcnt(3)
    v_mfma_f32_32x32x16_bf16 v[96:111], v[36:39], v[40:43], v[96:111]
    ds_read_b128 v[52:55], v7 offset:4096
    ds_read_b64_tr_b16 v[60:61], v17 offset:4096
    ds_read_b64_tr_b16 v[62:63], v17 offset:5120
    v_mfma_f32_32x32x16_bf16 v[80:95], v[32:35], v[44:47], v[80:95]
    v_mfma_f32_32x32x16_bf16 v[112:127], v[36:39], v[44:47], v[112:127]
    s_waitcnt lgkmcnt(3)
    v_mfma_f32_32x32x16_bf16 v[64:79], v[48:51], v[56:59], v[64:79]
    ds_read_b128 v[32:35], v8 offset:0
    ds_read_b64_tr_b16 v[40:41], v16 offset:8192
    ds_read_b64_tr_b16 v[42:43], v16 offset:9216
    s_waitcnt lgkmcnt(3)
    v_mfma_f32_32x32x16_bf16 v[96:111], v[52:55], v[56:59], v[96:111]
    ds_read_b128 v[36:39], v8 offset:4096
    ds_read_b64_tr_b16 v[44:45], v17 offset:8192
    ds_read_b64_tr_b16 v[46:47], v17 offset:9216
    v_mfma_f32_32x32x16_bf16 v[80:95], v[48:51], v[60:63], v[80:95]
    v_mfma_f32_32x32x16_bf16 v[112:127], v[52:55], v[60:63], v[112:127]
    s_waitcnt lgkmcnt(3)
    v_mfma_f32_32x32x16_bf16 v[64:79], v[32:35], v[40:43], v[64:79]
    ds_read_b128 v[48:51], v9 offset:0
    ds_read_b64_tr_b16 v[56:57], v16 offset:12288
    ds_read_b64_tr_b16 v[58:59], v16 offset:13312
    s_waitcnt lgkmcnt(3)
    v_mfma_f32_32x32x16_bf16 v[96:111], v[36:39], v[40:43], v[96:111]
    ds_read_b128 v[52:55], v9 offset:4096
    ds_read_b64_tr_b16 v[60:61], v17 offset:12288
    ds_read_b64_tr_b16 v[62:63], v17 offset:13312
    v_mfma_f32_32x32x16_bf16 v[80:95], v[32:35], v[44:47], v[80:95]
    v_mfma_f32_32x32x16_bf16 v[112:127], v[36:39], v[44:47], v[112:127]
    s_waitcnt lgkmcnt(0)
    s_barrier
    v_mfma_f32_32x32x16_bf16 v[64:79], v[48:51], v[56:59], v[64:79]
    ds_read_b128 v[32:35], v6 offset:32768
    ds_read_b64_tr_b16 v[40:41], v16 offset:32768
    ds_read_b64_tr_b16 v[42:43], v16 offset:33792
    v_mfma_f32_32x32x16_bf16 v[96:111], v[52:55], v[56:59], v[96:111]
    ds_read_b128 v[36:39], v6 offset:36864
    ds_read_b64_tr_b16 v[44:45], v17 offset:32768
    ds_read_b64_tr_b16 v[46:47], v17 offset:33792
    v_mfma_f32_32x32x16_bf16 v[80:95], v[48:51], v[60:63], v[80:95]
    v_mfma_f32_32x32x16_bf16 v[112:127], v[52:55], v[60:63], v[112:127]
    s_waitcnt lgkmcnt(3)
    v_mfma_f32_32x32x16_bf16 v[64:79], v[32:35], v[40:43], v[64:79]
    ds_read_b128 v[48:51], v7 offset:32768
    ds_read_b64_tr_b16 v[56:57], v16 offset:36864
    ds_read_b64_tr_b16 v[58:59], v16 offset:37888
    s_waitcnt lgkmcnt(3)
    v_mfma_f32_32x32x16_bf16 v[96:111], v[36:39], v[40:43], v[96:111]
    ds_read_b128 v[52:55], v7 offset:36864
    ds_read_b64_tr_b16 v[60:61], v17 offset:36864
    ds_read_b64_tr_b16 v[62:63], v17 offset:37888
    v_mfma_f32_32x32x16_bf16 v[80:95], v[32:35], v[44:47], v[80:95]
    v_mfma_f32_32x32x16_bf16 v[112:127], v[36:39], v[44:47], v[112:127]
    s_waitcnt lgkmcnt(3)
    v_mfma_f32_32x32x16_bf16 v[64:79], v[48:51], v[56:59], v[64:79]
    ds_read_b128 v[32:35], v8 offset:32768
    ds_read_b64_tr_b16 v[40:41], v16 offset:40960
    ds_read_b64_tr_b16 v[42:43], v16 offset:41984
    s_waitcnt lgkmcnt(3)
    v_mfma_f32_32x32x16_bf16 v[96:111], v[52:55], v[56:59], v[96:111]
    ds_read_b128 v[36:39], v8 offset:36864
    ds_read_b64_tr_b16 v[44:45], v17 offset:40960
    ds_read_b64_tr_b16 v[46:47], v17 offset:41984
    v_mfma_f32_32x32x16_bf16 v[80:95], v[48:51], v[60:63], v[80:95]
    v_mfma_f32_32x32x16_bf16 v[112:127], v[52:55], v[60:63], v[112:127]
    s_waitcnt lgkmcnt(3)
    v_mfma_f32_32x32x16_bf16 v[64:79], v[32:35], v[40:43], v[64:79]
    ds_read_b128 v[48:51], v9 offset:32768
    ds_read_b64_tr_b16 v[56:57], v16 offset:45056
    ds_read_b64_tr_b16 v[58:59], v16 offset:46080
    s_waitcnt lgkmcnt(3)
    v_mfma_f32_32x32x16_bf16 v[96:111], v[36:39], v[40:43], v[96:111]
    ds_read_b128 v[52:55], v9 offset:36864
    ds_read_b64_tr_b16 v[60:61], v17 offset:45056
    ds_read_b64_tr_b16 v[62:63], v17 offset:46080
    v_mfma_f32_32x32x16_bf16 v[80:95], v[32:35], v[44:47], v[80:95]
    v_mfma_f32_32x32x16_bf16 v[112:127], v[36:39], v[44:47], v[112:127]
    s_waitcnt lgkmcnt(0)
    s_barrier
    v_mfma_f32_32x32x16_bf16 v[64:79], v[48:51], v[56:59], v[64:79]
    ds_read_b128 v[32:35], v2 offset:0
    ds_read_b64_tr_b16 v[40:41], v14 offset:0
    ds_read_b64_tr_b16 v[42:43], v14 offset:1024
    v_mfma_f32_32x32x16_bf16 v[96:111], v[52:55], v[56:59], v[96:111]
    ds_read_b128 v[36:39], v2 offset:4096
    ds_read_b64_tr_b16 v[44:45], v15 offset:0
    ds_read_b64_tr_b16 v[46:47], v15 offset:1024
    v_mfma_f32_32x32x16_bf16 v[80:95], v[48:51], v[60:63], v[80:95]
    v_mfma_f32_32x32x16_bf16 v[112:127], v[52:55], v[60:63], v[112:127]
    s_waitcnt lgkmcnt(3)
    v_mfma_f32_32x32x16_bf16 v[64:79], v[32:35], v[40:43], v[64:79]
    ds_read_b128 v[48:51], v3 offset:0
    ds_read_b64_tr_b16 v[56:57], v14 offset:4096
    ds_read_b64_tr_b16 v[58:59], v14 offset:5120
    s_waitcnt lgkmcnt(3)
    v_mfma_f32_32x32x16_bf16 v[96:111], v[36:39], v[40:43], v[96:111]
    ds_read_b128 v[52:55], v3 offset:4096
    ds_read_b64_tr_b16 v[60:61], v15 offset:4096
    ds_read_b64_tr_b16 v[62:63], v15 offset:5120
    v_mfma_f32_32x32x16_bf16 v[80:95], v[32:35], v[44:47], v[80:95]
    v_mfma_f32_32x32x16_bf16 v[112:127], v[36:39], v[44:47], v[112:127]
    s_waitcnt lgkmcnt(3)
    v_mfma_f32_32x32x16_bf16 v[64:79], v[48:51], v[56:59], v[64:79]
    ds_read_b128 v[32:35], v4 offset:0
    ds_read_b64_tr_b16 v[40:41], v14 offset:8192
    ds_read_b64_tr_b16 v[42:43], v14 offset:9216
    s_waitcnt lgkmcnt(3)
    v_mfma_f32_32x32x16_bf16 v[96:111], v[52:55], v[56:59], v[96:111]
    ds_read_b128 v[36:39], v4 offset:4096
    ds_read_b64_tr_b16 v[44:45], v15 offset:8192
    ds_read_b64_tr_b16 v[46:47], v15 offset:9216
    v_mfma_f32_32x32x16_bf16 v[80:95], v[48:51], v[60:63], v[80:95]
    v_mfma_f32_32x32x16_bf16 v[112:127], v[52:55], v[60:63], v[112:127]
    s_waitcnt lgkmcnt(3)
    v_mfma_f32_32x32x16_bf16 v[64:79], v[32:35], v[40:43], v[64:79]
    ds_read_b128 v[48:51], v5 offset:0
    ds_read_b64_tr_b16 v[56:57], v14 offset:12288
    ds_read_b64_tr_b16 v[58:59], v14 offset:13312
    s_waitcnt lgkmcnt(3)
    v_mfma_f32_32x32x16_bf16 v[96:111], v[36:39], v[40:43], v[96:111]
    ds_read_b128 v[52:55], v5 offset:4096
    ds_read_b64_tr_b16 v[60:61], v15 offset:12288
    ds_read_b64_tr_b16 v[62:63], v15 offset:13312
    v_mfma_f32_32x32x16_bf16 v[80:95], v[32:35], v[44:47], v[80:95]
    v_mfma_f32_32x32x16_bf16 v[112:127], v[36:39], v[44:47], v[112:127]
    s_waitcnt lgkmcnt(0)
    s_barrier
    v_mfma_f32_32x32x16_bf16 v[64:79], v[48:51], v[56:59], v[64:79]
    ds_read_b128 v[32:35], v2 offset:32768
    ds_read_b64_tr_b16 v[40:41], v14 offset:32768
    ds_read_b64_tr_b16 v[42:43], v14 offset:33792
    v_mfma_f32_32x32x16_bf16 v[96:111], v[52:55], v[56:59], v[96:111]
    ds_read_b128 v[36:39], v2 offset:36864
    ds_read_b64_tr_b16 v[44:45], v15 offset:32768
    ds_read_b64_tr_b16 v[46:47], v15 offset:33792
    v_mfma_f32_32x32x16_bf16 v[80:95], v[48:51], v[60:63], v[80:95]
    v_mfma_f32_32x32x16_bf16 v[112:127], v[52:55], v[60:63], v[112:127]
    s_waitcnt lgkmcnt(3)
    v_mfma_f32_32x32x16_bf16 v[64:79], v[32:35], v[40:43], v[64:79]
    ds_read_b128 v[48:51], v3 offset:32768
    ds_read_b64_tr_b16 v[56:57], v14 offset:36864
    ds_read_b64_tr_b16 v[58:59], v14 offset:37888
    s_waitcnt lgkmcnt(3)
    v_mfma_f32_32x32x16_bf16 v[96:111], v[36:39], v[40:43], v[96:111]
    ds_read_b128 v[52:55], v3 offset:36864
    ds_read_b64_tr_b16 v[60:61], v15 offset:36864
    ds_read_b64_tr_b16 v[62:63], v15 offset:37888
    v_mfma_f32_32x32x16_bf16 v[80:95], v[32:35], v[44:47], v[80:95]
    v_mfma_f32_32x32x16_bf16 v[112:127], v[36:39], v[44:47], v[112:127]
    s_waitcnt lgkmcnt(3)
    v_mfma_f32_32x32x16_bf16 v[64:79], v[48:51], v[56:59], v[64:79]
    ds_read_b128 v[32:35], v4 offset:32768
    ds_read_b64_tr_b16 v[40:41], v14 offset:40960
    ds_read_b64_tr_b16 v[42:43], v14 offset:41984
    s_waitcnt lgkmcnt(3)
    v_mfma_f32_32x32x16_bf16 v[96:111], v[52:55], v[56:59], v[96:111]
    ds_read_b128 v[36:39], v4 offset:36864
    ds_read_b64_tr_b16 v[44:45], v15 offset:40960
    ds_read_b64_tr_b16 v[46:47], v15 offset:41984
    v_mfma_f32_32x32x16_bf16 v[80:95], v[48:51], v[60:63], v[80:95]
    v_mfma_f32_32x32x16_bf16 v[112:127], v[52:55], v[60:63], v[112:127]
    s_waitcnt lgkmcnt(3)
    v_mfma_f32_32x32x16_bf16 v[64:79], v[32:35], v[40:43], v[64:79]
    ds_read_b128 v[48:51], v5 offset:32768
    ds_read_b64_tr_b16 v[56:57], v14 offset:45056
    ds_read_b64_tr_b16 v[58:59], v14 offset:46080
    s_waitcnt lgkmcnt(3)
    v_mfma_f32_32x32x16_bf16 v[96:111], v[36:39], v[40:43], v[96:111]
    ds_read_b128 v[52:55], v5 offset:36864
    ds_read_b64_tr_b16 v[60:61], v15 offset:45056
    ds_read_b64_tr_b16 v[62:63], v15 offset:46080
    v_mfma_f32_32x32x16_bf16 v[80:95], v[32:35], v[44:47], v[80:95]
    v_mfma_f32_32x32x16_bf16 v[112:127], v[36:39], v[44:47], v[112:127]
    s_waitcnt lgkmcnt(0)
    v_mfma_f32_32x32x16_bf16 v[64:79], v[48:51], v[56:59], v[64:79]
    v_mfma_f32_32x32x16_bf16 v[96:111], v[52:55], v[56:59], v[96:111]
    v_mfma_f32_32x32x16_bf16 v[80:95], v[48:51], v[60:63], v[80:95]
    v_mfma_f32_32x32x16_bf16 v[112:127], v[52:55], v[60:63], v[112:127]
    s_setprio 2
    s_mul_i32 s3, s40, 163840
    s_mul_i32 s14, s43, 81920
    s_add_u32 s3, s3, s14
    s_lshl_b32 s14, s41, 11
    s_add_u32 s3, s3, s14
    s_lshl_b32 s14, s44, 10
    s_add_u32 s3, s3, s14
    s_add_u32 s3, s3, 5222400
    v_mul_u32_u24 v5, 10240, v21
    v_lshl_add_u32 v5, v20, 4, v5
    v_add_u32 v2, s3, v5
    v_mul_u32_u24 v6, 0xffff, v244
    v_not_b32 v6, v6
    s_barrier
    s_lshl_b32 s3, s44, 8
    s_add_u32 s3, s3, 1024
    v_lshl_add_u32 v18, v20, 2, s3
    ds_read_b32 v4, v18
    ds_read_b32 v5, v18 offset:128
    s_lshl_b32 s3, s43, 8
    s_add_u32 s3, s3, 0
    v_lshl_add_u32 v19, v21, 4, s3
    ds_read_b128 v[128:131], v19 offset:0
    ds_read_b128 v[144:147], v19 offset:512
    ds_read_b128 v[132:135], v19 offset:32
    ds_read_b128 v[148:151], v19 offset:544
    ds_read_b128 v[136:139], v19 offset:64
    ds_read_b128 v[152:155], v19 offset:576
    ds_read_b128 v[140:143], v19 offset:96
    ds_read_b128 v[156:159], v19 offset:608
    ds_read_b128 v[160:163], v19 offset:128
    ds_read_b128 v[176:179], v19 offset:640
    ds_read_b128 v[164:167], v19 offset:160
    ds_read_b128 v[180:183], v19 offset:672
    ds_read_b128 v[168:171], v19 offset:192
    ds_read_b128 v[184:187], v19 offset:704
    ds_read_b128 v[172:175], v19 offset:224
    ds_read_b128 v[188:191], v19 offset:736
    s_waitcnt lgkmcnt(8)
    v_pk_fma_f32 v[64:65], v[4:5], v[128:129], v[64:65] op_sel:[0,0,0] op_sel_hi:[0,1,1] neg_lo:[1,0,0] neg_hi:[1,0,0]
    v_pk_fma_f32 v[66:67], v[4:5], v[130:131], v[66:67] op_sel:[0,0,0] op_sel_hi:[0,1,1] neg_lo:[1,0,0] neg_hi:[1,0,0]
    v_pk_fma_f32 v[68:69], v[4:5], v[132:133], v[68:69] op_sel:[0,0,0] op_sel_hi:[0,1,1] neg_lo:[1,0,0] neg_hi:[1,0,0]
    v_pk_fma_f32 v[70:71], v[4:5], v[134:135], v[70:71] op_sel:[0,0,0] op_sel_hi:[0,1,1] neg_lo:[1,0,0] neg_hi:[1,0,0]
    v_pk_fma_f32 v[72:73], v[4:5], v[136:137], v[72:73] op_sel:[0,0,0] op_sel_hi:[0,1,1] neg_lo:[1,0,0] neg_hi:[1,0,0]
    v_pk_fma_f32 v[74:75], v[4:5], v[138:139], v[74:75] op_sel:[0,0,0] op_sel_hi:[0,1,1] neg_lo:[1,0,0] neg_hi:[1,0,0]
    v_pk_fma_f32 v[76:77], v[4:5], v[140:141], v[76:77] op_sel:[0,0,0] op_sel_hi:[0,1,1] neg_lo:[1,0,0] neg_hi:[1,0,0]
    v_pk_fma_f32 v[78:79], v[4:5], v[142:143], v[78:79] op_sel:[0,0,0] op_sel_hi:[0,1,1] neg_lo:[1,0,0] neg_hi:[1,0,0]
    v_pk_mul_f32 v[64:65], v[144:145], v[64:65]
    v_pk_mul_f32 v[66:67], v[146:147], v[66:67]
    v_pk_mul_f32 v[68:69], v[148:149], v[68:69]
    v_pk_mul_f32 v[70:71], v[150:151], v[70:71]
    v_pk_mul_f32 v[72:73], v[152:153], v[72:73]
    v_pk_mul_f32 v[74:75], v[154:155], v[74:75]
    v_pk_mul_f32 v[76:77], v[156:157], v[76:77]
    v_pk_mul_f32 v[78:79], v[158:159], v[78:79]
    v_and_b32 v64, v64, v6
    v_and_b32 v72, v72, v6
    v_cvt_pk_bf16_f32 v64, v64, v65
    v_cvt_pk_bf16_f32 v65, v66, v67
    v_cvt_pk_bf16_f32 v66, v68, v69
    v_cvt_pk_bf16_f32 v67, v70, v71
    v_cvt_pk_bf16_f32 v68, v72, v73
    v_cvt_pk_bf16_f32 v69, v74, v75
    v_cvt_pk_bf16_f32 v70, v76, v77
    v_cvt_pk_bf16_f32 v71, v78, v79
    v_or_b32 v64, v244, v64
    s_mov_b32 s3, 0
    buffer_store_dwordx4 v[64:67], v2, s[24:27], s3 offen offset:0 sc1
    v_or_b32 v68, v244, v68
    s_mov_b32 s3, 20480
    buffer_store_dwordx4 v[68:71], v2, s[24:27], s3 offen offset:0 sc1
    v_pk_fma_f32 v[80:81], v[4:5], v[128:129], v[80:81] op_sel:[1,0,0] op_sel_hi:[1,1,1] neg_lo:[1,0,0] neg_hi:[1,0,0]
    v_pk_fma_f32 v[82:83], v[4:5], v[130:131], v[82:83] op_sel:[1,0,0] op_sel_hi:[1,1,1] neg_lo:[1,0,0] neg_hi:[1,0,0]
    v_pk_fma_f32 v[84:85], v[4:5], v[132:133], v[84:85] op_sel:[1,0,0] op_sel_hi:[1,1,1] neg_lo:[1,0,0] neg_hi:[1,0,0]
    v_pk_fma_f32 v[86:87], v[4:5], v[134:135], v[86:87] op_sel:[1,0,0] op_sel_hi:[1,1,1] neg_lo:[1,0,0] neg_hi:[1,0,0]
    v_pk_fma_f32 v[88:89], v[4:5], v[136:137], v[88:89] op_sel:[1,0,0] op_sel_hi:[1,1,1] neg_lo:[1,0,0] neg_hi:[1,0,0]
    v_pk_fma_f32 v[90:91], v[4:5], v[138:139], v[90:91] op_sel:[1,0,0] op_sel_hi:[1,1,1] neg_lo:[1,0,0] neg_hi:[1,0,0]
    v_pk_fma_f32 v[92:93], v[4:5], v[140:141], v[92:93] op_sel:[1,0,0] op_sel_hi:[1,1,1] neg_lo:[1,0,0] neg_hi:[1,0,0]
    v_pk_fma_f32 v[94:95], v[4:5], v[142:143], v[94:95] op_sel:[1,0,0] op_sel_hi:[1,1,1] neg_lo:[1,0,0] neg_hi:[1,0,0]
    v_pk_mul_f32 v[80:81], v[144:145], v[80:81]
    v_pk_mul_f32 v[82:83], v[146:147], v[82:83]
    v_pk_mul_f32 v[84:85], v[148:149], v[84:85]
    v_pk_mul_f32 v[86:87], v[150:151], v[86:87]
    v_pk_mul_f32 v[88:89], v[152:153], v[88:89]
    v_pk_mul_f32 v[90:91], v[154:155], v[90:91]
    v_pk_mul_f32 v[92:93], v[156:157], v[92:93]
    v_pk_mul_f32 v[94:95], v[158:159], v[94:95]
    v_and_b32 v80, v80, v6
    v_and_b32 v88, v88, v6
    v_cvt_pk_bf16_f32 v80, v80, v81
    v_cvt_pk_bf16_f32 v81, v82, v83
    v_cvt_pk_bf16_f32 v82, v84, v85
    v_cvt_pk_bf16_f32 v83, v86, v87
    v_cvt_pk_bf16_f32 v84, v88, v89
    v_cvt_pk_bf16_f32 v85, v90, v91
    v_cvt_pk_bf16_f32 v86, v92, v93
    v_cvt_pk_bf16_f32 v87, v94, v95
    v_or_b32 v80, v244, v80
    s_mov_b32 s3, 0
    buffer_store_dwordx4 v[80:83], v2, s[24:27], s3 offen offset:512 sc1
    v_or_b32 v84, v244, v84
    s_mov_b32 s3, 20480
    buffer_store_dwordx4 v[84:87], v2, s[24:27], s3 offen offset:512 sc1
    s_waitcnt lgkmcnt(0)
    v_pk_fma_f32 v[96:97], v[4:5], v[160:161], v[96:97] op_sel:[0,0,0] op_sel_hi:[0,1,1] neg_lo:[1,0,0] neg_hi:[1,0,0]
    v_pk_fma_f32 v[98:99], v[4:5], v[162:163], v[98:99] op_sel:[0,0,0] op_sel_hi:[0,1,1] neg_lo:[1,0,0] neg_hi:[1,0,0]
    v_pk_fma_f32 v[100:101], v[4:5], v[164:165], v[100:101] op_sel:[0,0,0] op_sel_hi:[0,1,1] neg_lo:[1,0,0] neg_hi:[1,0,0]
    v_pk_fma_f32 v[102:103], v[4:5], v[166:167], v[102:103] op_sel:[0,0,0] op_sel_hi:[0,1,1] neg_lo:[1,0,0] neg_hi:[1,0,0]
    v_pk_fma_f32 v[104:105], v[4:5], v[168:169], v[104:105] op_sel:[0,0,0] op_sel_hi:[0,1,1] neg_lo:[1,0,0] neg_hi:[1,0,0]
    v_pk_fma_f32 v[106:107], v[4:5], v[170:171], v[106:107] op_sel:[0,0,0] op_sel_hi:[0,1,1] neg_lo:[1,0,0] neg_hi:[1,0,0]
    v_pk_fma_f32 v[108:109], v[4:5], v[172:173], v[108:109] op_sel:[0,0,0] op_sel_hi:[0,1,1] neg_lo:[1,0,0] neg_hi:[1,0,0]
    v_pk_fma_f32 v[110:111], v[4:5], v[174:175], v[110:111] op_sel:[0,0,0] op_sel_hi:[0,1,1] neg_lo:[1,0,0] neg_hi:[1,0,0]
    v_pk_mul_f32 v[96:97], v[176:177], v[96:97]
    v_pk_mul_f32 v[98:99], v[178:179], v[98:99]
    v_pk_mul_f32 v[100:101], v[180:181], v[100:101]
    v_pk_mul_f32 v[102:103], v[182:183], v[102:103]
    v_pk_mul_f32 v[104:105], v[184:185], v[104:105]
    v_pk_mul_f32 v[106:107], v[186:187], v[106:107]
    v_pk_mul_f32 v[108:109], v[188:189], v[108:109]
    v_pk_mul_f32 v[110:111], v[190:191], v[110:111]
    v_and_b32 v96, v96, v6
    v_and_b32 v104, v104, v6
    v_cvt_pk_bf16_f32 v96, v96, v97
    v_cvt_pk_bf16_f32 v97, v98, v99
    v_cvt_pk_bf16_f32 v98, v100, v101
    v_cvt_pk_bf16_f32 v99, v102, v103
    v_cvt_pk_bf16_f32 v100, v104, v105
    v_cvt_pk_bf16_f32 v101, v106, v107
    v_cvt_pk_bf16_f32 v102, v108, v109
    v_cvt_pk_bf16_f32 v103, v110, v111
    v_or_b32 v96, v244, v96
    s_mov_b32 s3, 40960
    buffer_store_dwordx4 v[96:99], v2, s[24:27], s3 offen offset:0 sc1
    v_or_b32 v100, v244, v100
    s_mov_b32 s3, 61440
    buffer_store_dwordx4 v[100:103], v2, s[24:27], s3 offen offset:0 sc1
    v_pk_fma_f32 v[112:113], v[4:5], v[160:161], v[112:113] op_sel:[1,0,0] op_sel_hi:[1,1,1] neg_lo:[1,0,0] neg_hi:[1,0,0]
    v_pk_fma_f32 v[114:115], v[4:5], v[162:163], v[114:115] op_sel:[1,0,0] op_sel_hi:[1,1,1] neg_lo:[1,0,0] neg_hi:[1,0,0]
    v_pk_fma_f32 v[116:117], v[4:5], v[164:165], v[116:117] op_sel:[1,0,0] op_sel_hi:[1,1,1] neg_lo:[1,0,0] neg_hi:[1,0,0]
    v_pk_fma_f32 v[118:119], v[4:5], v[166:167], v[118:119] op_sel:[1,0,0] op_sel_hi:[1,1,1] neg_lo:[1,0,0] neg_hi:[1,0,0]
    v_pk_fma_f32 v[120:121], v[4:5], v[168:169], v[120:121] op_sel:[1,0,0] op_sel_hi:[1,1,1] neg_lo:[1,0,0] neg_hi:[1,0,0]
    v_pk_fma_f32 v[122:123], v[4:5], v[170:171], v[122:123] op_sel:[1,0,0] op_sel_hi:[1,1,1] neg_lo:[1,0,0] neg_hi:[1,0,0]
    v_pk_fma_f32 v[124:125], v[4:5], v[172:173], v[124:125] op_sel:[1,0,0] op_sel_hi:[1,1,1] neg_lo:[1,0,0] neg_hi:[1,0,0]
    v_pk_fma_f32 v[126:127], v[4:5], v[174:175], v[126:127] op_sel:[1,0,0] op_sel_hi:[1,1,1] neg_lo:[1,0,0] neg_hi:[1,0,0]
    v_pk_mul_f32 v[112:113], v[176:177], v[112:113]
    v_pk_mul_f32 v[114:115], v[178:179], v[114:115]
    v_pk_mul_f32 v[116:117], v[180:181], v[116:117]
    v_pk_mul_f32 v[118:119], v[182:183], v[118:119]
    v_pk_mul_f32 v[120:121], v[184:185], v[120:121]
    v_pk_mul_f32 v[122:123], v[186:187], v[122:123]
    v_pk_mul_f32 v[124:125], v[188:189], v[124:125]
    v_pk_mul_f32 v[126:127], v[190:191], v[126:127]
    v_and_b32 v112, v112, v6
    v_and_b32 v120, v120, v6
    v_cvt_pk_bf16_f32 v112, v112, v113
    v_cvt_pk_bf16_f32 v113, v114, v115
    v_cvt_pk_bf16_f32 v114, v116, v117
    v_cvt_pk_bf16_f32 v115, v118, v119
    v_cvt_pk_bf16_f32 v116, v120, v121
    v_cvt_pk_bf16_f32 v117, v122, v123
    v_cvt_pk_bf16_f32 v118, v124, v125
    v_cvt_pk_bf16_f32 v119, v126, v127
    v_or_b32 v112, v244, v112
    s_mov_b32 s3, 40960
    buffer_store_dwordx4 v[112:115], v2, s[24:27], s3 offen offset:512 sc1
    v_or_b32 v116, v244, v116
    s_mov_b32 s3, 61440
    buffer_store_dwordx4 v[116:119], v2, s[24:27], s3 offen offset:512 sc1
    s_branch L1_done
L1_spare:
    s_lshl_b32 s3, s40, 3
    s_add_u32 s3, s3, s42
    s_lshl_b32 s15, s3, 4
    v_lshrrev_b32 v2, 2, v0
    v_add_u32 v3, s15, v2
    v_mul_u32_u24 v3, 1280, v3
    v_and_b32 v4, 3, v0
    v_lshl_add_u32 v3, v4, 4, v3
    s_waitcnt lgkmcnt(0)
    s_mov_b32 s16, s4
    s_mov_b32 s17, s5
    s_mov_b32 s18, 2621440
    s_mov_b32 s19, 0x00020000
    s_mov_b32 s24, s38
    s_mov_b32 s25, s39
    s_mov_b32 s26, 18890752
    s_mov_b32 s27, 0x00020000
    buffer_load_dwordx4 v[32:35], v3, s[16:19], 0 offen offset:0
    buffer_load_dwordx4 v[36:39], v3, s[16:19], 0 offen offset:64
    buffer_load_dwordx4 v[40:43], v3, s[16:19], 0 offen offset:128
    buffer_load_dwordx4 v[44:47], v3, s[16:19], 0 offen offset:192
    buffer_load_dwordx4 v[48:51], v3, s[16:19], 0 offen offset:256
    buffer_load_dwordx4 v[52:55], v3, s[16:19], 0 offen offset:320
    buffer_load_dwordx4 v[56:59], v3, s[16:19], 0 offen offset:384
    buffer_load_dwordx4 v[60:63], v3, s[16:19], 0 offen offset:448
    buffer_load_dwordx4 v[64:67], v3, s[16:19], 0 offen offset:512
    buffer_load_dwordx4 v[68:71], v3, s[16:19], 0 offen offset:576
    buffer_load_dwordx4 v[72:75], v3, s[16:19], 0 offen offset:640
    buffer_load_dwordx4 v[76:79], v3, s[16:19], 0 offen offset:704
    buffer_load_dwordx4 v[80:83], v3, s[16:19], 0 offen offset:768
    buffer_load_dwordx4 v[84:87], v3, s[16:19], 0 offen offset:832
    buffer_load_dwordx4 v[88:91], v3, s[16:19], 0 offen offset:896
    buffer_load_dwordx4 v[92:95], v3, s[16:19], 0 offen offset:960
    buffer_load_dwordx4 v[96:99], v3, s[16:19], 0 offen offset:1024
    buffer_load_dwordx4 v[100:103], v3, s[16:19], 0 offen offset:1088
    buffer_load_dwordx4 v[104:107], v3, s[16:19], 0 offen offset:1152
    buffer_load_dwordx4 v[108:111], v3, s[16:19], 0 offen offset:1216
    s_mov_b32 s46, 0x3f803f80
    v_mov_b32 v6, 0
    v_mov_b32 v7, 0
    s_lshl_b32 s15, s15, 3
    s_add_u32 s15, s15, 18759680
    v_lshl_add_u32 v5, v2, 3, s15
    s_waitcnt vmcnt(19)
    v_dot2_f32_bf16 v6, v32, s46, v6
    v_dot2_f32_bf16 v7, v32, v32, v7
    v_dot2_f32_bf16 v6, v33, s46, v6
    v_dot2_f32_bf16 v7, v33, v33, v7
    v_dot2_f32_bf16 v6, v34, s46, v6
    v_dot2_f32_bf16 v7, v34, v34, v7
    v_dot2_f32_bf16 v6, v35, s46, v6
    v_dot2_f32_bf16 v7, v35, v35, v7
    s_waitcnt vmcnt(18)
    v_dot2_f32_bf16 v6, v36, s46, v6
    v_dot2_f32_bf16 v7, v36, v36, v7
    v_dot2_f32_bf16 v6, v37, s46, v6
    v_dot2_f32_bf16 v7, v37, v37, v7
    v_dot2_f32_bf16 v6, v38, s46, v6
    v_dot2_f32_bf16 v7, v38, v38, v7
    v_dot2_f32_bf16 v6, v39, s46, v6
    v_dot2_f32_bf16 v7, v39, v39, v7
    s_waitcnt vmcnt(17)
    v_dot2_f32_bf16 v6, v40, s46, v6
    v_dot2_f32_bf16 v7, v40, v40, v7
    v_dot2_f32_bf16 v6, v41, s46, v6
    v_dot2_f32_bf16 v7, v41, v41, v7
    v_dot2_f32_bf16 v6, v42, s46, v6
    v_dot2_f32_bf16 v7, v42, v42, v7
    v_dot2_f32_bf16 v6, v43, s46, v6
    v_dot2_f32_bf16 v7, v43, v43, v7
    s_waitcnt vmcnt(16)
    v_dot2_f32_bf16 v6, v44, s46, v6
    v_dot2_f32_bf16 v7, v44, v44, v7
    v_dot2_f32_bf16 v6, v45, s46, v6
    v_dot2_f32_bf16 v7, v45, v45, v7
    v_dot2_f32_bf16 v6, v46, s46, v6
    v_dot2_f32_bf16 v7, v46, v46, v7
    v_dot2_f32_bf16 v6, v47, s46, v6
    v_dot2_f32_bf16 v7, v47, v47, v7
    s_waitcnt vmcnt(15)
    v_dot2_f32_bf16 v6, v48, s46, v6
    v_dot2_f32_bf16 v7, v48, v48, v7
    v_dot2_f32_bf16 v6, v49, s46, v6
    v_dot2_f32_bf16 v7, v49, v49, v7
    v_dot2_f32_bf16 v6, v50, s46, v6
    v_dot2_f32_bf16 v7, v50, v50, v7
    v_dot2_f32_bf16 v6, v51, s46, v6
    v_dot2_f32_bf16 v7, v51, v51, v7
    s_waitcnt vmcnt(14)
    v_dot2_f32_bf16 v6, v52, s46, v6
    v_dot2_f32_bf16 v7, v52, v52, v7
    v_dot2_f32_bf16 v6, v53, s46, v6
    v_dot2_f32_bf16 v7, v53, v53, v7
    v_dot2_f32_bf16 v6, v54, s46, v6
    v_dot2_f32_bf16 v7, v54, v54, v7
    v_dot2_f32_bf16 v6, v55, s46, v6
    v_dot2_f32_bf16 v7, v55, v55, v7
    s_waitcnt vmcnt(13)
    v_dot2_f32_bf16 v6, v56, s46, v6
    v_dot2_f32_bf16 v7, v56, v56, v7
    v_dot2_f32_bf16 v6, v57, s46, v6
    v_dot2_f32_bf16 v7, v57, v57, v7
    v_dot2_f32_bf16 v6, v58, s46, v6
    v_dot2_f32_bf16 v7, v58, v58, v7
    v_dot2_f32_bf16 v6, v59, s46, v6
    v_dot2_f32_bf16 v7, v59, v59, v7
    s_waitcnt vmcnt(12)
    v_dot2_f32_bf16 v6, v60, s46, v6
    v_dot2_f32_bf16 v7, v60, v60, v7
    v_dot2_f32_bf16 v6, v61, s46, v6
    v_dot2_f32_bf16 v7, v61, v61, v7
    v_dot2_f32_bf16 v6, v62, s46, v6
    v_dot2_f32_bf16 v7, v62, v62, v7
    v_dot2_f32_bf16 v6, v63, s46, v6
    v_dot2_f32_bf16 v7, v63, v63, v7
    s_waitcnt vmcnt(11)
    v_dot2_f32_bf16 v6, v64, s46, v6
    v_dot2_f32_bf16 v7, v64, v64, v7
    v_dot2_f32_bf16 v6, v65, s46, v6
    v_dot2_f32_bf16 v7, v65, v65, v7
    v_dot2_f32_bf16 v6, v66, s46, v6
    v_dot2_f32_bf16 v7, v66, v66, v7
    v_dot2_f32_bf16 v6, v67, s46, v6
    v_dot2_f32_bf16 v7, v67, v67, v7
    s_waitcnt vmcnt(10)
    v_dot2_f32_bf16 v6, v68, s46, v6
    v_dot2_f32_bf16 v7, v68, v68, v7
    v_dot2_f32_bf16 v6, v69, s46, v6
    v_dot2_f32_bf16 v7, v69, v69, v7
    v_dot2_f32_bf16 v6, v70, s46, v6
    v_dot2_f32_bf16 v7, v70, v70, v7
    v_dot2_f32_bf16 v6, v71, s46, v6
    v_dot2_f32_bf16 v7, v71, v71, v7
    s_waitcnt vmcnt(9)
    v_dot2_f32_bf16 v6, v72, s46, v6
    v_dot2_f32_bf16 v7, v72, v72, v7
    v_dot2_f32_bf16 v6, v73, s46, v6
    v_dot2_f32_bf16 v7, v73, v73, v7
    v_dot2_f32_bf16 v6, v74, s46, v6
    v_dot2_f32_bf16 v7, v74, v74, v7
    v_dot2_f32_bf16 v6, v75, s46, v6
    v_dot2_f32_bf16 v7, v75, v75, v7
    s_waitcnt vmcnt(8)
    v_dot2_f32_bf16 v6, v76, s46, v6
    v_dot2_f32_bf16 v7, v76, v76, v7
    v_dot2_f32_bf16 v6, v77, s46, v6
    v_dot2_f32_bf16 v7, v77, v77, v7
    v_dot2_f32_bf16 v6, v78, s46, v6
    v_dot2_f32_bf16 v7, v78, v78, v7
    v_dot2_f32_bf16 v6, v79, s46, v6
    v_dot2_f32_bf16 v7, v79, v79, v7
    s_waitcnt vmcnt(7)
    v_dot2_f32_bf16 v6, v80, s46, v6
    v_dot2_f32_bf16 v7, v80, v80, v7
    v_dot2_f32_bf16 v6, v81, s46, v6
    v_dot2_f32_bf16 v7, v81, v81, v7
    v_dot2_f32_bf16 v6, v82, s46, v6
    v_dot2_f32_bf16 v7, v82, v82, v7
    v_dot2_f32_bf16 v6, v83, s46, v6
    v_dot2_f32_bf16 v7, v83, v83, v7
    s_waitcnt vmcnt(6)
    v_dot2_f32_bf16 v6, v84, s46, v6
    v_dot2_f32_bf16 v7, v84, v84, v7
    v_dot2_f32_bf16 v6, v85, s46, v6
    v_dot2_f32_bf16 v7, v85, v85, v7
    v_dot2_f32_bf16 v6, v86, s46, v6
    v_dot2_f32_bf16 v7, v86, v86, v7
    v_dot2_f32_bf16 v6, v87, s46, v6
    v_dot2_f32_bf16 v7, v87, v87, v7
    s_waitcnt vmcnt(5)
    v_dot2_f32_bf16 v6, v88, s46, v6
    v_dot2_f32_bf16 v7, v88, v88, v7
    v_dot2_f32_bf16 v6, v89, s46, v6
    v_dot2_f32_bf16 v7, v89, v89, v7
    v_dot2_f32_bf16 v6, v90, s46, v6
    v_dot2_f32_bf16 v7, v90, v90, v7
    v_dot2_f32_bf16 v6, v91, s46, v6
    v_dot2_f32_bf16 v7, v91, v91, v7
    s_waitcnt vmcnt(4)
    v_dot2_f32_bf16 v6, v92, s46, v6
    v_dot2_f32_bf16 v7, v92, v92, v7
    v_dot2_f32_bf16 v6, v93, s46, v6
    v_dot2_f32_bf16 v7, v93, v93, v7
    v_dot2_f32_bf16 v6, v94, s46, v6
    v_dot2_f32_bf16 v7, v94, v94, v7
    v_dot2_f32_bf16 v6, v95, s46, v6
    v_dot2_f32_bf16 v7, v95, v95, v7
    s_waitcnt vmcnt(3)
    v_dot2_f32_bf16 v6, v96, s46, v6
    v_dot2_f32_bf16 v7, v96, v96, v7
    v_dot2_f32_bf16 v6, v97, s46, v6
    v_dot2_f32_bf16 v7, v97, v97, v7
    v_dot2_f32_bf16 v6, v98, s46, v6
    v_dot2_f32_bf16 v7, v98, v98, v7
    v_dot2_f32_bf16 v6, v99, s46, v6
    v_dot2_f32_bf16 v7, v99, v99, v7
    s_waitcnt vmcnt(2)
    v_dot2_f32_bf16 v6, v100, s46, v6
    v_dot2_f32_bf16 v7, v100, v100, v7
    v_dot2_f32_bf16 v6, v101, s46, v6
    v_dot2_f32_bf16 v7, v101, v101, v7
    v_dot2_f32_bf16 v6, v102, s46, v6
    v_dot2_f32_bf16 v7, v102, v102, v7
    v_dot2_f32_bf16 v6, v103, s46, v6
    v_dot2_f32_bf16 v7, v103, v103, v7
    s_waitcnt vmcnt(1)
    v_dot2_f32_bf16 v6, v104, s46, v6
    v_dot2_f32_bf16 v7, v104, v104, v7
    v_dot2_f32_bf16 v6, v105, s46, v6
    v_dot2_f32_bf16 v7, v105, v105, v7
    v_dot2_f32_bf16 v6, v106, s46, v6
    v_dot2_f32_bf16 v7, v106, v106, v7
    v_dot2_f32_bf16 v6, v107, s46, v6
    v_dot2_f32_bf16 v7, v107, v107, v7
    s_waitcnt vmcnt(0)
    v_dot2_f32_bf16 v6, v108, s46, v6
    v_dot2_f32_bf16 v7, v108, v108, v7
    v_dot2_f32_bf16 v6, v109, s46, v6
    v_dot2_f32_bf16 v7, v109, v109, v7
    v_dot2_f32_bf16 v6, v110, s46, v6
    v_dot2_f32_bf16 v7, v110, v110, v7
    v_dot2_f32_bf16 v6, v111, s46, v6
    v_dot2_f32_bf16 v7, v111, v111, v7
    s_nop 2
    v_add_f32_dpp v6, v6, v6 quad_perm:[1,0,3,2] row_mask:0xf bank_mask:0xf
    v_add_f32_dpp v7, v7, v7 quad_perm:[1,0,3,2] row_mask:0xf bank_mask:0xf
    s_nop 0
    v_add_f32_dpp v6, v6, v6 quad_perm:[2,3,0,1] row_mask:0xf bank_mask:0xf
    v_add_f32_dpp v7, v7, v7 quad_perm:[2,3,0,1] row_mask:0xf bank_mask:0xf
    s_nop 0
    v_mul_f32 v6, 0x3acccccd, v6
    v_mul_f32 v7, 0x3acccccd, v7
    v_fma_f32 v7, -v6, v6, v7
    v_max_f32 v7, 0, v7
    v_add_f32 v7, 0x3727c5ac, v7
    v_rsq_f32 v7, v7
    s_mov_b32 exec_lo, 0x11111111
    s_mov_b32 exec_hi, 0x11111111
    buffer_store_dwordx2 v[6:7], v5, s[24:27], 0 offen sc1
    s_mov_b64 exec, -1
    s_waitcnt vmcnt(0)
    s_barrier
    s_lshl_b32 s3, s40, 3
    s_add_u32 s3, s3, s42
    s_cmp_lg_u32 s3, 1
    s_cbranch_scc1 L1_nozero
    s_mov_b32 s3, 18776064
    v_lshl_add_u32 v131, v0, 8, s3
    v_mov_b32 v132, 0
    s_mov_b32 s3, 0
    buffer_store_dword v132, v131, s[24:27], s3 offen sc1
    s_mov_b32 s3, 16384
    buffer_store_dword v132, v131, s[24:27], s3 offen sc1
    s_mov_b32 s3, 32768
    buffer_store_dword v132, v131, s[24:27], s3 offen sc1
    s_mov_b32 s3, 49152
    buffer_store_dword v132, v131, s[24:27], s3 offen sc1
    s_mov_b32 s3, 65536
    buffer_store_dword v132, v131, s[24:27], s3 offen sc1
    s_mov_b32 s3, 81920
    buffer_store_dword v132, v131, s[24:27], s3 offen sc1
    s_mov_b32 s3, 98304
    buffer_store_dword v132, v131, s[24:27], s3 offen sc1
    s_waitcnt vmcnt(0)
    v_mov_b32 v133, 1
    s_mov_b64 exec, 1
    global_store_dword v132, v133, s[36:37] sc1
    s_mov_b64 exec, -1
L1_nozero:
    s_cmp_lg_u32 s42, 0
    s_cbranch_scc1 L1_done
    s_lshl_b32 s3, s40, 2
    s_add_u32 s3, s3, 4
    v_mov_b32 v8, s3
    v_mov_b32 v9, 1
    s_mov_b64 exec, 1
    global_store_dword v8, v9, s[36:37] sc1
    s_mov_b64 exec, -1
L1_done:
    v_mov_b32 v200, 0
    s_cmp_lg_u32 s42, 2
    s_cbranch_scc1 L1_s1b
    global_load_dword v201, v200, s[36:37] sc1
L1_s1b:
    s_lshl_b32 s3, s40, 4
    s_add_u32 s3, s3, s41
    s_lshl_b32 s3, s3, 8
    s_add_u32 s3, s3, 18776064
    v_mov_b32 v233, s3
    s_and_b32 s3, s2, 7
    s_lshl_b32 s3, s3, 2
    s_bfe_u32 s14, s2, 0x20003
    s_add_u32 s40, s3, s14
    s_lshr_b32 s41, s2, 5
    s_mov_b32 s45, 0
    s_mov_b32 s48, 0x000fffff
    s_mov_b32 s49, 0x000fffff
    s_and_b32 s43, s42, 3
    s_lshr_b32 s44, s42, 2
    s_and_b32 s53, s40, 1
    s_mov_b32 s56, s40
    s_mov_b32 s57, s41
    v_lshlrev_b32 v2, 4, v0
    v_and_b32 v52, 31, v0
    v_lshrrev_b32 v53, 5, v0
    s_mul_i32 s50, s44, 45056
    s_mul_i32 s51, s43, 3072
    s_add_u32 s51, s51, s50
    s_lshr_b32 s96, s40, 1
    s_mul_i32 s96, s96, 10240
    s_cmp_ge_u32 s43, 2
    s_cbranch_scc1 L2_vdma
    s_lshl_b32 s3, s53, 12
    s_add_u32 s3, s3, s96
    s_mul_i32 s14, s43, 3072
    s_add_u32 s3, s3, s14
    s_add_u32 s3, s3, 2621440
    v_add_u32 v160, s3, v2
    v_add_u32 v161, 1024, v160
    v_add_u32 v162, 2048, v160
    s_mov_b32 s97, 2048
    s_branch L2_dmago
L2_vdma:
    s_sub_u32 s3, s43, 2
    s_mul_i32 s3, s3, 192
    s_mul_i32 s14, s40, 320
    s_add_u32 s14, s14, 5242880
    s_cmp_eq_u32 s43, 3
    s_mov_b32 s97, 2048
    s_cmov_b32 s97, 1024
    s_cselect_b32 s15, 64, 128
    v_add_u32 v54, 0, v0
    v_add_u32 v54, s3, v54
    v_mul_u32_u24 v55, 3277, v54
    v_lshrrev_b32 v55, 16, v55
    v_mul_u32_u24 v56, 20, v55
    v_sub_u32 v54, v54, v56
    v_mul_u32_u24 v55, 10240, v55
    v_lshl_add_u32 v55, v54, 4, v55
    v_add_u32 v160, s14, v55
    v_add_u32 v54, 64, v0
    v_add_u32 v54, s3, v54
    v_mul_u32_u24 v55, 3277, v54
    v_lshrrev_b32 v55, 16, v55
    v_mul_u32_u24 v56, 20, v55
    v_sub_u32 v54, v54, v56
    v_mul_u32_u24 v55, 10240, v55
    v_lshl_add_u32 v55, v54, 4, v55
    v_add_u32 v161, s14, v55
    v_add_u32 v54, s15, v0
    v_add_u32 v54, s3, v54
    v_mul_u32_u24 v55, 3277, v54
    v_lshrrev_b32 v55, 16, v55
    v_mul_u32_u24 v56, 20, v55
    v_sub_u32 v54, v54, v56
    v_mul_u32_u24 v55, 10240, v55
    v_lshl_add_u32 v55, v54, 4, v55
    v_add_u32 v162, s14, v55
L2_dmago:
    s_lshl_b32 s3, s41, 1
    s_lshr_b32 s14, s43, 1
    s_add_u32 s3, s3, s14
    s_mul_i32 s3, s3, 163840
    s_add_u32 s3, s3, s96
    s_and_b32 s14, s43, 1
    s_lshl_b32 s14, s14, 10
    s_add_u32 s3, s3, s14
    s_lshl_b32 s14, s44, 9
    s_add_u32 s98, s3, s14
    s_sub_u32 s99, s3, s14
    s_add_u32 s99, s99, 512
    s_mul_i32 s3, s53, 6144
    v_lshlrev_b32 v54, 4, v52
    v_lshl_add_u32 v55, v53, 11, v54
    v_add_u32 v55, s3, v55
    s_lshl_b32 s3, s53, 3
    s_add_u32 s3, s3, 4096
    v_add_u32 v54, s3, v54
    s_sub_u32 s3, s99, s98
    v_mul_lo_u32 v20, v53, s3
    v_add_u32 v20, v20, v54
    v_mov_b32 v7, 0xdddddddd
    s_mul_i32 s3, s2, 7
    s_add_u32 s3, s3, s42
    s_sub_u32 s3, s3, 1
    s_cmp_eq_u32 s42, 0
    s_cmov_b32 s3, 1790
    s_mov_b32 s52, 0x40000000
    s_cmp_lt_u32 s3, 960
    s_cbranch_scc1 L2_pgu
    s_sub_u32 s3, s3, 960
    s_mov_b32 s54, 1280
    s_mul_i32 s14, s3, 6554
    s_lshr_b32 s14, s14, 16
    s_mul_i32 s15, s14, 10
    s_sub_u32 s15, s3, s15
    s_lshl_b32 s55, s15, 2
    s_mov_b32 s10, 13108
    s_mov_b32 s11, 5
    s_cmp_lt_u32 s14, 48
    s_cbranch_scc0 L2_pwo
    s_mov_b32 s16, s32
    s_mov_b32 s17, s33
    s_mov_b32 s18, 1966080
    s_mov_b32 s19, 0x00020000
    s_mov_b32 s100, 4
    s_mov_b32 s46, 10240
    s_mov_b32 s47, 20480
    s_mul_i32 s101, s14, 40960
    s_mov_b32 s12, 245760
    s_mul_i32 s13, s14, 21846
    s_lshr_b32 s13, s13, 16
    s_mul_i32 s15, s13, 3
    s_sub_u32 s15, s14, s15
    s_lshl_b32 s15, s15, 3
    s_add_u32 s13, s13, s15
    s_cmp_ge_u32 s14, 24
    s_cselect_b32 s15, 16, 0
    s_add_u32 s13, s13, s15
    s_mul_i32 s13, s13, 5120
    s_add_u32 s13, s13, 16793600
    s_branch L2_pdone
L2_pwo:
    s_mov_b32 s16, s8
    s_mov_b32 s17, s9
    s_mov_b32 s18, 819200
    s_mov_b32 s19, 0x00020000
    s_sub_u32 s14, s14, 48
    s_mov_b32 s12, 102400
    s_cmp_lt_u32 s14, 16
    s_cbranch_scc0 L2_pwob
    s_mov_b32 s100, 8
    s_mov_b32 s46, 5120
    s_mov_b32 s47, 25600
    s_mul_i32 s101, s14, 51200
    s_lshr_b32 s3, s14, 3
    s_and_b32 s14, s14, 7
    s_branch L2_pwoc
L2_pwob:
    s_sub_u32 s14, s14, 16
    s_mov_b32 s100, 20
    s_mov_b32 s46, 51200
    s_mov_b32 s47, 102400
    s_mul_i32 s101, s14, 204800
    s_add_u32 s101, s101, 20480
    s_lshr_b32 s3, s14, 1
    s_and_b32 s14, s14, 1
    s_add_u32 s14, s14, 8
L2_pwoc:
    s_mul_i32 s13, s3, 7
    s_add_u32 s13, s13, 6
    s_mul_i32 s15, s3, 3
    s_sub_u32 s15, s15, 7
    s_cmp_ge_u32 s14, 7
    s_cselect_b32 s13, s15, s13
    s_add_u32 s13, s13, s14
    s_mul_i32 s13, s13, 5120
    s_add_u32 s13, s13, 12042240
    s_cmp_lt_u32 s3, 2
    s_cbranch_scc1 L2_pdone
    s_mov_b32 s18, 0
    s_mov_b32 s13, 0x40000000
    s_branch L2_pdone
L2_pgu:
    s_cmp_ge_u32 s3, 480
    s_cselect_b32 s16, s30, s28
    s_cselect_b32 s17, s31, s29
    s_cselect_b32 s13, 6144, 0
    s_cselect_b32 s14, 480, 0
    s_mov_b32 s18, 1966080
    s_mov_b32 s19, 0x00020000
    s_sub_u32 s3, s3, s14
    s_mul_i32 s14, s3, 2731
    s_lshr_b32 s14, s14, 16
    s_mul_i32 s15, s14, 24
    s_sub_u32 s15, s3, s15
    s_lshl_b32 s55, s15, 2
    s_mov_b32 s54, 3072
    s_mov_b32 s100, 4
    s_mov_b32 s46, 24576
    s_mov_b32 s47, 49152
    s_mul_i32 s101, s14, 98304
    s_mov_b32 s10, 10923
    s_mov_b32 s11, 6
    s_mov_b32 s12, 245760
    s_mul_i32 s14, s14, 12288
    s_add_u32 s13, s13, s14
    s_lshl_b32 s52, s15, 8
    s_add_u32 s52, s52, s13
    s_add_u32 s52, s52, 11796480
    s_add_u32 s13, s13, 12861440
L2_pdone:
    v_mul_u32_u24 v165, s100, v53
    v_bfe_u32 v57, v0, 3, 2
    v_add_u32 v165, v165, v57
    v_mul_u32_u24 v165, s54, v165
    v_and_b32 v57, 7, v0
    v_lshl_add_u32 v165, v57, 4, v165
    s_lshl_b32 s3, s55, 5
    s_add_u32 s3, s3, s101
    v_add_u32 v165, s3, v165
    s_lshl_b32 s101, s42, 12
    s_add_u32 s101, s101, 90112
    v_lshrrev_b32 v57, 4, v0
    v_bfe_u32 v58, v0, 2, 2
    v_lshl_add_u32 v57, v57, 3, v58
    v_lshlrev_b32 v57, 7, v57
    v_and_b32 v58, 3, v0
    v_lshl_add_u32 v57, v58, 3, v57
    v_add_u32 v164, s101, v57
    s_mov_b32 s100, s52
    s_add_u32 s54, s46, s47
    s_add_u32 s3, s55, 0
    s_mul_i32 s14, s3, s10
    s_lshr_b32 s14, s14, 16
    s_mul_i32 s15, s14, s11
    s_sub_u32 s3, s3, s15
    s_mul_i32 s14, s14, s12
    s_lshl_b32 s3, s3, 10
    s_add_u32 s3, s3, s14
    s_add_u32 s58, s3, s13
    s_add_u32 s3, s55, 1
    s_mul_i32 s14, s3, s10
    s_lshr_b32 s14, s14, 16
    s_mul_i32 s15, s14, s11
    s_sub_u32 s3, s3, s15
    s_mul_i32 s14, s14, s12
    s_lshl_b32 s3, s3, 10
    s_add_u32 s3, s3, s14
    s_add_u32 s59, s3, s13
    s_add_u32 s3, s55, 2
    s_mul_i32 s14, s3, s10
    s_lshr_b32 s14, s14, 16
    s_mul_i32 s15, s14, s11
    s_sub_u32 s3, s3, s15
    s_mul_i32 s14, s14, s12
    s_lshl_b32 s3, s3, 10
    s_add_u32 s3, s3, s14
    s_add_u32 s60, s3, s13
    s_add_u32 s3, s55, 3
    s_mul_i32 s14, s3, s10
    s_lshr_b32 s14, s14, 16
    s_mul_i32 s15, s14, s11
    s_sub_u32 s3, s3, s15
    s_mul_i32 s14, s14, s12
    s_lshl_b32 s3, s3, 10
    s_add_u32 s3, s3, s14
    s_add_u32 s61, s3, s13
    s_cmp_lt_u32 s42, 4
    s_cbranch_scc1 L1_s1a
    s_setprio 0
    s_waitcnt vmcnt(0)
    s_barrier
L1_s1a:
    s_mov_b32 s20, s4
    s_mov_b32 s21, s5
    s_mov_b32 s22, 2621440
    s_mov_b32 s23, 0x00020000
    s_lshl_b32 s3, s56, 2
    s_add_u32 s3, s3, s43
    s_mul_i32 s3, s3, 20480
    s_mul_i32 s14, s57, 160
    s_add_u32 s3, s3, s14
    s_lshl_b32 s14, s44, 30
    s_add_u32 s3, s3, s14
    v_and_b32 v202, 15, v0
    v_mul_u32_u24 v202, 1280, v202
    v_lshrrev_b32 v203, 4, v0
    v_lshl_add_u32 v202, v203, 3, v202
    v_add_u32 v202, s3, v202
    s_lshr_b32 s3, s2, 3
    s_lshl_b32 s3, s3, 3
    s_add_u32 s3, s3, s42
    s_bfe_u32 s14, s2, 0x10002
    s_lshl_b32 s14, s14, 8
    s_add_u32 s3, s3, s14
    s_lshr_b32 s14, s3, 5
    s_and_b32 s3, s3, 31
    s_mul_i32 s14, s14, 245760
    s_mul_i32 s3, s3, 3072
    s_add_u32 s3, s3, s14
    s_add_u32 s3, s3, 12861440
    v_min_u32 v203, 5, v0
    v_lshl_add_u32 v203, v203, 7, s3
    v_add_u32 v210, 3840, v203
    v_lshlrev_b32 v204, 2, v0
    s_mul_i32 s3, s57, 102400
    s_lshl_b32 s10, s42, 10
    s_add_u32 s3, s3, s10
    s_add_u32 s3, s3, 12072960
    v_add_u32 v205, s3, v2
    s_add_u32 s10, s10, 90112
    s_cmp_ge_u32 s42, 6
    s_cselect_b32 s12, 7, 8
    s_lshl_b32 s12, s12, 13
    s_add_u32 s13, s12, s10
    s_lshl_b32 s3, s53, 11
    s_add_u32 s3, s3, s50
    v_lshlrev_b32 v4, 4, v52
    v_lshl_add_u32 v4, v53, 11, v4
    v_add_u32 v4, s3, v4
    s_mul_i32 s3, s53, -4088
    s_add_u32 s3, s3, 4096
    s_add_u32 s3, s3, s50
    v_add_u32 v5, s3, v2
    v_mul_u32_u24 v6, 320, v53
    v_lshl_add_u32 v6, v52, 4, v6
    v_add_u32 v6, s50, v6
    s_mul_i32 s52, s44, 1310720
    s_add_u32 s97, s97, s51
    v_cmp_eq_u32 vcc, 20, v52
    v_mov_b32 v36, 0x3f803f80
    s_nop 0
    v_cndmask_b32 v36, 0, v36, vcc
    v_mov_b32 v37, v36
    v_mov_b32 v38, v36
    v_mov_b32 v39, v36
    v_mov_b32 v40, v36
    v_mov_b32 v41, v36
    v_mov_b32 v42, v36
    v_mov_b32 v43, v36
    v_mov_b32 v44, v36
    v_mov_b32 v45, v36
    v_mov_b32 v46, v36
    v_mov_b32 v47, v36
    v_mov_b32 v48, v36
    v_mov_b32 v49, v36
    v_mov_b32 v50, v36
    v_mov_b32 v51, v36
    v_mov_b32 v128, 0
    v_mov_b32 v129, 0
    v_mov_b32 v130, 0
    v_mov_b32 v131, 0
    v_mov_b32 v132, 0
    v_mov_b32 v133, 0
    v_mov_b32 v134, 0
    v_mov_b32 v135, 0
    v_mov_b32 v136, 0
    v_mov_b32 v137, 0
    v_mov_b32 v138, 0
    v_mov_b32 v139, 0
    v_mov_b32 v140, 0
    v_mov_b32 v141, 0
    v_mov_b32 v142, 0
    v_mov_b32 v143, 0
    v_mov_b32 v144, 0
    v_mov_b32 v145, 0
    v_mov_b32 v146, 0
    v_mov_b32 v147, 0
    v_mov_b32 v148, 0
    v_mov_b32 v149, 0
    v_mov_b32 v150, 0
    v_mov_b32 v151, 0
    v_mov_b32 v152, 0
    v_mov_b32 v153, 0
    v_mov_b32 v154, 0
    v_mov_b32 v155, 0
    v_mov_b32 v156, 0
    v_mov_b32 v157, 0
    v_mov_b32 v158, 0
    v_mov_b32 v159, 0
    s_mul_i32 s3, s43, 3072
    s_add_u32 s14, s3, s50
    v_add_u32 v56, s14, v2
    s_sub_u32 s14, 45056, s50
    s_add_u32 s14, s14, s3
    v_add_u32 v59, s14, v2
    s_lshl_b32 s3, s41, 4
    s_lshl_b32 s14, s43, 2
    s_add_u32 s3, s3, s14
    s_lshl_b32 s14, s44, 1
    s_add_u32 s3, s3, s14
    v_bfe_u32 v57, v0, 4, 1
    v_add_u32 v57, s3, v57
    v_mul_u32_u24 v57, 20480, v57
    v_and_b32 v60, 15, v0
    s_lshl_b32 s3, s40, 9
    s_add_u32 s3, s3, 8912896
    v_lshl_add_u32 v58, v53, 8, s3
    v_lshl_add_u32 v58, v60, 4, v58
    v_add_u32 v58, v58, v57
    s_lshl_b32 s3, s40, 7
    s_add_u32 s3, s3, 8929280
    v_lshl_add_u32 v57, v60, 3, v57
    v_add_u32 v57, s3, v57
    s_lshl_b32 s3, s56, 2
    s_add_u32 s3, s3, s43
    s_mul_i32 s3, s3, 20480
    s_add_u32 s3, s3, 8912896
    s_lshl_b32 s14, s44, 13
    s_add_u32 s14, s14, s3
    v_add_u32 v230, s14, v2
    v_add_u32 v231, 4096, v230
    s_lshl_b32 s14, s44, 11
    s_add_u32 s14, s14, s3
    s_add_u32 s14, s14, 16384
    v_lshrrev_b32 v232, 4, v0
    v_lshlrev_b32 v232, 8, v232
    v_lshl_add_u32 v232, v60, 3, v232
    v_add_u32 v232, s14, v232
    s_lshr_b32 s3, s40, 1
    s_mul_i32 s3, s3, 5
    s_lshl_b32 s14, s53, 1
    s_add_u32 s3, s3, s14
    s_add_u32 s14, s3, 2
    s_lshr_b32 s3, s3, 4
    s_lshr_b32 s14, s14, 4
    s_lshl_b32 s14, s14, 8
    s_or_b32 s3, s3, s14
    s_mul_i32 s14, s40, 20
    s_lshr_b32 s15, s14, 7
    s_lshl_b32 s15, s15, 16
    s_or_b32 s3, s3, s15
    s_add_u32 s14, s14, 19
    s_lshr_b32 s14, s14, 7
    s_lshl_b32 s14, s14, 24
    s_or_b32 s3, s3, s14
    s_add_u32 s15, s3, 0x0a0a0505
    v_lshrrev_b32 v235, 4, v0
    v_lshlrev_b32 v235, 3, v235
    v_bfe_u32 v235, s15, v235, 8
    v_lshl_add_u32 v235, v60, 4, v235
    s_mov_b32 s14, 18776064
    v_lshl_add_u32 v235, v235, 8, s14
    v_and_b32 v236, 3, v0
    v_lshlrev_b32 v236, 3, v236
    v_bfe_u32 v234, s15, v236, 8
    v_bfe_u32 v236, v0, 2, 1
    v_and_or_b32 v236, v0, 8, v236
    v_lshl_add_u32 v234, v236, 4, v234
    v_and_b32 v236, 1, v0
    v_lshlrev_b32 v236, 3, v236
    v_bfe_u32 v236, s3, v236, 8
    v_bfe_u32 v237, v0, 1, 1
    s_lshl_b32 s3, s41, 1
    v_add_u32 v237, s3, v237
    v_lshl_add_u32 v236, v237, 4, v236
    v_cmp_gt_u32 vcc, 16, v0
    s_nop 1
    v_cndmask_b32 v234, v236, v234, vcc
    v_lshl_add_u32 v234, v234, 8, s14
    v_mov_b32 v236, 1
    s_cmp_ge_u32 s42, 4
    s_cbranch_scc1 L1_s1d
    s_cmp_lg_u32 s42, 2
    s_cbranch_scc1 L1_s1c
    s_waitcnt vmcnt(0)
    s_mov_b32 s14, 400000
L1_rdy:
    v_readfirstlane_b32 s3, v201
    s_cmp_lg_u32 s3, 0
    s_cbranch_scc1 L1_rdy2
    global_load_dword v201, v200, s[36:37] sc1
    s_waitcnt vmcnt(0)
    s_sub_u32 s14, s14, 1
    s_cmp_lg_u32 s14, 0
    s_cbranch_scc1 L1_rdy
L1_rdy2:
    v_mov_b32 v201, 1
    s_mov_b64 exec, 1
    s_barrier
    buffer_store_dword v201, v233, s[24:27], 0 offen sc1
    s_mov_b64 exec, -1
    s_branch L1_s1d
L1_s1c:
    s_waitcnt vmcnt(0)
    s_barrier
    s_cmp_lg_u32 s42, 3
    s_cbranch_scc1 L1_s1d
    s_mov_b32 s14, 400000
    s_mov_b32 exec_lo, 0xfffff
    s_mov_b32 exec_hi, 0x0
Lpoll1:
    buffer_load_dword v201, v234, s[24:27], 0 offen sc1
    s_waitcnt vmcnt(0)
    v_cmp_ne_u32 vcc, 0, v201
    s_sub_u32 s14, s14, 1
    s_cmp_eq_u32 s14, 0
    s_cbranch_scc1 Lpolld1
    s_cmp_eq_u64 vcc, exec
    s_cbranch_scc0 Lpoll1
Lpolld1:
    s_mov_b64 exec, -1
L1_s1d:
    s_barrier
    buffer_load_dwordx4 v[8:11], v55, s[24:27], s98 offen sc1
    buffer_load_dwordx4 v[12:15], v55, s[24:27], s99 offen sc1
    buffer_load_dwordx2 v[16:17], v20, s[24:27], s98 offen sc1
    s_add_u32 m0, s51, 0
    s_nop 0
    buffer_load_dwordx4 v160, s[24:27], s52 offen sc1 lds
    s_add_u32 m0, s51, 1024
    s_nop 0
    buffer_load_dwordx4 v161, s[24:27], s52 offen sc1 lds
    s_add_u32 m0, s97, 0
    s_nop 0
    buffer_load_dwordx4 v162, s[24:27], s52 offen sc1 lds
    s_add_u32 s52, s52, 163840
    s_bfe_u32 s3, s2, 0x30003
    s_lshl_b32 s3, s3, 8
    s_add_u32 s3, s3, 18841600
    v_mov_b32 v206, s3
    v_mov_b32 v207, 1
    s_add_u32 s3, s3, 2048
    v_lshl_add_u32 v212, v0, 11, s3
    v_mov_b32 v213, 1
    s_and_b32 s3, s2, 7
    s_lshl_b32 s3, s3, 11
    s_add_u32 s3, s3, 18843648
    v_and_b32 v200, 7, v0
    v_lshl_add_u32 v200, v200, 8, s3
    s_cmp_eq_u32 s42, 0
    s_cselect_b32 s62, 255, 0
    s_mov_b32 s63, 0
    v_mov_b32 v238, 0x3f803f80
    v_mov_b32 v239, v238
    v_mov_b32 v240, v238
    v_mov_b32 v241, v238
    v_mov_b32 v201, 1
    s_lshl_b32 s3, s2, 3
    s_add_u32 s3, s3, s42
    s_mul_i32 s3, s3, 1920
    s_add_u32 s3, s3, 7864320
    v_add_u32 v224, s3, v2
    v_mov_b32 v226, -1
    v_mov_b32 v227, -1
    v_mov_b32 v228, -1
    v_mov_b32 v229, -1
    s_waitcnt vmcnt(0)
    s_barrier
    ds_read_b64 v[32:33], v5 offset:0
    ds_read_b128 v[24:27], v4 offset:0
    ds_read_b128 v[28:31], v4 offset:512
    ds_read_b64 v[34:35], v5 offset:1024
    s_mov_b64 exec, s[48:49]
    ds_read_b128 v[36:39], v6 offset:6144
    ds_read_b128 v[40:43], v6 offset:6784
    s_mov_b64 exec, -1
    s_cmp_eq_u32 s42, 0
    s_cselect_b64 exec, -1, 0
    buffer_load_dword v236, v235, s[24:27], 0 offen sc1
    s_mov_b64 exec, -1
    s_waitcnt lgkmcnt(5)
    v_mfma_f32_32x32x4_2b_bf16 v[64:95], v[32:33], v[16:17], 0 cbsz:1 abid:0
    s_add_u32 m0, s51, 11264
    s_nop 0
    buffer_load_dwordx4 v160, s[24:27], s52 offen sc1 lds
    s_add_u32 m0, s51, 12288
    s_nop 0
    buffer_load_dwordx4 v161, s[24:27], s52 offen sc1 lds
    s_add_u32 m0, s97, 11264
    s_nop 0
    buffer_load_dwordx4 v162, s[24:27], s52 offen sc1 lds
    s_add_u32 s52, s52, 163840
    s_waitcnt lgkmcnt(0)
    s_nop 6
    v_mfma_f32_32x32x16_bf16 v[64:79], v[24:27], v[8:11], v[64:79]
    v_mfma_f32_32x32x16_bf16 v[80:95], v[24:27], v[12:15], v[80:95]
    s_nop 9
    s_setprio 2
    v_exp_f32 v64, v64
    v_exp_f32 v65, v65
    v_exp_f32 v66, v66
    v_exp_f32 v67, v67
    v_mfma_f32_32x32x4_2b_bf16 v[96:127], v[32:33], v[16:17], 0 cbsz:1 abid:1
    v_exp_f32 v68, v68
    v_exp_f32 v69, v69
    v_exp_f32 v70, v70
    v_exp_f32 v71, v71
    v_exp_f32 v72, v72
    v_exp_f32 v73, v73
    v_exp_f32 v74, v74
    v_exp_f32 v75, v75
    v_smfmac_f32_32x32x32_bf16 v[128:143], v[36:39], v[64:71], v7
    v_exp_f32 v76, v76
    v_exp_f32 v77, v77
    v_exp_f32 v78, v78
    v_exp_f32 v79, v79
    s_waitcnt lgkmcnt(0)
    s_mov_b64 exec, s[48:49]
    ds_read_b128 v[44:47], v6 offset:7424
    ds_read_b128 v[48:51], v6 offset:8064
    s_mov_b64 exec, -1
    v_smfmac_f32_32x32x32_bf16 v[128:143], v[40:43], v[72:79], v7
    s_setprio 1
    v_exp_f32 v80, v80
    v_exp_f32 v81, v81
    v_exp_f32 v82, v82
    v_exp_f32 v83, v83
    v_mfma_f32_32x32x16_bf16 v[96:111], v[28:31], v[8:11], v[96:111]
    v_exp_f32 v84, v84
    v_exp_f32 v85, v85
    v_exp_f32 v86, v86
    v_exp_f32 v87, v87
    v_mfma_f32_32x32x16_bf16 v[112:127], v[28:31], v[12:15], v[112:127]
    v_exp_f32 v88, v88
    v_exp_f32 v89, v89
    v_exp_f32 v90, v90
    v_exp_f32 v91, v91
    v_smfmac_f32_32x32x32_bf16 v[144:159], v[36:39], v[80:87], v7
    v_exp_f32 v92, v92
    v_exp_f32 v93, v93
    v_exp_f32 v94, v94
    v_exp_f32 v95, v95
    s_waitcnt lgkmcnt(0)
    ds_read_b128 v[24:27], v4 offset:1024
    v_smfmac_f32_32x32x32_bf16 v[144:159], v[40:43], v[88:95], v7
    v_exp_f32 v96, v96
    v_exp_f32 v97, v97
    v_exp_f32 v98, v98
    v_exp_f32 v99, v99
    v_mfma_f32_32x32x4_2b_bf16 v[64:95], v[34:35], v[16:17], 0 cbsz:1 abid:0
    v_exp_f32 v100, v100
    v_exp_f32 v101, v101
    v_exp_f32 v102, v102
    v_exp_f32 v103, v103
    v_exp_f32 v104, v104
    v_exp_f32 v105, v105
    v_exp_f32 v106, v106
    v_exp_f32 v107, v107
    v_smfmac_f32_32x32x32_bf16 v[128:143], v[44:47], v[96:103], v7
    s_waitcnt vmcnt(3)
    v_cmp_ne_u32 vcc, 0, v236
    s_cmp_eq_u64 vcc, -1
    s_cbranch_scc0 L2_kvwait
L2_kvback:
    s_barrier
    v_exp_f32 v108, v108
    v_exp_f32 v109, v109
    v_exp_f32 v110, v110
    v_exp_f32 v111, v111
    s_waitcnt lgkmcnt(0)
    s_mov_b64 exec, s[48:49]
    ds_read_b128 v[36:39], v6 offset:8704
    ds_read_b128 v[40:43], v6 offset:9344
    s_mov_b64 exec, -1
    v_smfmac_f32_32x32x32_bf16 v[128:143], v[48:51], v[104:111], v7
    s_setprio 0
    s_add_u32 m0, s51, 22528
    v_exp_f32 v112, v112
    v_exp_f32 v113, v113
    v_exp_f32 v114, v114
    v_exp_f32 v115, v115
    v_mfma_f32_32x32x16_bf16 v[64:79], v[24:27], v[8:11], v[64:79]
    buffer_load_dwordx4 v160, s[24:27], s52 offen sc1 lds
    v_exp_f32 v116, v116
    v_exp_f32 v117, v117
    v_exp_f32 v118, v118
    v_exp_f32 v119, v119
    v_mfma_f32_32x32x16_bf16 v[80:95], v[24:27], v[12:15], v[80:95]
    s_add_u32 m0, s51, 23552
    v_exp_f32 v120, v120
    v_exp_f32 v121, v121
    v_exp_f32 v122, v122
    v_exp_f32 v123, v123
    v_smfmac_f32_32x32x32_bf16 v[144:159], v[44:47], v[112:119], v7
    buffer_load_dwordx4 v161, s[24:27], s52 offen sc1 lds
    v_exp_f32 v124, v124
    v_exp_f32 v125, v125
    v_exp_f32 v126, v126
    v_exp_f32 v127, v127
    s_waitcnt lgkmcnt(0)
    ds_read_b128 v[28:31], v4 offset:1536
    v_smfmac_f32_32x32x32_bf16 v[144:159], v[48:51], v[120:127], v7
    s_add_u32 m0, s97, 22528
    v_exp_f32 v64, v64
    v_exp_f32 v65, v65
    v_exp_f32 v66, v66
    v_exp_f32 v67, v67
    v_mfma_f32_32x32x4_2b_bf16 v[96:127], v[34:35], v[16:17], 0 cbsz:1 abid:1
    buffer_load_dwordx4 v162, s[24:27], s52 offen sc1 lds
    s_add_u32 s52, s52, 163840
    v_exp_f32 v68, v68
    v_exp_f32 v69, v69
    v_exp_f32 v70, v70
    v_exp_f32 v71, v71
    v_exp_f32 v72, v72
    v_exp_f32 v73, v73
    v_exp_f32 v74, v74
    v_exp_f32 v75, v75
    v_smfmac_f32_32x32x32_bf16 v[128:143], v[36:39], v[64:71], v7
    s_waitcnt vmcnt(3)
    s_barrier
    v_exp_f32 v76, v76
    v_exp_f32 v77, v77
    v_exp_f32 v78, v78
    v_exp_f32 v79, v79
    s_waitcnt lgkmcnt(0)
    s_mov_b64 exec, s[48:49]
    ds_read_b128 v[44:47], v6 offset:9984
    ds_read_b128 v[48:51], v6 offset:10624
    s_mov_b64 exec, -1
    ds_read_b64 v[32:33], v5 offset:11264
    v_smfmac_f32_32x32x32_bf16 v[128:143], v[40:43], v[72:79], v7
    s_setprio 3
    s_add_u32 m0, s51, 33792
    v_exp_f32 v80, v80
    v_exp_f32 v81, v81
    v_exp_f32 v82, v82
    v_exp_f32 v83, v83
    v_mfma_f32_32x32x16_bf16 v[96:111], v[28:31], v[8:11], v[96:111]
    buffer_load_dwordx4 v160, s[24:27], s52 offen sc1 lds
    v_exp_f32 v84, v84
    v_exp_f32 v85, v85
    v_exp_f32 v86, v86
    v_exp_f32 v87, v87
    v_mfma_f32_32x32x16_bf16 v[112:127], v[28:31], v[12:15], v[112:127]
    s_add_u32 m0, s51, 34816
    v_exp_f32 v88, v88
    v_exp_f32 v89, v89
    v_exp_f32 v90, v90
    v_exp_f32 v91, v91
    v_smfmac_f32_32x32x32_bf16 v[144:159], v[36:39], v[80:87], v7
    buffer_load_dwordx4 v161, s[24:27], s52 offen sc1 lds
    v_exp_f32 v92, v92
    v_exp_f32 v93, v93
    v_exp_f32 v94, v94
    v_exp_f32 v95, v95
    s_waitcnt lgkmcnt(0)
    ds_read_b128 v[24:27], v4 offset:11264
    v_smfmac_f32_32x32x32_bf16 v[144:159], v[40:43], v[88:95], v7
    s_add_u32 m0, s97, 33792
    v_exp_f32 v96, v96
    v_exp_f32 v97, v97
    v_exp_f32 v98, v98
    v_exp_f32 v99, v99
    v_mfma_f32_32x32x4_2b_bf16 v[64:95], v[32:33], v[16:17], 0 cbsz:1 abid:0
    buffer_load_dwordx4 v162, s[24:27], s52 offen sc1 lds
    s_add_u32 s52, s52, 163840
    v_exp_f32 v100, v100
    v_exp_f32 v101, v101
    v_exp_f32 v102, v102
    v_exp_f32 v103, v103
    v_exp_f32 v104, v104
    v_exp_f32 v105, v105
    v_exp_f32 v106, v106
    v_exp_f32 v107, v107
    v_smfmac_f32_32x32x32_bf16 v[128:143], v[44:47], v[96:103], v7
    s_add_u32 m0, s101, 0
    v_exp_f32 v108, v108
    v_exp_f32 v109, v109
    v_exp_f32 v110, v110
    v_exp_f32 v111, v111
    s_waitcnt lgkmcnt(0)
    s_mov_b64 exec, s[48:49]
    ds_read_b128 v[36:39], v6 offset:17408
    ds_read_b128 v[40:43], v6 offset:18048
    s_mov_b64 exec, -1
    v_smfmac_f32_32x32x32_bf16 v[128:143], v[48:51], v[104:111], v7
    s_setprio 2
    buffer_load_dwordx4 v165, s[16:19], 0 offen lds
    v_exp_f32 v112, v112
    v_exp_f32 v113, v113
    v_exp_f32 v114, v114
    v_exp_f32 v115, v115
    v_mfma_f32_32x32x16_bf16 v[64:79], v[24:27], v[8:11], v[64:79]
    s_add_u32 m0, s101, 1024
    v_exp_f32 v116, v116
    v_exp_f32 v117, v117
    v_exp_f32 v118, v118
    v_exp_f32 v119, v119
    v_mfma_f32_32x32x16_bf16 v[80:95], v[24:27], v[12:15], v[80:95]
    buffer_load_dwordx4 v165, s[16:19], s46 offen lds
    v_exp_f32 v120, v120
    v_exp_f32 v121, v121
    v_exp_f32 v122, v122
    v_exp_f32 v123, v123
    v_smfmac_f32_32x32x32_bf16 v[144:159], v[44:47], v[112:119], v7
    s_add_u32 m0, s101, 2048
    v_exp_f32 v124, v124
    v_exp_f32 v125, v125
    v_exp_f32 v126, v126
    v_exp_f32 v127, v127
    s_waitcnt lgkmcnt(0)
    ds_read_b128 v[28:31], v4 offset:11776
    ds_read_b64 v[34:35], v5 offset:12288
    v_smfmac_f32_32x32x32_bf16 v[144:159], v[48:51], v[120:127], v7
    buffer_load_dwordx4 v165, s[16:19], s47 offen lds
    v_exp_f32 v64, v64
    v_exp_f32 v65, v65
    v_exp_f32 v66, v66
    v_exp_f32 v67, v67
    v_mfma_f32_32x32x4_2b_bf16 v[96:127], v[32:33], v[16:17], 0 cbsz:1 abid:1
    s_add_u32 m0, s101, 3072
    v_exp_f32 v68, v68
    v_exp_f32 v69, v69
    v_exp_f32 v70, v70
    v_exp_f32 v71, v71
    v_exp_f32 v72, v72
    v_exp_f32 v73, v73
    v_exp_f32 v74, v74
    v_exp_f32 v75, v75
    v_smfmac_f32_32x32x32_bf16 v[128:143], v[36:39], v[64:71], v7
    buffer_load_dwordx4 v165, s[16:19], s54 offen lds
    v_exp_f32 v76, v76
    v_exp_f32 v77, v77
    v_exp_f32 v78, v78
    v_exp_f32 v79, v79
    s_waitcnt lgkmcnt(0)
    s_mov_b64 exec, s[48:49]
    ds_read_b128 v[44:47], v6 offset:18688
    ds_read_b128 v[48:51], v6 offset:19328
    s_mov_b64 exec, -1
    v_smfmac_f32_32x32x32_bf16 v[128:143], v[40:43], v[72:79], v7
    s_setprio 1
    v_exp_f32 v80, v80
    v_exp_f32 v81, v81
    v_exp_f32 v82, v82
    v_exp_f32 v83, v83
    v_mfma_f32_32x32x16_bf16 v[96:111], v[28:31], v[8:11], v[96:111]
    v_exp_f32 v84, v84
    v_exp_f32 v85, v85
    v_exp_f32 v86, v86
    v_exp_f32 v87, v87
    v_mfma_f32_32x32x16_bf16 v[112:127], v[28:31], v[12:15], v[112:127]
    v_exp_f32 v88, v88
    v_exp_f32 v89, v89
    v_exp_f32 v90, v90
    v_exp_f32 v91, v91
    v_smfmac_f32_32x32x32_bf16 v[144:159], v[36:39], v[80:87], v7
    v_exp_f32 v92, v92
    v_exp_f32 v93, v93
    v_exp_f32 v94, v94
    v_exp_f32 v95, v95
    s_waitcnt lgkmcnt(0)
    ds_read_b128 v[24:27], v4 offset:12288
    v_smfmac_f32_32x32x32_bf16 v[144:159], v[40:43], v[88:95], v7
    v_exp_f32 v96, v96
    v_exp_f32 v97, v97
    v_exp_f32 v98, v98
    v_exp_f32 v99, v99
    v_mfma_f32_32x32x4_2b_bf16 v[64:95], v[34:35], v[16:17], 0 cbsz:1 abid:0
    v_exp_f32 v100, v100
    v_exp_f32 v101, v101
    v_exp_f32 v102, v102
    v_exp_f32 v103, v103
    v_exp_f32 v104, v104
    v_exp_f32 v105, v105
    v_exp_f32 v106, v106
    v_exp_f32 v107, v107
    v_smfmac_f32_32x32x32_bf16 v[128:143], v[44:47], v[96:103], v7
    v_exp_f32 v108, v108
    v_exp_f32 v109, v109
    v_exp_f32 v110, v110
    v_exp_f32 v111, v111
    s_waitcnt lgkmcnt(0)
    s_mov_b64 exec, s[48:49]
    ds_read_b128 v[36:39], v6 offset:19968
    ds_read_b128 v[40:43], v6 offset:20608
    s_mov_b64 exec, -1
    v_smfmac_f32_32x32x32_bf16 v[128:143], v[48:51], v[104:111], v7
    s_setprio 0
    v_exp_f32 v112, v112
    v_exp_f32 v113, v113
    v_exp_f32 v114, v114
    v_exp_f32 v115, v115
    v_mfma_f32_32x32x16_bf16 v[64:79], v[24:27], v[8:11], v[64:79]
    v_exp_f32 v116, v116
    v_exp_f32 v117, v117
    v_exp_f32 v118, v118
    v_exp_f32 v119, v119
    v_mfma_f32_32x32x16_bf16 v[80:95], v[24:27], v[12:15], v[80:95]
    v_exp_f32 v120, v120
    v_exp_f32 v121, v121
    v_exp_f32 v122, v122
    v_exp_f32 v123, v123
    v_smfmac_f32_32x32x32_bf16 v[144:159], v[44:47], v[112:119], v7
    v_exp_f32 v124, v124
    v_exp_f32 v125, v125
    v_exp_f32 v126, v126
    v_exp_f32 v127, v127
    s_waitcnt lgkmcnt(0)
    ds_read_b128 v[28:31], v4 offset:12800
    v_smfmac_f32_32x32x32_bf16 v[144:159], v[48:51], v[120:127], v7
    v_exp_f32 v64, v64
    v_exp_f32 v65, v65
    v_exp_f32 v66, v66
    v_exp_f32 v67, v67
    v_mfma_f32_32x32x4_2b_bf16 v[96:127], v[34:35], v[16:17], 0 cbsz:1 abid:1
    v_exp_f32 v68, v68
    v_exp_f32 v69, v69
    v_exp_f32 v70, v70
    v_exp_f32 v71, v71
    v_exp_f32 v72, v72
    v_exp_f32 v73, v73
    v_exp_f32 v74, v74
    v_exp_f32 v75, v75
    v_smfmac_f32_32x32x32_bf16 v[128:143], v[36:39], v[64:71], v7
    s_waitcnt vmcnt(4)
    s_barrier
    v_exp_f32 v76, v76
    v_exp_f32 v77, v77
    v_exp_f32 v78, v78
    v_exp_f32 v79, v79
    s_waitcnt lgkmcnt(0)
    s_mov_b64 exec, s[48:49]
    ds_read_b128 v[44:47], v6 offset:21248
    ds_read_b128 v[48:51], v6 offset:21888
    s_mov_b64 exec, -1
    ds_read_b64 v[32:33], v5 offset:22528
    v_smfmac_f32_32x32x32_bf16 v[128:143], v[40:43], v[72:79], v7
    s_setprio 3
    s_add_u32 m0, s51, 0
    v_exp_f32 v80, v80
    v_exp_f32 v81, v81
    v_exp_f32 v82, v82
    v_exp_f32 v83, v83
    v_mfma_f32_32x32x16_bf16 v[96:111], v[28:31], v[8:11], v[96:111]
    buffer_load_dwordx4 v160, s[24:27], s52 offen sc1 lds
    v_exp_f32 v84, v84
    v_exp_f32 v85, v85
    v_exp_f32 v86, v86
    v_exp_f32 v87, v87
    v_mfma_f32_32x32x16_bf16 v[112:127], v[28:31], v[12:15], v[112:127]
    s_add_u32 m0, s51, 1024
    v_exp_f32 v88, v88
    v_exp_f32 v89, v89
    v_exp_f32 v90, v90
    v_exp_f32 v91, v91
    v_smfmac_f32_32x32x32_bf16 v[144:159], v[36:39], v[80:87], v7
    buffer_load_dwordx4 v161, s[24:27], s52 offen sc1 lds
    v_exp_f32 v92, v92
    v_exp_f32 v93, v93
    v_exp_f32 v94, v94
    v_exp_f32 v95, v95
    s_waitcnt lgkmcnt(0)
    ds_read_b128 v[24:27], v4 offset:22528
    v_smfmac_f32_32x32x32_bf16 v[144:159], v[40:43], v[88:95], v7
    s_add_u32 m0, s97, 0
    v_exp_f32 v96, v96
    v_exp_f32 v97, v97
    v_exp_f32 v98, v98
    v_exp_f32 v99, v99
    v_mfma_f32_32x32x4_2b_bf16 v[64:95], v[32:33], v[16:17], 0 cbsz:1 abid:0
    buffer_load_dwordx4 v162, s[24:27], s52 offen sc1 lds
    s_add_u32 s52, s52, 163840
    v_exp_f32 v100, v100
    v_exp_f32 v101, v101
    v_exp_f32 v102, v102
    v_exp_f32 v103, v103
    v_exp_f32 v104, v104
    v_exp_f32 v105, v105
    v_exp_f32 v106, v106
    v_exp_f32 v107, v107
    v_smfmac_f32_32x32x32_bf16 v[128:143], v[44:47], v[96:103], v7
    buffer_load_dwordx2 v[246:247], v202, s[20:23], 0 offen offset:0
    v_exp_f32 v108, v108
    v_exp_f32 v109, v109
    v_exp_f32 v110, v110
    v_exp_f32 v111, v111
    s_waitcnt lgkmcnt(0)
    s_mov_b64 exec, s[48:49]
    ds_read_b128 v[36:39], v6 offset:28672
    ds_read_b128 v[40:43], v6 offset:29312
    s_mov_b64 exec, -1
    v_smfmac_f32_32x32x32_bf16 v[128:143], v[48:51], v[104:111], v7
    s_setprio 2
    buffer_load_dwordx2 v[248:249], v202, s[20:23], 0 offen offset:32
    v_exp_f32 v112, v112
    v_exp_f32 v113, v113
    v_exp_f32 v114, v114
    v_exp_f32 v115, v115
    v_mfma_f32_32x32x16_bf16 v[64:79], v[24:27], v[8:11], v[64:79]
    v_exp_f32 v116, v116
    v_exp_f32 v117, v117
    v_exp_f32 v118, v118
    v_exp_f32 v119, v119
    v_mfma_f32_32x32x16_bf16 v[80:95], v[24:27], v[12:15], v[80:95]
    v_exp_f32 v120, v120
    v_exp_f32 v121, v121
    v_exp_f32 v122, v122
    v_exp_f32 v123, v123
    v_smfmac_f32_32x32x32_bf16 v[144:159], v[44:47], v[112:119], v7
    v_exp_f32 v124, v124
    v_exp_f32 v125, v125
    v_exp_f32 v126, v126
    v_exp_f32 v127, v127
    s_waitcnt lgkmcnt(0)
    ds_read_b128 v[28:31], v4 offset:23040
    ds_read_b64 v[34:35], v5 offset:23552
    v_smfmac_f32_32x32x32_bf16 v[144:159], v[48:51], v[120:127], v7
    buffer_load_dwordx2 v[250:251], v202, s[20:23], 0 offen offset:64
    v_exp_f32 v64, v64
    v_exp_f32 v65, v65
    v_exp_f32 v66, v66
    v_exp_f32 v67, v67
    v_mfma_f32_32x32x4_2b_bf16 v[96:127], v[32:33], v[16:17], 0 cbsz:1 abid:1
    v_exp_f32 v68, v68
    v_exp_f32 v69, v69
    v_exp_f32 v70, v70
    v_exp_f32 v71, v71
    v_exp_f32 v72, v72
    v_exp_f32 v73, v73
    v_exp_f32 v74, v74
    v_exp_f32 v75, v75
    v_smfmac_f32_32x32x32_bf16 v[128:143], v[36:39], v[64:71], v7
    v_exp_f32 v76, v76
    v_exp_f32 v77, v77
    v_exp_f32 v78, v78
    v_exp_f32 v79, v79
    s_waitcnt lgkmcnt(0)
    s_mov_b64 exec, s[48:49]
    ds_read_b128 v[44:47], v6 offset:29952
    ds_read_b128 v[48:51], v6 offset:30592
    s_mov_b64 exec, -1
    v_smfmac_f32_32x32x32_bf16 v[128:143], v[40:43], v[72:79], v7
    s_setprio 1
    buffer_load_dwordx2 v[252:253], v202, s[20:23], 0 offen offset:96
    v_exp_f32 v80, v80
    v_exp_f32 v81, v81
    v_exp_f32 v82, v82
    v_exp_f32 v83, v83
    v_mfma_f32_32x32x16_bf16 v[96:111], v[28:31], v[8:11], v[96:111]
    v_exp_f32 v84, v84
    v_exp_f32 v85, v85
    v_exp_f32 v86, v86
    v_exp_f32 v87, v87
    v_mfma_f32_32x32x16_bf16 v[112:127], v[28:31], v[12:15], v[112:127]
    v_exp_f32 v88, v88
    v_exp_f32 v89, v89
    v_exp_f32 v90, v90
    v_exp_f32 v91, v91
    v_smfmac_f32_32x32x32_bf16 v[144:159], v[36:39], v[80:87], v7
    v_exp_f32 v92, v92
    v_exp_f32 v93, v93
    v_exp_f32 v94, v94
    v_exp_f32 v95, v95
    s_waitcnt lgkmcnt(0)
    ds_read_b128 v[24:27], v4 offset:23552
    v_smfmac_f32_32x32x32_bf16 v[144:159], v[40:43], v[88:95], v7
    buffer_load_dwordx2 v[254:255], v202, s[20:23], 0 offen offset:128
    v_exp_f32 v96, v96
    v_exp_f32 v97, v97
    v_exp_f32 v98, v98
    v_exp_f32 v99, v99
    v_mfma_f32_32x32x4_2b_bf16 v[64:95], v[34:35], v[16:17], 0 cbsz:1 abid:0
    v_exp_f32 v100, v100
    v_exp_f32 v101, v101
    v_exp_f32 v102, v102
    v_exp_f32 v103, v103
    v_exp_f32 v104, v104
    v_exp_f32 v105, v105
    v_exp_f32 v106, v106
    v_exp_f32 v107, v107
    v_smfmac_f32_32x32x32_bf16 v[128:143], v[44:47], v[96:103], v7
    v_exp_f32 v108, v108
    v_exp_f32 v109, v109
    v_exp_f32 v110, v110
    v_exp_f32 v111, v111
    s_waitcnt lgkmcnt(0)
    s_mov_b64 exec, s[48:49]
    ds_read_b128 v[36:39], v6 offset:31232
    ds_read_b128 v[40:43], v6 offset:31872
    s_mov_b64 exec, -1
    v_smfmac_f32_32x32x32_bf16 v[128:143], v[48:51], v[104:111], v7
    s_setprio 0
    v_exp_f32 v112, v112
    v_exp_f32 v113, v113
    v_exp_f32 v114, v114
    v_exp_f32 v115, v115
    v_mfma_f32_32x32x16_bf16 v[64:79], v[24:27], v[8:11], v[64:79]
    v_exp_f32 v116, v116
    v_exp_f32 v117, v117
    v_exp_f32 v118, v118
    v_exp_f32 v119, v119
    v_mfma_f32_32x32x16_bf16 v[80:95], v[24:27], v[12:15], v[80:95]
    v_exp_f32 v120, v120
    v_exp_f32 v121, v121
    v_exp_f32 v122, v122
    v_exp_f32 v123, v123
    v_smfmac_f32_32x32x32_bf16 v[144:159], v[44:47], v[112:119], v7
    v_exp_f32 v124, v124
    v_exp_f32 v125, v125
    v_exp_f32 v126, v126
    v_exp_f32 v127, v127
    s_waitcnt lgkmcnt(0)
    ds_read_b128 v[28:31], v4 offset:24064
    v_smfmac_f32_32x32x32_bf16 v[144:159], v[48:51], v[120:127], v7
    v_exp_f32 v64, v64
    v_exp_f32 v65, v65
    v_exp_f32 v66, v66
    v_exp_f32 v67, v67
    v_mfma_f32_32x32x4_2b_bf16 v[96:127], v[34:35], v[16:17], 0 cbsz:1 abid:1
    v_exp_f32 v68, v68
    v_exp_f32 v69, v69
    v_exp_f32 v70, v70
    v_exp_f32 v71, v71
    v_exp_f32 v72, v72
    v_exp_f32 v73, v73
    v_exp_f32 v74, v74
    v_exp_f32 v75, v75
    v_smfmac_f32_32x32x32_bf16 v[128:143], v[36:39], v[64:71], v7
    s_barrier
    v_exp_f32 v76, v76
    v_exp_f32 v77, v77
    v_exp_f32 v78, v78
    v_exp_f32 v79, v79
    s_waitcnt lgkmcnt(0)
    s_mov_b64 exec, s[48:49]
    ds_read_b128 v[44:47], v6 offset:32512
    ds_read_b128 v[48:51], v6 offset:33152
    s_mov_b64 exec, -1
    ds_read_b64 v[32:33], v5 offset:33792
    v_smfmac_f32_32x32x32_bf16 v[128:143], v[40:43], v[72:79], v7
    s_setprio 3
    s_waitcnt vmcnt(8)
    ds_read_b64_tr_b16 v[168:169], v164 offset:0
    ds_read_b64_tr_b16 v[170:171], v164 offset:512
    v_exp_f32 v80, v80
    v_exp_f32 v81, v81
    v_exp_f32 v82, v82
    v_exp_f32 v83, v83
    v_mfma_f32_32x32x16_bf16 v[96:111], v[28:31], v[8:11], v[96:111]
    ds_read_b64_tr_b16 v[172:173], v164 offset:32
    ds_read_b64_tr_b16 v[174:175], v164 offset:544
    v_exp_f32 v84, v84
    v_exp_f32 v85, v85
    v_exp_f32 v86, v86
    v_exp_f32 v87, v87
    v_mfma_f32_32x32x16_bf16 v[112:127], v[28:31], v[12:15], v[112:127]
    ds_read_b64_tr_b16 v[176:177], v164 offset:64
    ds_read_b64_tr_b16 v[178:179], v164 offset:576
    v_exp_f32 v88, v88
    v_exp_f32 v89, v89
    v_exp_f32 v90, v90
    v_exp_f32 v91, v91
    v_smfmac_f32_32x32x32_bf16 v[144:159], v[36:39], v[80:87], v7
    ds_read_b64_tr_b16 v[180:181], v164 offset:96
    ds_read_b64_tr_b16 v[182:183], v164 offset:608
    v_exp_f32 v92, v92
    v_exp_f32 v93, v93
    v_exp_f32 v94, v94
    v_exp_f32 v95, v95
    s_waitcnt lgkmcnt(0)
    ds_read_b128 v[24:27], v4 offset:33792
    v_smfmac_f32_32x32x32_bf16 v[144:159], v[40:43], v[88:95], v7
    buffer_store_dwordx4 v[168:171], v2, s[24:27], s58 offen sc1
    v_exp_f32 v96, v96
    v_exp_f32 v97, v97
    v_exp_f32 v98, v98
    v_exp_f32 v99, v99
    v_mfma_f32_32x32x4_2b_bf16 v[64:95], v[32:33], v[16:17], 0 cbsz:1 abid:0
    v_exp_f32 v100, v100
    v_exp_f32 v101, v101
    v_exp_f32 v102, v102
    v_exp_f32 v103, v103
    v_exp_f32 v104, v104
    v_exp_f32 v105, v105
    v_exp_f32 v106, v106
    v_exp_f32 v107, v107
    v_smfmac_f32_32x32x32_bf16 v[128:143], v[44:47], v[96:103], v7
    v_exp_f32 v108, v108
    v_exp_f32 v109, v109
    v_exp_f32 v110, v110
    v_exp_f32 v111, v111
    s_waitcnt lgkmcnt(0)
    s_mov_b64 exec, s[48:49]
    ds_read_b128 v[36:39], v6 offset:39936
    ds_read_b128 v[40:43], v6 offset:40576
    s_mov_b64 exec, -1
    v_smfmac_f32_32x32x32_bf16 v[128:143], v[48:51], v[104:111], v7
    s_setprio 2
    buffer_store_dwordx4 v[172:175], v2, s[24:27], s59 offen sc1
    v_exp_f32 v112, v112
    v_exp_f32 v113, v113
    v_exp_f32 v114, v114
    v_exp_f32 v115, v115
    v_mfma_f32_32x32x16_bf16 v[64:79], v[24:27], v[8:11], v[64:79]
    v_mfma_f32_16x16x32_bf16 v[184:187], v[238:241], v[168:171], 0
    v_exp_f32 v116, v116
    v_exp_f32 v117, v117
    v_exp_f32 v118, v118
    v_exp_f32 v119, v119
    v_mfma_f32_32x32x16_bf16 v[80:95], v[24:27], v[12:15], v[80:95]
    v_mfma_f32_16x16x32_bf16 v[188:191], v[238:241], v[172:175], 0
    v_exp_f32 v120, v120
    v_exp_f32 v121, v121
    v_exp_f32 v122, v122
    v_exp_f32 v123, v123
    v_smfmac_f32_32x32x32_bf16 v[144:159], v[44:47], v[112:119], v7
    v_mfma_f32_16x16x32_bf16 v[192:195], v[238:241], v[176:179], 0
    v_exp_f32 v124, v124
    v_exp_f32 v125, v125
    v_exp_f32 v126, v126
    v_exp_f32 v127, v127
    s_waitcnt lgkmcnt(0)
    ds_read_b128 v[28:31], v4 offset:34304
    ds_read_b64 v[34:35], v5 offset:34816
    v_smfmac_f32_32x32x32_bf16 v[144:159], v[48:51], v[120:127], v7
    v_mfma_f32_16x16x32_bf16 v[196:199], v[238:241], v[180:183], 0
    v_exp_f32 v64, v64
    v_exp_f32 v65, v65
    v_exp_f32 v66, v66
    v_exp_f32 v67, v67
    v_mfma_f32_32x32x4_2b_bf16 v[96:127], v[32:33], v[16:17], 0 cbsz:1 abid:1
    buffer_store_dwordx4 v[176:179], v2, s[24:27], s60 offen sc1
    v_exp_f32 v68, v68
    v_exp_f32 v69, v69
    v_exp_f32 v70, v70
    v_exp_f32 v71, v71
    v_exp_f32 v72, v72
    v_exp_f32 v73, v73
    v_exp_f32 v74, v74
    v_exp_f32 v75, v75
    v_smfmac_f32_32x32x32_bf16 v[128:143], v[36:39], v[64:71], v7
    v_exp_f32 v76, v76
    v_exp_f32 v77, v77
    v_exp_f32 v78, v78
    v_exp_f32 v79, v79
    s_waitcnt lgkmcnt(0)
    s_mov_b64 exec, s[48:49]
    ds_read_b128 v[44:47], v6 offset:41216
    ds_read_b128 v[48:51], v6 offset:41856
    s_mov_b64 exec, -1
    v_smfmac_f32_32x32x32_bf16 v[128:143], v[40:43], v[72:79], v7
    s_setprio 1
    buffer_store_dwordx4 v[180:183], v2, s[24:27], s61 offen sc1
    v_exp_f32 v80, v80
    v_exp_f32 v81, v81
    v_exp_f32 v82, v82
    v_exp_f32 v83, v83
    v_mfma_f32_32x32x16_bf16 v[96:111], v[28:31], v[8:11], v[96:111]
    v_mov_b32_dpp v184, v188 quad_perm:[0,1,2,3] row_mask:0x2 bank_mask:0xf
    v_exp_f32 v84, v84
    v_exp_f32 v85, v85
    v_exp_f32 v86, v86
    v_exp_f32 v87, v87
    v_mfma_f32_32x32x16_bf16 v[112:127], v[28:31], v[12:15], v[112:127]
    v_mov_b32_dpp v184, v192 quad_perm:[0,1,2,3] row_mask:0x4 bank_mask:0xf
    v_exp_f32 v88, v88
    v_exp_f32 v89, v89
    v_exp_f32 v90, v90
    v_exp_f32 v91, v91
    v_smfmac_f32_32x32x32_bf16 v[144:159], v[36:39], v[80:87], v7
    v_mov_b32_dpp v184, v196 quad_perm:[0,1,2,3] row_mask:0x8 bank_mask:0xf
    v_exp_f32 v92, v92
    v_exp_f32 v93, v93
    v_exp_f32 v94, v94
    v_exp_f32 v95, v95
    s_waitcnt lgkmcnt(0)
    ds_read_b128 v[24:27], v4 offset:34816
    v_smfmac_f32_32x32x32_bf16 v[144:159], v[40:43], v[88:95], v7
    buffer_store_dword v184, v204, s[24:27], s100 offen sc1
    v_exp_f32 v96, v96
    v_exp_f32 v97, v97
    v_exp_f32 v98, v98
    v_exp_f32 v99, v99
    v_mfma_f32_32x32x4_2b_bf16 v[64:95], v[34:35], v[16:17], 0 cbsz:1 abid:0
    buffer_store_dwordx4 v[226:229], v224, s[24:27], 0 offen offset:0 sc1
    v_exp_f32 v100, v100
    v_exp_f32 v101, v101
    v_exp_f32 v102, v102
    v_exp_f32 v103, v103
    v_exp_f32 v104, v104
    v_exp_f32 v105, v105
    v_exp_f32 v106, v106
    v_exp_f32 v107, v107
    v_smfmac_f32_32x32x32_bf16 v[128:143], v[44:47], v[96:103], v7
    v_exp_f32 v108, v108
    v_exp_f32 v109, v109
    v_exp_f32 v110, v110
    v_exp_f32 v111, v111
    s_waitcnt lgkmcnt(0)
    s_mov_b64 exec, s[48:49]
    ds_read_b128 v[36:39], v6 offset:42496
    ds_read_b128 v[40:43], v6 offset:43136
    s_mov_b64 exec, -1
    v_smfmac_f32_32x32x32_bf16 v[128:143], v[48:51], v[104:111], v7
    s_setprio 0
    buffer_store_dwordx4 v[226:229], v224, s[24:27], 0 offen offset:896 sc1
    v_exp_f32 v112, v112
    v_exp_f32 v113, v113
    v_exp_f32 v114, v114
    v_exp_f32 v115, v115
    v_mfma_f32_32x32x16_bf16 v[64:79], v[24:27], v[8:11], v[64:79]
    v_exp_f32 v116, v116
    v_exp_f32 v117, v117
    v_exp_f32 v118, v118
    v_exp_f32 v119, v119
    v_mfma_f32_32x32x16_bf16 v[80:95], v[24:27], v[12:15], v[80:95]
    v_exp_f32 v120, v120
    v_exp_f32 v121, v121
    v_exp_f32 v122, v122
    v_exp_f32 v123, v123
    v_smfmac_f32_32x32x32_bf16 v[144:159], v[44:47], v[112:119], v7
    v_exp_f32 v124, v124
    v_exp_f32 v125, v125
    v_exp_f32 v126, v126
    v_exp_f32 v127, v127
    s_waitcnt lgkmcnt(0)
    ds_read_b128 v[28:31], v4 offset:35328
    v_smfmac_f32_32x32x32_bf16 v[144:159], v[48:51], v[120:127], v7
    v_exp_f32 v64, v64
    v_exp_f32 v65, v65
    v_exp_f32 v66, v66
    v_exp_f32 v67, v67
    v_mfma_f32_32x32x4_2b_bf16 v[96:127], v[34:35], v[16:17], 0 cbsz:1 abid:1
    v_exp_f32 v68, v68
    v_exp_f32 v69, v69
    v_exp_f32 v70, v70
    v_exp_f32 v71, v71
    v_exp_f32 v72, v72
    v_exp_f32 v73, v73
    v_exp_f32 v74, v74
    v_exp_f32 v75, v75
    v_smfmac_f32_32x32x32_bf16 v[128:143], v[36:39], v[64:71], v7
    s_waitcnt vmcnt(12)
    s_barrier
    v_exp_f32 v76, v76
    v_exp_f32 v77, v77
    v_exp_f32 v78, v78
    v_exp_f32 v79, v79
    s_waitcnt lgkmcnt(0)
    s_mov_b64 exec, s[48:49]
    ds_read_b128 v[44:47], v6 offset:43776
    ds_read_b128 v[48:51], v6 offset:44416
    s_mov_b64 exec, -1
    ds_read_b64 v[32:33], v5 offset:0
    v_smfmac_f32_32x32x32_bf16 v[128:143], v[40:43], v[72:79], v7
    s_setprio 3
    s_add_u32 m0, s51, 11264
    v_exp_f32 v80, v80
    v_exp_f32 v81, v81
    v_exp_f32 v82, v82
    v_exp_f32 v83, v83
    v_mfma_f32_32x32x16_bf16 v[96:111], v[28:31], v[8:11], v[96:111]
    buffer_load_dwordx4 v160, s[24:27], s52 offen sc1 lds
    v_exp_f32 v84, v84
    v_exp_f32 v85, v85
    v_exp_f32 v86, v86
    v_exp_f32 v87, v87
    v_mfma_f32_32x32x16_bf16 v[112:127], v[28:31], v[12:15], v[112:127]
    s_add_u32 m0, s51, 12288
    v_exp_f32 v88, v88
    v_exp_f32 v89, v89
    v_exp_f32 v90, v90
    v_exp_f32 v91, v91
    v_smfmac_f32_32x32x32_bf16 v[144:159], v[36:39], v[80:87], v7
    buffer_load_dwordx4 v161, s[24:27], s52 offen sc1 lds
    v_exp_f32 v92, v92
    v_exp_f32 v93, v93
    v_exp_f32 v94, v94
    v_exp_f32 v95, v95
    s_waitcnt lgkmcnt(0)
    ds_read_b128 v[24:27], v4 offset:0
    v_smfmac_f32_32x32x32_bf16 v[144:159], v[40:43], v[88:95], v7
    s_add_u32 m0, s97, 11264
    v_exp_f32 v96, v96
    v_exp_f32 v97, v97
    v_exp_f32 v98, v98
    v_exp_f32 v99, v99
    v_mfma_f32_32x32x4_2b_bf16 v[64:95], v[32:33], v[16:17], 0 cbsz:1 abid:0
    buffer_load_dwordx4 v162, s[24:27], s52 offen sc1 lds
    s_add_u32 s52, s52, 163840
    v_exp_f32 v100, v100
    v_exp_f32 v101, v101
    v_exp_f32 v102, v102
    v_exp_f32 v103, v103
    v_exp_f32 v104, v104
    v_exp_f32 v105, v105
    v_exp_f32 v106, v106
    v_exp_f32 v107, v107
    v_smfmac_f32_32x32x32_bf16 v[128:143], v[44:47], v[96:103], v7
    s_add_u32 m0, s51, 22528
    v_exp_f32 v108, v108
    v_exp_f32 v109, v109
    v_exp_f32 v110, v110
    v_exp_f32 v111, v111
    s_waitcnt lgkmcnt(0)
    s_mov_b64 exec, s[48:49]
    ds_read_b128 v[36:39], v6 offset:6144
    ds_read_b128 v[40:43], v6 offset:6784
    s_mov_b64 exec, -1
    v_smfmac_f32_32x32x32_bf16 v[128:143], v[48:51], v[104:111], v7
    s_setprio 2
    buffer_load_dwordx4 v160, s[24:27], s52 offen sc1 lds
    v_exp_f32 v112, v112
    v_exp_f32 v113, v113
    v_exp_f32 v114, v114
    v_exp_f32 v115, v115
    v_mfma_f32_32x32x16_bf16 v[64:79], v[24:27], v[8:11], v[64:79]
    s_add_u32 m0, s51, 23552
    v_exp_f32 v116, v116
    v_exp_f32 v117, v117
    v_exp_f32 v118, v118
    v_exp_f32 v119, v119
    v_mfma_f32_32x32x16_bf16 v[80:95], v[24:27], v[12:15], v[80:95]
    buffer_load_dwordx4 v161, s[24:27], s52 offen sc1 lds
    v_exp_f32 v120, v120
    v_exp_f32 v121, v121
    v_exp_f32 v122, v122
    v_exp_f32 v123, v123
    v_smfmac_f32_32x32x32_bf16 v[144:159], v[44:47], v[112:119], v7
    s_add_u32 m0, s97, 22528
    v_exp_f32 v124, v124
    v_exp_f32 v125, v125
    v_exp_f32 v126, v126
    v_exp_f32 v127, v127
    s_waitcnt lgkmcnt(0)
    ds_read_b128 v[28:31], v4 offset:512
    ds_read_b64 v[34:35], v5 offset:1024
    v_smfmac_f32_32x32x32_bf16 v[144:159], v[48:51], v[120:127], v7
    buffer_load_dwordx4 v162, s[24:27], s52 offen sc1 lds
    s_add_u32 s52, s52, 163840
    v_exp_f32 v64, v64
    v_exp_f32 v65, v65
    v_exp_f32 v66, v66
    v_exp_f32 v67, v67
    v_mfma_f32_32x32x4_2b_bf16 v[96:127], v[32:33], v[16:17], 0 cbsz:1 abid:1
    v_exp_f32 v68, v68
    v_exp_f32 v69, v69
    v_exp_f32 v70, v70
    v_exp_f32 v71, v71
    v_exp_f32 v72, v72
    v_exp_f32 v73, v73
    v_exp_f32 v74, v74
    v_exp_f32 v75, v75
    v_smfmac_f32_32x32x32_bf16 v[128:143], v[36:39], v[64:71], v7
    v_exp_f32 v76, v76
    v_exp_f32 v77, v77
    v_exp_f32 v78, v78
    v_exp_f32 v79, v79
    s_waitcnt lgkmcnt(0)
    s_mov_b64 exec, s[48:49]
    ds_read_b128 v[44:47], v6 offset:7424
    ds_read_b128 v[48:51], v6 offset:8064
    s_mov_b64 exec, -1
    v_smfmac_f32_32x32x32_bf16 v[128:143], v[40:43], v[72:79], v7
    s_setprio 1
    v_exp_f32 v80, v80
    v_exp_f32 v81, v81
    v_exp_f32 v82, v82
    v_exp_f32 v83, v83
    v_mfma_f32_32x32x16_bf16 v[96:111], v[28:31], v[8:11], v[96:111]
    v_exp_f32 v84, v84
    v_exp_f32 v85, v85
    v_exp_f32 v86, v86
    v_exp_f32 v87, v87
    v_mfma_f32_32x32x16_bf16 v[112:127], v[28:31], v[12:15], v[112:127]
    v_exp_f32 v88, v88
    v_exp_f32 v89, v89
    v_exp_f32 v90, v90
    v_exp_f32 v91, v91
    v_smfmac_f32_32x32x32_bf16 v[144:159], v[36:39], v[80:87], v7
    v_exp_f32 v92, v92
    v_exp_f32 v93, v93
    v_exp_f32 v94, v94
    v_exp_f32 v95, v95
    s_waitcnt lgkmcnt(0)
    ds_read_b128 v[24:27], v4 offset:1024
    v_smfmac_f32_32x32x32_bf16 v[144:159], v[40:43], v[88:95], v7
    v_exp_f32 v96, v96
    v_exp_f32 v97, v97
    v_exp_f32 v98, v98
    v_exp_f32 v99, v99
    v_mfma_f32_32x32x4_2b_bf16 v[64:95], v[34:35], v[16:17], 0 cbsz:1 abid:0
    v_exp_f32 v100, v100
    v_exp_f32 v101, v101
    v_exp_f32 v102, v102
    v_exp_f32 v103, v103
    v_exp_f32 v104, v104
    v_exp_f32 v105, v105
    v_exp_f32 v106, v106
    v_exp_f32 v107, v107
    v_smfmac_f32_32x32x32_bf16 v[128:143], v[44:47], v[96:103], v7
    v_exp_f32 v108, v108
    v_exp_f32 v109, v109
    v_exp_f32 v110, v110
    v_exp_f32 v111, v111
    s_waitcnt lgkmcnt(0)
    s_mov_b64 exec, s[48:49]
    ds_read_b128 v[36:39], v6 offset:8704
    ds_read_b128 v[40:43], v6 offset:9344
    s_mov_b64 exec, -1
    v_smfmac_f32_32x32x32_bf16 v[128:143], v[48:51], v[104:111], v7
    s_setprio 0
    v_exp_f32 v112, v112
    v_exp_f32 v113, v113
    v_exp_f32 v114, v114
    v_exp_f32 v115, v115
    v_mfma_f32_32x32x16_bf16 v[64:79], v[24:27], v[8:11], v[64:79]
    v_exp_f32 v116, v116
    v_exp_f32 v117, v117
    v_exp_f32 v118, v118
    v_exp_f32 v119, v119
    v_mfma_f32_32x32x16_bf16 v[80:95], v[24:27], v[12:15], v[80:95]
    v_exp_f32 v120, v120
    v_exp_f32 v121, v121
    v_exp_f32 v122, v122
    v_exp_f32 v123, v123
    v_smfmac_f32_32x32x32_bf16 v[144:159], v[44:47], v[112:119], v7
    v_exp_f32 v124, v124
    v_exp_f32 v125, v125
    v_exp_f32 v126, v126
    v_exp_f32 v127, v127
    s_waitcnt lgkmcnt(0)
    ds_read_b128 v[28:31], v4 offset:1536
    v_smfmac_f32_32x32x32_bf16 v[144:159], v[48:51], v[120:127], v7
    v_exp_f32 v64, v64
    v_exp_f32 v65, v65
    v_exp_f32 v66, v66
    v_exp_f32 v67, v67
    v_mfma_f32_32x32x4_2b_bf16 v[96:127], v[34:35], v[16:17], 0 cbsz:1 abid:1
    v_exp_f32 v68, v68
    v_exp_f32 v69, v69
    v_exp_f32 v70, v70
    v_exp_f32 v71, v71
    v_exp_f32 v72, v72
    v_exp_f32 v73, v73
    v_exp_f32 v74, v74
    v_exp_f32 v75, v75
    v_smfmac_f32_32x32x32_bf16 v[128:143], v[36:39], v[64:71], v7
    s_waitcnt vmcnt(0)
    s_waitcnt vmcnt(0)
    s_barrier
    v_exp_f32 v76, v76
    v_exp_f32 v77, v77
    v_exp_f32 v78, v78
    v_exp_f32 v79, v79
    s_waitcnt lgkmcnt(0)
    s_mov_b64 exec, s[48:49]
    ds_read_b128 v[44:47], v6 offset:9984
    ds_read_b128 v[48:51], v6 offset:10624
    s_mov_b64 exec, -1
    ds_read_b64 v[32:33], v5 offset:11264
    v_smfmac_f32_32x32x32_bf16 v[128:143], v[40:43], v[72:79], v7
    s_setprio 3
    s_and_b64 exec, s[62:63], 1
    buffer_atomic_add v207, v206, s[24:27], 0 offen sc0 sc1
    s_mov_b64 exec, -1
    v_exp_f32 v80, v80
    v_exp_f32 v81, v81
    v_exp_f32 v82, v82
    v_exp_f32 v83, v83
    v_mfma_f32_32x32x16_bf16 v[96:111], v[28:31], v[8:11], v[96:111]
    s_add_u32 m0, s51, 33792
    v_exp_f32 v84, v84
    v_exp_f32 v85, v85
    v_exp_f32 v86, v86
    v_exp_f32 v87, v87
    v_mfma_f32_32x32x16_bf16 v[112:127], v[28:31], v[12:15], v[112:127]
    buffer_load_dwordx4 v160, s[24:27], s52 offen sc1 lds
    v_exp_f32 v88, v88
    v_exp_f32 v89, v89
    v_exp_f32 v90, v90
    v_exp_f32 v91, v91
    v_smfmac_f32_32x32x32_bf16 v[144:159], v[36:39], v[80:87], v7
    s_add_u32 m0, s51, 34816
    v_exp_f32 v92, v92
    v_exp_f32 v93, v93
    v_exp_f32 v94, v94
    v_exp_f32 v95, v95
    s_waitcnt lgkmcnt(0)
    ds_read_b128 v[24:27], v4 offset:11264
    v_smfmac_f32_32x32x32_bf16 v[144:159], v[40:43], v[88:95], v7
    buffer_load_dwordx4 v161, s[24:27], s52 offen sc1 lds
    v_exp_f32 v96, v96
    v_exp_f32 v97, v97
    v_exp_f32 v98, v98
    v_exp_f32 v99, v99
    v_mfma_f32_32x32x4_2b_bf16 v[64:95], v[32:33], v[16:17], 0 cbsz:1 abid:0
    s_add_u32 m0, s97, 33792
    v_exp_f32 v100, v100
    v_exp_f32 v101, v101
    v_exp_f32 v102, v102
    v_exp_f32 v103, v103
    v_exp_f32 v104, v104
    v_exp_f32 v105, v105
    v_exp_f32 v106, v106
    v_exp_f32 v107, v107
    v_smfmac_f32_32x32x32_bf16 v[128:143], v[44:47], v[96:103], v7
    buffer_load_dwordx4 v162, s[24:27], s52 offen sc1 lds
    s_add_u32 s52, s52, 163840
    v_exp_f32 v108, v108
    v_exp_f32 v109, v109
    v_exp_f32 v110, v110
    v_exp_f32 v111, v111
    s_waitcnt lgkmcnt(0)
    s_mov_b64 exec, s[48:49]
    ds_read_b128 v[36:39], v6 offset:17408
    ds_read_b128 v[40:43], v6 offset:18048
    s_mov_b64 exec, -1
    v_smfmac_f32_32x32x32_bf16 v[128:143], v[48:51], v[104:111], v7
    s_setprio 2
    v_exp_f32 v112, v112
    v_exp_f32 v113, v113
    v_exp_f32 v114, v114
    v_exp_f32 v115, v115
    v_mfma_f32_32x32x16_bf16 v[64:79], v[24:27], v[8:11], v[64:79]
    v_exp_f32 v116, v116
    v_exp_f32 v117, v117
    v_exp_f32 v118, v118
    v_exp_f32 v119, v119
    v_mfma_f32_32x32x16_bf16 v[80:95], v[24:27], v[12:15], v[80:95]
    v_exp_f32 v120, v120
    v_exp_f32 v121, v121
    v_exp_f32 v122, v122
    v_exp_f32 v123, v123
    v_smfmac_f32_32x32x32_bf16 v[144:159], v[44:47], v[112:119], v7
    v_exp_f32 v124, v124
    v_exp_f32 v125, v125
    v_exp_f32 v126, v126
    v_exp_f32 v127, v127
    s_waitcnt lgkmcnt(0)
    ds_read_b128 v[28:31], v4 offset:11776
    ds_read_b64 v[34:35], v5 offset:12288
    v_smfmac_f32_32x32x32_bf16 v[144:159], v[48:51], v[120:127], v7
    s_waitcnt vmcnt(3)
    v_cmp_eq_u32 vcc, 31, v207
    s_cmp_lg_u64 vcc, 0
    s_cselect_b64 exec, s[62:63], 0
    buffer_store_dword v213, v212, s[24:27], 0 offen sc1
    s_mov_b64 exec, -1
    v_exp_f32 v64, v64
    v_exp_f32 v65, v65
    v_exp_f32 v66, v66
    v_exp_f32 v67, v67
    v_mfma_f32_32x32x4_2b_bf16 v[96:127], v[32:33], v[16:17], 0 cbsz:1 abid:1
    v_exp_f32 v68, v68
    v_exp_f32 v69, v69
    v_exp_f32 v70, v70
    v_exp_f32 v71, v71
    v_exp_f32 v72, v72
    v_exp_f32 v73, v73
    v_exp_f32 v74, v74
    v_exp_f32 v75, v75
    v_smfmac_f32_32x32x32_bf16 v[128:143], v[36:39], v[64:71], v7
    v_exp_f32 v76, v76
    v_exp_f32 v77, v77
    v_exp_f32 v78, v78
    v_exp_f32 v79, v79
    s_waitcnt lgkmcnt(0)
    s_mov_b64 exec, s[48:49]
    ds_read_b128 v[44:47], v6 offset:18688
    ds_read_b128 v[48:51], v6 offset:19328
    s_mov_b64 exec, -1
    v_smfmac_f32_32x32x32_bf16 v[128:143], v[40:43], v[72:79], v7
    s_setprio 1
    v_exp_f32 v80, v80
    v_exp_f32 v81, v81
    v_exp_f32 v82, v82
    v_exp_f32 v83, v83
    v_mfma_f32_32x32x16_bf16 v[96:111], v[28:31], v[8:11], v[96:111]
    v_exp_f32 v84, v84
    v_exp_f32 v85, v85
    v_exp_f32 v86, v86
    v_exp_f32 v87, v87
    v_mfma_f32_32x32x16_bf16 v[112:127], v[28:31], v[12:15], v[112:127]
    v_exp_f32 v88, v88
    v_exp_f32 v89, v89
    v_exp_f32 v90, v90
    v_exp_f32 v91, v91
    v_smfmac_f32_32x32x32_bf16 v[144:159], v[36:39], v[80:87], v7
    v_exp_f32 v92, v92
    v_exp_f32 v93, v93
    v_exp_f32 v94, v94
    v_exp_f32 v95, v95
    s_waitcnt lgkmcnt(0)
    ds_read_b128 v[24:27], v4 offset:12288
    v_smfmac_f32_32x32x32_bf16 v[144:159], v[40:43], v[88:95], v7
    v_exp_f32 v96, v96
    v_exp_f32 v97, v97
    v_exp_f32 v98, v98
    v_exp_f32 v99, v99
    v_mfma_f32_32x32x4_2b_bf16 v[64:95], v[34:35], v[16:17], 0 cbsz:1 abid:0
    v_exp_f32 v100, v100
    v_exp_f32 v101, v101
    v_exp_f32 v102, v102
    v_exp_f32 v103, v103
    v_exp_f32 v104, v104
    v_exp_f32 v105, v105
    v_exp_f32 v106, v106
    v_exp_f32 v107, v107
    v_smfmac_f32_32x32x32_bf16 v[128:143], v[44:47], v[96:103], v7
    v_exp_f32 v108, v108
    v_exp_f32 v109, v109
    v_exp_f32 v110, v110
    v_exp_f32 v111, v111
    s_waitcnt lgkmcnt(0)
    s_mov_b64 exec, s[48:49]
    ds_read_b128 v[36:39], v6 offset:19968
    ds_read_b128 v[40:43], v6 offset:20608
    s_mov_b64 exec, -1
    v_smfmac_f32_32x32x32_bf16 v[128:143], v[48:51], v[104:111], v7
    s_setprio 0
    v_exp_f32 v112, v112
    v_exp_f32 v113, v113
    v_exp_f32 v114, v114
    v_exp_f32 v115, v115
    v_mfma_f32_32x32x16_bf16 v[64:79], v[24:27], v[8:11], v[64:79]
    v_exp_f32 v116, v116
    v_exp_f32 v117, v117
    v_exp_f32 v118, v118
    v_exp_f32 v119, v119
    v_mfma_f32_32x32x16_bf16 v[80:95], v[24:27], v[12:15], v[80:95]
    v_exp_f32 v120, v120
    v_exp_f32 v121, v121
    v_exp_f32 v122, v122
    v_exp_f32 v123, v123
    v_smfmac_f32_32x32x32_bf16 v[144:159], v[44:47], v[112:119], v7
    v_exp_f32 v124, v124
    v_exp_f32 v125, v125
    v_exp_f32 v126, v126
    v_exp_f32 v127, v127
    s_waitcnt lgkmcnt(0)
    ds_read_b128 v[28:31], v4 offset:12800
    v_smfmac_f32_32x32x32_bf16 v[144:159], v[48:51], v[120:127], v7
    s_mov_b64 exec, s[62:63]
    buffer_load_dword v201, v200, s[24:27], 0 offen sc1
    s_mov_b64 exec, -1
    v_exp_f32 v64, v64
    v_exp_f32 v65, v65
    v_exp_f32 v66, v66
    v_exp_f32 v67, v67
    v_mfma_f32_32x32x4_2b_bf16 v[96:127], v[34:35], v[16:17], 0 cbsz:1 abid:1
    v_exp_f32 v68, v68
    v_exp_f32 v69, v69
    v_exp_f32 v70, v70
    v_exp_f32 v71, v71
    v_exp_f32 v72, v72
    v_exp_f32 v73, v73
    v_exp_f32 v74, v74
    v_exp_f32 v75, v75
    v_smfmac_f32_32x32x32_bf16 v[128:143], v[36:39], v[64:71], v7
    s_barrier
    v_exp_f32 v76, v76
    v_exp_f32 v77, v77
    v_exp_f32 v78, v78
    v_exp_f32 v79, v79
    s_waitcnt lgkmcnt(0)
    s_mov_b64 exec, s[48:49]
    ds_read_b128 v[44:47], v6 offset:21248
    ds_read_b128 v[48:51], v6 offset:21888
    s_mov_b64 exec, -1
    ds_read_b64 v[32:33], v5 offset:22528
    v_smfmac_f32_32x32x32_bf16 v[128:143], v[40:43], v[72:79], v7
    s_setprio 3
    v_exp_f32 v80, v80
    v_exp_f32 v81, v81
    v_exp_f32 v82, v82
    v_exp_f32 v83, v83
    v_mfma_f32_32x32x16_bf16 v[96:111], v[28:31], v[8:11], v[96:111]
    v_exp_f32 v84, v84
    v_exp_f32 v85, v85
    v_exp_f32 v86, v86
    v_exp_f32 v87, v87
    v_mfma_f32_32x32x16_bf16 v[112:127], v[28:31], v[12:15], v[112:127]
    v_exp_f32 v88, v88
    v_exp_f32 v89, v89
    v_exp_f32 v90, v90
    v_exp_f32 v91, v91
    v_smfmac_f32_32x32x32_bf16 v[144:159], v[36:39], v[80:87], v7
    v_exp_f32 v92, v92
    v_exp_f32 v93, v93
    v_exp_f32 v94, v94
    v_exp_f32 v95, v95
    s_waitcnt lgkmcnt(0)
    ds_read_b128 v[24:27], v4 offset:22528
    v_smfmac_f32_32x32x32_bf16 v[144:159], v[40:43], v[88:95], v7
    v_exp_f32 v96, v96
    v_exp_f32 v97, v97
    v_exp_f32 v98, v98
    v_exp_f32 v99, v99
    v_mfma_f32_32x32x4_2b_bf16 v[64:95], v[32:33], v[16:17], 0 cbsz:1 abid:0
    v_exp_f32 v100, v100
    v_exp_f32 v101, v101
    v_exp_f32 v102, v102
    v_exp_f32 v103, v103
    v_exp_f32 v104, v104
    v_exp_f32 v105, v105
    v_exp_f32 v106, v106
    v_exp_f32 v107, v107
    v_smfmac_f32_32x32x32_bf16 v[128:143], v[44:47], v[96:103], v7
    s_waitcnt vmcnt(0)
    v_cmp_le_u32 vcc, 1, v201
    s_cmp_eq_u64 vcc, -1
    s_cbranch_scc0 L2_cpwait
L2_cpback:
    s_barrier
    v_exp_f32 v108, v108
    v_exp_f32 v109, v109
    v_exp_f32 v110, v110
    v_exp_f32 v111, v111
    s_waitcnt lgkmcnt(0)
    s_mov_b64 exec, s[48:49]
    ds_read_b128 v[36:39], v6 offset:28672
    ds_read_b128 v[40:43], v6 offset:29312
    s_mov_b64 exec, -1
    v_smfmac_f32_32x32x32_bf16 v[128:143], v[48:51], v[104:111], v7
    s_setprio 2
    s_lshl_b32 s3, s42, 8
    s_add_u32 s3, s3, s2
    s_cmp_lt_u32 s3, 48
    s_cbranch_scc1 L2_cs0
L2_csb0:
    v_exp_f32 v112, v112
    v_exp_f32 v113, v113
    v_exp_f32 v114, v114
    v_exp_f32 v115, v115
    v_mfma_f32_32x32x16_bf16 v[64:79], v[24:27], v[8:11], v[64:79]
    buffer_load_dword v214, v203, s[24:27], 0 offen offset:0 sc1
    v_exp_f32 v116, v116
    v_exp_f32 v117, v117
    v_exp_f32 v118, v118
    v_exp_f32 v119, v119
    v_mfma_f32_32x32x16_bf16 v[80:95], v[24:27], v[12:15], v[80:95]
    v_exp_f32 v120, v120
    v_exp_f32 v121, v121
    v_exp_f32 v122, v122
    v_exp_f32 v123, v123
    v_smfmac_f32_32x32x32_bf16 v[144:159], v[44:47], v[112:119], v7
    v_exp_f32 v124, v124
    v_exp_f32 v125, v125
    v_exp_f32 v126, v126
    v_exp_f32 v127, v127
    s_waitcnt lgkmcnt(0)
    ds_read_b128 v[28:31], v4 offset:23040
    ds_read_b64 v[34:35], v5 offset:23552
    v_smfmac_f32_32x32x32_bf16 v[144:159], v[48:51], v[120:127], v7
    s_add_u32 m0, s10, 0
    s_mov_b32 s3, 0
    v_exp_f32 v64, v64
    v_exp_f32 v65, v65
    v_exp_f32 v66, v66
    v_exp_f32 v67, v67
    v_mfma_f32_32x32x4_2b_bf16 v[96:127], v[32:33], v[16:17], 0 cbsz:1 abid:1
    buffer_load_dwordx4 v205, s[24:27], s3 offen sc1 lds
    v_exp_f32 v68, v68
    v_exp_f32 v69, v69
    v_exp_f32 v70, v70
    v_exp_f32 v71, v71
    v_exp_f32 v72, v72
    v_exp_f32 v73, v73
    v_exp_f32 v74, v74
    v_exp_f32 v75, v75
    v_smfmac_f32_32x32x32_bf16 v[128:143], v[36:39], v[64:71], v7
    v_exp_f32 v76, v76
    v_exp_f32 v77, v77
    v_exp_f32 v78, v78
    v_exp_f32 v79, v79
    s_waitcnt lgkmcnt(0)
    s_mov_b64 exec, s[48:49]
    ds_read_b128 v[44:47], v6 offset:29952
    ds_read_b128 v[48:51], v6 offset:30592
    s_mov_b64 exec, -1
    v_smfmac_f32_32x32x32_bf16 v[128:143], v[40:43], v[72:79], v7
    s_setprio 1
    s_add_u32 m0, s10, 8192
    s_mov_b32 s3, 8192
    v_exp_f32 v80, v80
    v_exp_f32 v81, v81
    v_exp_f32 v82, v82
    v_exp_f32 v83, v83
    v_mfma_f32_32x32x16_bf16 v[96:111], v[28:31], v[8:11], v[96:111]
    buffer_load_dwordx4 v205, s[24:27], s3 offen sc1 lds
    v_exp_f32 v84, v84
    v_exp_f32 v85, v85
    v_exp_f32 v86, v86
    v_exp_f32 v87, v87
    v_mfma_f32_32x32x16_bf16 v[112:127], v[28:31], v[12:15], v[112:127]
    buffer_load_dword v215, v203, s[24:27], 0 offen offset:768 sc1
    v_exp_f32 v88, v88
    v_exp_f32 v89, v89
    v_exp_f32 v90, v90
    v_exp_f32 v91, v91
    v_smfmac_f32_32x32x32_bf16 v[144:159], v[36:39], v[80:87], v7
    v_exp_f32 v92, v92
    v_exp_f32 v93, v93
    v_exp_f32 v94, v94
    v_exp_f32 v95, v95
    s_waitcnt lgkmcnt(0)
    ds_read_b128 v[24:27], v4 offset:23552
    v_smfmac_f32_32x32x32_bf16 v[144:159], v[40:43], v[88:95], v7
    s_add_u32 m0, s10, 16384
    s_mov_b32 s3, 16384
    v_exp_f32 v96, v96
    v_exp_f32 v97, v97
    v_exp_f32 v98, v98
    v_exp_f32 v99, v99
    v_mfma_f32_32x32x4_2b_bf16 v[64:95], v[34:35], v[16:17], 0 cbsz:1 abid:0
    buffer_load_dwordx4 v205, s[24:27], s3 offen sc1 lds
    v_exp_f32 v100, v100
    v_exp_f32 v101, v101
    v_exp_f32 v102, v102
    v_exp_f32 v103, v103
    v_exp_f32 v104, v104
    v_exp_f32 v105, v105
    v_exp_f32 v106, v106
    v_exp_f32 v107, v107
    v_smfmac_f32_32x32x32_bf16 v[128:143], v[44:47], v[96:103], v7
    v_exp_f32 v108, v108
    v_exp_f32 v109, v109
    v_exp_f32 v110, v110
    v_exp_f32 v111, v111
    s_waitcnt lgkmcnt(0)
    s_mov_b64 exec, s[48:49]
    ds_read_b128 v[36:39], v6 offset:31232
    ds_read_b128 v[40:43], v6 offset:31872
    s_mov_b64 exec, -1
    v_smfmac_f32_32x32x32_bf16 v[128:143], v[48:51], v[104:111], v7
    s_setprio 0
    s_add_u32 m0, s10, 24576
    s_mov_b32 s3, 24576
    v_exp_f32 v112, v112
    v_exp_f32 v113, v113
    v_exp_f32 v114, v114
    v_exp_f32 v115, v115
    v_mfma_f32_32x32x16_bf16 v[64:79], v[24:27], v[8:11], v[64:79]
    buffer_load_dwordx4 v205, s[24:27], s3 offen sc1 lds
    v_exp_f32 v116, v116
    v_exp_f32 v117, v117
    v_exp_f32 v118, v118
    v_exp_f32 v119, v119
    v_mfma_f32_32x32x16_bf16 v[80:95], v[24:27], v[12:15], v[80:95]
    buffer_load_dword v216, v203, s[24:27], 0 offen offset:1536 sc1
    v_exp_f32 v120, v120
    v_exp_f32 v121, v121
    v_exp_f32 v122, v122
    v_exp_f32 v123, v123
    v_smfmac_f32_32x32x32_bf16 v[144:159], v[44:47], v[112:119], v7
    v_exp_f32 v124, v124
    v_exp_f32 v125, v125
    v_exp_f32 v126, v126
    v_exp_f32 v127, v127
    s_waitcnt lgkmcnt(0)
    ds_read_b128 v[28:31], v4 offset:24064
    v_smfmac_f32_32x32x32_bf16 v[144:159], v[48:51], v[120:127], v7
    s_add_u32 m0, s10, 32768
    s_mov_b32 s3, 32768
    v_exp_f32 v64, v64
    v_exp_f32 v65, v65
    v_exp_f32 v66, v66
    v_exp_f32 v67, v67
    v_mfma_f32_32x32x4_2b_bf16 v[96:127], v[34:35], v[16:17], 0 cbsz:1 abid:1
    buffer_load_dwordx4 v205, s[24:27], s3 offen sc1 lds
    v_exp_f32 v68, v68
    v_exp_f32 v69, v69
    v_exp_f32 v70, v70
    v_exp_f32 v71, v71
    v_exp_f32 v72, v72
    v_exp_f32 v73, v73
    v_exp_f32 v74, v74
    v_exp_f32 v75, v75
    v_smfmac_f32_32x32x32_bf16 v[128:143], v[36:39], v[64:71], v7
    s_waitcnt vmcnt(10)
    s_barrier
    v_exp_f32 v76, v76
    v_exp_f32 v77, v77
    v_exp_f32 v78, v78
    v_exp_f32 v79, v79
    s_waitcnt lgkmcnt(0)
    s_mov_b64 exec, s[48:49]
    ds_read_b128 v[44:47], v6 offset:32512
    ds_read_b128 v[48:51], v6 offset:33152
    s_mov_b64 exec, -1
    ds_read_b64 v[32:33], v5 offset:33792
    v_smfmac_f32_32x32x32_bf16 v[128:143], v[40:43], v[72:79], v7
    s_setprio 3
    s_add_u32 m0, s10, 40960
    s_mov_b32 s3, 40960
    v_exp_f32 v80, v80
    v_exp_f32 v81, v81
    v_exp_f32 v82, v82
    v_exp_f32 v83, v83
    v_mfma_f32_32x32x16_bf16 v[96:111], v[28:31], v[8:11], v[96:111]
    buffer_load_dwordx4 v205, s[24:27], s3 offen sc1 lds
    v_exp_f32 v84, v84
    v_exp_f32 v85, v85
    v_exp_f32 v86, v86
    v_exp_f32 v87, v87
    v_mfma_f32_32x32x16_bf16 v[112:127], v[28:31], v[12:15], v[112:127]
    s_lshl_b32 s3, s42, 8
    s_add_u32 s3, s3, s2
    s_cmp_lt_u32 s3, 48
    s_cbranch_scc1 L2_cs1
L2_csb1:
    v_exp_f32 v88, v88
    v_exp_f32 v89, v89
    v_exp_f32 v90, v90
    v_exp_f32 v91, v91
    v_smfmac_f32_32x32x32_bf16 v[144:159], v[36:39], v[80:87], v7
    s_mul_i32 s98, s44, 11264
    s_sub_u32 s98, s98, 30720
    v_add_u32 v211, s98, v205
    v_exp_f32 v92, v92
    v_exp_f32 v93, v93
    v_exp_f32 v94, v94
    v_exp_f32 v95, v95
    s_waitcnt lgkmcnt(0)
    ds_read_b128 v[24:27], v4 offset:33792
    v_smfmac_f32_32x32x32_bf16 v[144:159], v[40:43], v[88:95], v7
    s_lshl_b32 s99, s43, 10
    s_add_u32 s99, s99, s50
    s_add_u32 m0, s99, 12288
    v_exp_f32 v96, v96
    v_exp_f32 v97, v97
    v_exp_f32 v98, v98
    v_exp_f32 v99, v99
    v_mfma_f32_32x32x4_2b_bf16 v[64:95], v[32:33], v[16:17], 0 cbsz:1 abid:0
    buffer_load_dwordx4 v211, s[24:27], 0 offen sc1 lds
    v_exp_f32 v100, v100
    v_exp_f32 v101, v101
    v_exp_f32 v102, v102
    v_exp_f32 v103, v103
    v_exp_f32 v104, v104
    v_exp_f32 v105, v105
    v_exp_f32 v106, v106
    v_exp_f32 v107, v107
    v_smfmac_f32_32x32x32_bf16 v[128:143], v[44:47], v[96:103], v7
    buffer_load_dword v217, v203, s[24:27], 0 offen offset:2304 sc1
    v_exp_f32 v108, v108
    v_exp_f32 v109, v109
    v_exp_f32 v110, v110
    v_exp_f32 v111, v111
    s_waitcnt lgkmcnt(0)
    s_mov_b64 exec, s[48:49]
    ds_read_b128 v[36:39], v6 offset:39936
    ds_read_b128 v[40:43], v6 offset:40576
    s_mov_b64 exec, -1
    v_smfmac_f32_32x32x32_bf16 v[128:143], v[48:51], v[104:111], v7
    s_setprio 2
    s_add_u32 m0, s10, 49152
    s_mov_b32 s3, 49152
    v_exp_f32 v112, v112
    v_exp_f32 v113, v113
    v_exp_f32 v114, v114
    v_exp_f32 v115, v115
    v_mfma_f32_32x32x16_bf16 v[64:79], v[24:27], v[8:11], v[64:79]
    buffer_load_dwordx4 v205, s[24:27], s3 offen sc1 lds
    v_exp_f32 v116, v116
    v_exp_f32 v117, v117
    v_exp_f32 v118, v118
    v_exp_f32 v119, v119
    v_mfma_f32_32x32x16_bf16 v[80:95], v[24:27], v[12:15], v[80:95]
    s_add_u32 m0, s10, 57344
    s_mov_b32 s3, 57344
    v_exp_f32 v120, v120
    v_exp_f32 v121, v121
    v_exp_f32 v122, v122
    v_exp_f32 v123, v123
    v_smfmac_f32_32x32x32_bf16 v[144:159], v[44:47], v[112:119], v7
    buffer_load_dwordx4 v205, s[24:27], s3 offen sc1 lds
    v_exp_f32 v124, v124
    v_exp_f32 v125, v125
    v_exp_f32 v126, v126
    v_exp_f32 v127, v127
    s_waitcnt lgkmcnt(0)
    ds_read_b128 v[28:31], v4 offset:34304
    ds_read_b64 v[34:35], v5 offset:34816
    v_smfmac_f32_32x32x32_bf16 v[144:159], v[48:51], v[120:127], v7
    s_add_u32 m0, s99, 16384
    s_mov_b32 s3, 4096
    v_exp_f32 v64, v64
    v_exp_f32 v65, v65
    v_exp_f32 v66, v66
    v_exp_f32 v67, v67
    v_mfma_f32_32x32x4_2b_bf16 v[96:127], v[32:33], v[16:17], 0 cbsz:1 abid:1
    buffer_load_dwordx4 v211, s[24:27], s3 offen sc1 lds
    v_exp_f32 v68, v68
    v_exp_f32 v69, v69
    v_exp_f32 v70, v70
    v_exp_f32 v71, v71
    v_exp_f32 v72, v72
    v_exp_f32 v73, v73
    v_exp_f32 v74, v74
    v_exp_f32 v75, v75
    v_smfmac_f32_32x32x32_bf16 v[128:143], v[36:39], v[64:71], v7
    s_mov_b32 m0, s13
    v_exp_f32 v76, v76
    v_exp_f32 v77, v77
    v_exp_f32 v78, v78
    v_exp_f32 v79, v79
    s_waitcnt lgkmcnt(0)
    s_mov_b64 exec, s[48:49]
    ds_read_b128 v[44:47], v6 offset:41216
    ds_read_b128 v[48:51], v6 offset:41856
    s_mov_b64 exec, -1
    v_smfmac_f32_32x32x32_bf16 v[128:143], v[40:43], v[72:79], v7
    s_setprio 1
    buffer_load_dwordx4 v205, s[24:27], s12 offen sc1 lds
    v_exp_f32 v80, v80
    v_exp_f32 v81, v81
    v_exp_f32 v82, v82
    v_exp_f32 v83, v83
    v_mfma_f32_32x32x16_bf16 v[96:111], v[28:31], v[8:11], v[96:111]
    v_exp_f32 v84, v84
    v_exp_f32 v85, v85
    v_exp_f32 v86, v86
    v_exp_f32 v87, v87
    v_mfma_f32_32x32x16_bf16 v[112:127], v[28:31], v[12:15], v[112:127]
    v_exp_f32 v88, v88
    v_exp_f32 v89, v89
    v_exp_f32 v90, v90
    v_exp_f32 v91, v91
    v_smfmac_f32_32x32x32_bf16 v[144:159], v[36:39], v[80:87], v7
    v_exp_f32 v92, v92
    v_exp_f32 v93, v93
    v_exp_f32 v94, v94
    v_exp_f32 v95, v95
    s_waitcnt lgkmcnt(0)
    ds_read_b128 v[24:27], v4 offset:34816
    v_smfmac_f32_32x32x32_bf16 v[144:159], v[40:43], v[88:95], v7
    v_exp_f32 v96, v96
    v_exp_f32 v97, v97
    v_exp_f32 v98, v98
    v_exp_f32 v99, v99
    v_mfma_f32_32x32x4_2b_bf16 v[64:95], v[34:35], v[16:17], 0 cbsz:1 abid:0
    v_exp_f32 v100, v100
    v_exp_f32 v101, v101
    v_exp_f32 v102, v102
    v_exp_f32 v103, v103
    v_exp_f32 v104, v104
    v_exp_f32 v105, v105
    v_exp_f32 v106, v106
    v_exp_f32 v107, v107
    v_smfmac_f32_32x32x32_bf16 v[128:143], v[44:47], v[96:103], v7
    v_exp_f32 v108, v108
    v_exp_f32 v109, v109
    v_exp_f32 v110, v110
    v_exp_f32 v111, v111
    s_waitcnt lgkmcnt(0)
    s_mov_b64 exec, s[48:49]
    ds_read_b128 v[36:39], v6 offset:42496
    ds_read_b128 v[40:43], v6 offset:43136
    s_mov_b64 exec, -1
    v_smfmac_f32_32x32x32_bf16 v[128:143], v[48:51], v[104:111], v7
    s_setprio 0
    v_exp_f32 v112, v112
    v_exp_f32 v113, v113
    v_exp_f32 v114, v114
    v_exp_f32 v115, v115
    v_mfma_f32_32x32x16_bf16 v[64:79], v[24:27], v[8:11], v[64:79]
    v_exp_f32 v116, v116
    v_exp_f32 v117, v117
    v_exp_f32 v118, v118
    v_exp_f32 v119, v119
    v_mfma_f32_32x32x16_bf16 v[80:95], v[24:27], v[12:15], v[80:95]
    v_exp_f32 v120, v120
    v_exp_f32 v121, v121
    v_exp_f32 v122, v122
    v_exp_f32 v123, v123
    v_smfmac_f32_32x32x32_bf16 v[144:159], v[44:47], v[112:119], v7
    v_exp_f32 v124, v124
    v_exp_f32 v125, v125
    v_exp_f32 v126, v126
    v_exp_f32 v127, v127
    s_waitcnt lgkmcnt(0)
    ds_read_b128 v[28:31], v4 offset:35328
    v_smfmac_f32_32x32x32_bf16 v[144:159], v[48:51], v[120:127], v7
    v_exp_f32 v64, v64
    v_exp_f32 v65, v65
    v_exp_f32 v66, v66
    v_exp_f32 v67, v67
    v_mfma_f32_32x32x4_2b_bf16 v[96:127], v[34:35], v[16:17], 0 cbsz:1 abid:1
    v_exp_f32 v68, v68
    v_exp_f32 v69, v69
    v_exp_f32 v70, v70
    v_exp_f32 v71, v71
    v_exp_f32 v72, v72
    v_exp_f32 v73, v73
    v_exp_f32 v74, v74
    v_exp_f32 v75, v75
    v_smfmac_f32_32x32x32_bf16 v[128:143], v[36:39], v[64:71], v7
    s_barrier
    v_exp_f32 v76, v76
    v_exp_f32 v77, v77
    v_exp_f32 v78, v78
    v_exp_f32 v79, v79
    s_waitcnt lgkmcnt(0)
    s_mov_b64 exec, s[48:49]
    ds_read_b128 v[44:47], v6 offset:43776
    ds_read_b128 v[48:51], v6 offset:44416
    s_mov_b64 exec, -1
    v_smfmac_f32_32x32x32_bf16 v[128:143], v[40:43], v[72:79], v7
    s_setprio 2
    s_add_u32 m0, s99, 20480
    s_mov_b32 s3, 8192
    v_exp_f32 v80, v80
    v_exp_f32 v81, v81
    v_exp_f32 v82, v82
    v_exp_f32 v83, v83
    v_mfma_f32_32x32x16_bf16 v[96:111], v[28:31], v[8:11], v[96:111]
    buffer_load_dwordx4 v211, s[24:27], s3 offen sc1 lds
    v_exp_f32 v84, v84
    v_exp_f32 v85, v85
    v_exp_f32 v86, v86
    v_exp_f32 v87, v87
    v_mfma_f32_32x32x16_bf16 v[112:127], v[28:31], v[12:15], v[112:127]
    s_add_u32 m0, s99, 24576
    s_mov_b32 s3, 12288
    v_exp_f32 v88, v88
    v_exp_f32 v89, v89
    v_exp_f32 v90, v90
    v_exp_f32 v91, v91
    v_smfmac_f32_32x32x32_bf16 v[144:159], v[36:39], v[80:87], v7
    buffer_load_dwordx4 v211, s[24:27], s3 offen sc1 lds
    v_exp_f32 v92, v92
    v_exp_f32 v93, v93
    v_exp_f32 v94, v94
    v_exp_f32 v95, v95
    s_waitcnt lgkmcnt(0)
    s_nop 0
    v_smfmac_f32_32x32x32_bf16 v[144:159], v[40:43], v[88:95], v7
    s_setprio 1
    v_exp_f32 v96, v96
    v_exp_f32 v97, v97
    v_exp_f32 v98, v98
    v_exp_f32 v99, v99
    v_exp_f32 v100, v100
    v_exp_f32 v101, v101
    v_exp_f32 v102, v102
    v_exp_f32 v103, v103
    v_exp_f32 v104, v104
    v_exp_f32 v105, v105
    v_exp_f32 v106, v106
    v_exp_f32 v107, v107
    v_smfmac_f32_32x32x32_bf16 v[128:143], v[44:47], v[96:103], v7
    v_exp_f32 v108, v108
    v_exp_f32 v109, v109
    v_exp_f32 v110, v110
    v_exp_f32 v111, v111
    s_waitcnt lgkmcnt(0)
    s_nop 0
    v_smfmac_f32_32x32x32_bf16 v[128:143], v[48:51], v[104:111], v7
    s_setprio 0
    v_exp_f32 v112, v112
    v_exp_f32 v113, v113
    v_exp_f32 v114, v114
    v_exp_f32 v115, v115
    v_exp_f32 v116, v116
    v_exp_f32 v117, v117
    v_exp_f32 v118, v118
    v_exp_f32 v119, v119
    v_exp_f32 v120, v120
    v_exp_f32 v121, v121
    v_exp_f32 v122, v122
    v_exp_f32 v123, v123
    v_smfmac_f32_32x32x32_bf16 v[144:159], v[44:47], v[112:119], v7
    v_exp_f32 v124, v124
    v_exp_f32 v125, v125
    v_exp_f32 v126, v126
    v_exp_f32 v127, v127
    s_waitcnt lgkmcnt(0)
    s_nop 0
    v_smfmac_f32_32x32x32_bf16 v[144:159], v[48:51], v[120:127], v7
L2_epi:
    s_setprio 0
    s_cmp_eq_u32 s44, 0
    s_cbranch_scc1 L2_np0
    s_setprio 2
L2_np0:
    s_nop 8
    ds_write_b128 v56, v[152:155] offset:2048
    ds_write_b128 v56, v[144:147] offset:0
    ds_write_b128 v56, v[148:151] offset:1024
    s_waitcnt vmcnt(0) lgkmcnt(0)
    s_barrier
    ds_read_b128 v[72:75], v59 offset:2048
    ds_read_b128 v[64:67], v59 offset:0
    ds_read_b128 v[68:71], v59 offset:1024
    s_waitcnt lgkmcnt(2)
    v_add_f32 v140, v136, v72
    v_add_f32 v141, v136, v72
    s_nop 1
    v_permlane32_swap_b32 v141, v140
    v_rcp_f32 v142, v140
    s_waitcnt lgkmcnt(0)
    v_pk_add_f32 v[128:129], v[128:129], v[64:65]
    v_pk_add_f32 v[130:131], v[130:131], v[66:67]
    v_pk_add_f32 v[132:133], v[132:133], v[68:69]
    v_pk_add_f32 v[134:135], v[134:135], v[70:71]
    v_pk_add_f32 v[136:137], v[136:137], v[72:73]
    v_pk_add_f32 v[138:139], v[138:139], v[74:75]
    v_pk_mul_f32 v[128:129], v[128:129], v[142:143] op_sel_hi:[1,0]
    v_pk_mul_f32 v[130:131], v[130:131], v[142:143] op_sel_hi:[1,0]
    v_pk_mul_f32 v[132:133], v[132:133], v[142:143] op_sel_hi:[1,0]
    v_pk_mul_f32 v[134:135], v[134:135], v[142:143] op_sel_hi:[1,0]
    v_pk_mul_f32 v[136:137], v[136:137], v[142:143] op_sel_hi:[1,0]
    v_pk_mul_f32 v[138:139], v[138:139], v[142:143] op_sel_hi:[1,0]
    v_pk_mul_f32 v[72:73], v[128:129], 0 op_sel_hi:[1,0]
    v_pk_fma_f32 v[72:73], v[130:131], 0, v[72:73] op_sel_hi:[1,0,1]
    v_pk_fma_f32 v[72:73], v[132:133], 0, v[72:73] op_sel_hi:[1,0,1]
    v_pk_fma_f32 v[72:73], v[134:135], 0, v[72:73] op_sel_hi:[1,0,1]
    v_pk_fma_f32 v[72:73], v[136:137], 0, v[72:73] op_sel_hi:[1,0,1]
    v_pk_fma_f32 v[72:73], v[138:139], 0, v[72:73] op_sel_hi:[1,0,1]
    s_mov_b32 s3, 0x2b800000
    v_cmp_nle_f32 vcc, s3, v140
    v_cmp_u_f32 s[14:15], v72, v73
    s_mov_b32 s3, 0x53800000
    s_or_b64 s[14:15], s[14:15], vcc
    v_cmp_nge_f32 vcc, s3, v140
    v_cvt_pk_bf16_f32 v64, v128, v129
    v_cvt_pk_bf16_f32 v65, v130, v131
    v_cvt_pk_bf16_f32 v66, v132, v133
    v_cvt_pk_bf16_f32 v67, v134, v135
    v_cvt_pk_bf16_f32 v68, v136, v137
    v_cvt_pk_bf16_f32 v69, v138, v139
    v_min_u32 v64, -2, v64
    v_min_u32 v68, -2, v68
    s_or_b64 s[14:15], s[14:15], vcc
    s_cselect_b32 s3, 1, 0
    s_cselect_b32 s14, 0, -1
    s_cmp_lg_u32 s45, 0
    s_cmov_b32 s14, s55
    s_not_b32 s55, s14
    s_mov_b32 exec_lo, s14
    s_mov_b32 exec_hi, s14
    buffer_store_dwordx4 v[64:67], v58, s[24:27], 0 offen sc1
    s_mov_b32 exec_hi, 0
    buffer_store_dwordx2 v[68:69], v57, s[24:27], 0 offen sc1
    s_mov_b64 exec, -1
    v_mov_b32 v61, s3
    s_lshl_b32 s3, s42, 2
    v_mov_b32 v60, s3
    ds_write_b32 v60, v61 offset:29696
    v_and_b32 v60, 28, v204
    s_waitcnt lgkmcnt(0)
    s_barrier
    ds_read_b32 v61, v60 offset:29696
    s_waitcnt lgkmcnt(0)
    v_cmp_ne_u32 vcc, 0, v61
    s_cmp_eq_u64 vcc, 0
    s_cbranch_scc0 L2_bad
L2_done:
    s_lshl_b32 s47, s56, 2
    s_add_u32 s47, s47, s43
    v_lshrrev_b32 v7, 4, v0
    v_and_b32 v8, 15, v0
    s_mul_i32 s3, s44, 35840
    s_add_u32 s3, s3, 90112
    v_add_u32 v4, s3, v2
    s_mul_i32 s3, s44, 45056
    s_add_u32 s3, s3, 12288
    v_add_u32 v5, s3, v2
    s_and_b32 s3, s2, 3
    s_lshl_b32 s3, s3, 2
    s_bfe_u32 s14, s2, 0x20003
    s_add_u32 s40, s3, s14
    s_bfe_u32 s3, s2, 0x10002
    s_lshl_b32 s3, s3, 3
    s_lshr_b32 s14, s2, 5
    s_add_u32 s41, s3, s14
    s_mul_i32 s51, s47, 20480
    s_mul_i32 s3, s57, 2560
    s_add_u32 s51, s51, s3
    v_and_b32 v153, 1, v7
    v_lshlrev_b32 v153, 9, v153
    v_lshrrev_b32 v154, 1, v7
    v_lshl_add_u32 v153, v154, 8, v153
    v_lshl_add_u32 v153, v8, 4, v153
    s_lshl_b32 s52, s47, 10
    s_lshl_b32 s3, s57, 7
    s_add_u32 s52, s52, s3
    s_add_u32 s52, s52, 11534336
    v_lshlrev_b32 v154, 3, v8
    s_mov_b32 s53, 0x3f803f80
    s_mul_i32 s3, s43, 5120
    s_cmp_ge_u32 s43, 2
    s_cselect_b32 s14, 30720, 0
    s_add_u32 s3, s3, s14
    v_add_u32 v152, s3, v2
    v_lshlrev_b32 v132, 16, v246
    v_and_b32 v133, 0xffff0000, v246
    v_lshlrev_b32 v134, 16, v247
    v_and_b32 v135, 0xffff0000, v247
    v_lshlrev_b32 v136, 16, v248
    v_and_b32 v137, 0xffff0000, v248
    v_lshlrev_b32 v138, 16, v249
    v_and_b32 v139, 0xffff0000, v249
    v_lshlrev_b32 v140, 16, v250
    v_and_b32 v141, 0xffff0000, v250
    v_lshlrev_b32 v142, 16, v251
    v_and_b32 v143, 0xffff0000, v251
    v_lshlrev_b32 v144, 16, v252
    v_and_b32 v145, 0xffff0000, v252
    v_lshlrev_b32 v146, 16, v253
    v_and_b32 v147, 0xffff0000, v253
    v_lshlrev_b32 v148, 16, v254
    v_and_b32 v149, 0xffff0000, v254
    v_lshlrev_b32 v150, 16, v255
    v_and_b32 v151, 0xffff0000, v255
    s_waitcnt vmcnt(0)
    s_barrier
    buffer_load_dwordx4 v[80:83], v230, s[24:27], 0 offen offset:0 sc1
    buffer_load_dwordx4 v[84:87], v230, s[24:27], 0 offen offset:1024 sc1
    buffer_load_dwordx4 v[88:91], v230, s[24:27], 0 offen offset:2048 sc1
    buffer_load_dwordx4 v[92:95], v230, s[24:27], 0 offen offset:3072 sc1
    buffer_load_dwordx4 v[96:99], v231, s[24:27], 0 offen offset:0 sc1
    buffer_load_dwordx4 v[100:103], v231, s[24:27], 0 offen offset:1024 sc1
    buffer_load_dwordx4 v[104:107], v231, s[24:27], 0 offen offset:2048 sc1
    buffer_load_dwordx4 v[108:111], v231, s[24:27], 0 offen offset:3072 sc1
    buffer_load_dwordx2 v[112:113], v232, s[24:27], 0 offen offset:0 sc1
    buffer_load_dwordx2 v[114:115], v232, s[24:27], 0 offen offset:128 sc1
    buffer_load_dwordx2 v[116:117], v232, s[24:27], 0 offen offset:1024 sc1
    buffer_load_dwordx2 v[118:119], v232, s[24:27], 0 offen offset:1152 sc1
    s_mov_b32 s14, 400000
    ds_read_b128 v[12:15], v4 offset:0
    ds_read_b128 v[16:19], v4 offset:1024
    ds_read_b128 v[20:23], v4 offset:2048
    ds_read_b128 v[24:27], v4 offset:3072
    ds_read_b128 v[28:31], v4 offset:4096
    ds_read_b128 v[32:35], v4 offset:5120
    ds_read_b128 v[36:39], v4 offset:6144
    ds_read_b128 v[40:43], v4 offset:7168
    ds_read_b128 v[44:47], v4 offset:8192
    ds_read_b128 v[48:51], v4 offset:9216
    s_waitcnt vmcnt(11)
    v_cmp_eq_u32 vcc, -1, v80
    s_cbranch_vccnz L3_retry0
L3_ok0:
    s_waitcnt lgkmcnt(5)
    v_mfma_f32_16x16x32_bf16 v[132:135], v[12:15], v[80:83], v[132:135]
    ds_read_b128 v[52:55], v4 offset:10240
    v_mfma_f32_16x16x32_bf16 v[136:139], v[16:19], v[80:83], v[136:139]
    s_waitcnt vmcnt(10)
    v_cmp_eq_u32 vcc, -1, v84
    ds_read_b128 v[56:59], v4 offset:11264
    v_mfma_f32_16x16x32_bf16 v[140:143], v[20:23], v[80:83], v[140:143]
    ds_read_b128 v[60:63], v4 offset:12288
    v_mfma_f32_16x16x32_bf16 v[144:147], v[24:27], v[80:83], v[144:147]
    ds_read_b128 v[64:67], v4 offset:13312
    v_mfma_f32_16x16x32_bf16 v[148:151], v[28:31], v[80:83], v[148:151]
    ds_read_b128 v[68:71], v4 offset:14336
    s_cbranch_vccnz L3_retry1
L3_ok1:
    s_waitcnt lgkmcnt(5)
    v_mfma_f32_16x16x32_bf16 v[132:135], v[32:35], v[84:87], v[132:135]
    ds_read_b128 v[12:15], v4 offset:15360
    v_mfma_f32_16x16x32_bf16 v[136:139], v[36:39], v[84:87], v[136:139]
    s_waitcnt vmcnt(9)
    v_cmp_eq_u32 vcc, -1, v88
    ds_read_b128 v[16:19], v4 offset:16384
    v_mfma_f32_16x16x32_bf16 v[140:143], v[40:43], v[84:87], v[140:143]
    ds_read_b128 v[20:23], v4 offset:17408
    v_mfma_f32_16x16x32_bf16 v[144:147], v[44:47], v[84:87], v[144:147]
    ds_read_b128 v[24:27], v4 offset:18432
    v_mfma_f32_16x16x32_bf16 v[148:151], v[48:51], v[84:87], v[148:151]
    ds_read_b128 v[28:31], v4 offset:19456
    s_cbranch_vccnz L3_retry2
L3_ok2:
    s_waitcnt lgkmcnt(5)
    v_mfma_f32_16x16x32_bf16 v[132:135], v[52:55], v[88:91], v[132:135]
    ds_read_b128 v[32:35], v4 offset:20480
    v_mfma_f32_16x16x32_bf16 v[136:139], v[56:59], v[88:91], v[136:139]
    s_waitcnt vmcnt(8)
    v_cmp_eq_u32 vcc, -1, v92
    ds_read_b128 v[36:39], v4 offset:21504
    v_mfma_f32_16x16x32_bf16 v[140:143], v[60:63], v[88:91], v[140:143]
    ds_read_b128 v[40:43], v4 offset:22528
    v_mfma_f32_16x16x32_bf16 v[144:147], v[64:67], v[88:91], v[144:147]
    ds_read_b128 v[44:47], v4 offset:23552
    v_mfma_f32_16x16x32_bf16 v[148:151], v[68:71], v[88:91], v[148:151]
    ds_read_b128 v[48:51], v4 offset:24576
    s_cbranch_vccnz L3_retry3
L3_ok3:
    s_waitcnt lgkmcnt(5)
    v_mfma_f32_16x16x32_bf16 v[132:135], v[12:15], v[92:95], v[132:135]
    ds_read_b128 v[52:55], v4 offset:25600
    v_mfma_f32_16x16x32_bf16 v[136:139], v[16:19], v[92:95], v[136:139]
    s_waitcnt vmcnt(7)
    v_cmp_eq_u32 vcc, -1, v96
    ds_read_b128 v[56:59], v4 offset:26624
    v_mfma_f32_16x16x32_bf16 v[140:143], v[20:23], v[92:95], v[140:143]
    ds_read_b128 v[60:63], v4 offset:27648
    v_mfma_f32_16x16x32_bf16 v[144:147], v[24:27], v[92:95], v[144:147]
    ds_read_b128 v[64:67], v4 offset:28672
    v_mfma_f32_16x16x32_bf16 v[148:151], v[28:31], v[92:95], v[148:151]
    ds_read_b128 v[68:71], v4 offset:29696
    s_cbranch_vccnz L3_retry4
L3_ok4:
    s_waitcnt lgkmcnt(5)
    v_mfma_f32_16x16x32_bf16 v[132:135], v[32:35], v[96:99], v[132:135]
    ds_read_b128 v[12:15], v4 offset:30720
    v_mfma_f32_16x16x32_bf16 v[136:139], v[36:39], v[96:99], v[136:139]
    s_waitcnt vmcnt(6)
    v_cmp_eq_u32 vcc, -1, v100
    ds_read_b128 v[16:19], v4 offset:31744
    v_mfma_f32_16x16x32_bf16 v[140:143], v[40:43], v[96:99], v[140:143]
    ds_read_b128 v[20:23], v4 offset:32768
    v_mfma_f32_16x16x32_bf16 v[144:147], v[44:47], v[96:99], v[144:147]
    ds_read_b128 v[24:27], v4 offset:33792
    v_mfma_f32_16x16x32_bf16 v[148:151], v[48:51], v[96:99], v[148:151]
    ds_read_b128 v[28:31], v4 offset:34816
    s_cbranch_vccnz L3_retry5
L3_ok5:
    s_waitcnt lgkmcnt(5)
    v_mfma_f32_16x16x32_bf16 v[132:135], v[52:55], v[100:103], v[132:135]
    ds_read_b128 v[32:35], v5 offset:0
    v_mfma_f32_16x16x32_bf16 v[136:139], v[56:59], v[100:103], v[136:139]
    s_waitcnt vmcnt(5)
    v_cmp_eq_u32 vcc, -1, v104
    ds_read_b128 v[36:39], v5 offset:1024
    v_mfma_f32_16x16x32_bf16 v[140:143], v[60:63], v[100:103], v[140:143]
    ds_read_b128 v[40:43], v5 offset:2048
    v_mfma_f32_16x16x32_bf16 v[144:147], v[64:67], v[100:103], v[144:147]
    ds_read_b128 v[44:47], v5 offset:3072
    v_mfma_f32_16x16x32_bf16 v[148:151], v[68:71], v[100:103], v[148:151]
    ds_read_b128 v[48:51], v5 offset:4096
    s_cbranch_vccnz L3_retry6
L3_ok6:
    s_waitcnt lgkmcnt(5)
    v_mfma_f32_16x16x32_bf16 v[132:135], v[12:15], v[104:107], v[132:135]
    ds_read_b128 v[52:55], v5 offset:5120
    v_mfma_f32_16x16x32_bf16 v[136:139], v[16:19], v[104:107], v[136:139]
    s_waitcnt vmcnt(4)
    v_cmp_eq_u32 vcc, -1, v108
    ds_read_b128 v[56:59], v5 offset:6144
    v_mfma_f32_16x16x32_bf16 v[140:143], v[20:23], v[104:107], v[140:143]
    ds_read_b128 v[60:63], v5 offset:7168
    v_mfma_f32_16x16x32_bf16 v[144:147], v[24:27], v[104:107], v[144:147]
    ds_read_b128 v[64:67], v5 offset:8192
    v_mfma_f32_16x16x32_bf16 v[148:151], v[28:31], v[104:107], v[148:151]
    ds_read_b128 v[68:71], v5 offset:9216
    s_cbranch_vccnz L3_retry7
L3_ok7:
    s_waitcnt lgkmcnt(5)
    v_mfma_f32_16x16x32_bf16 v[132:135], v[32:35], v[108:111], v[132:135]
    ds_read_b128 v[12:15], v5 offset:10240
    v_mfma_f32_16x16x32_bf16 v[136:139], v[36:39], v[108:111], v[136:139]
    s_waitcnt vmcnt(2)
    v_max_u32 v158, v112, v114
    v_cmp_eq_u32 vcc, -1, v158
    ds_read_b128 v[16:19], v5 offset:11264
    v_mfma_f32_16x16x32_bf16 v[140:143], v[40:43], v[108:111], v[140:143]
    ds_read_b128 v[20:23], v5 offset:12288
    v_mfma_f32_16x16x32_bf16 v[144:147], v[44:47], v[108:111], v[144:147]
    ds_read_b128 v[24:27], v5 offset:13312
    v_mfma_f32_16x16x32_bf16 v[148:151], v[48:51], v[108:111], v[148:151]
    ds_read_b128 v[28:31], v5 offset:14336
    s_cbranch_vccnz L3_retry8
L3_ok8:
    s_waitcnt lgkmcnt(5)
    v_mfma_f32_16x16x32_bf16 v[132:135], v[52:55], v[112:115], v[132:135]
    v_mfma_f32_16x16x32_bf16 v[136:139], v[56:59], v[112:115], v[136:139]
    s_waitcnt vmcnt(0)
    v_max_u32 v158, v116, v118
    v_cmp_eq_u32 vcc, -1, v158
    v_mfma_f32_16x16x32_bf16 v[140:143], v[60:63], v[112:115], v[140:143]
    v_mfma_f32_16x16x32_bf16 v[144:147], v[64:67], v[112:115], v[144:147]
    v_mfma_f32_16x16x32_bf16 v[148:151], v[68:71], v[112:115], v[148:151]
    s_cbranch_vccnz L3_retry9
L3_ok9:
    s_waitcnt lgkmcnt(0)
    v_mfma_f32_16x16x32_bf16 v[132:135], v[12:15], v[116:119], v[132:135]
    v_mfma_f32_16x16x32_bf16 v[136:139], v[16:19], v[116:119], v[136:139]
    v_mfma_f32_16x16x32_bf16 v[140:143], v[20:23], v[116:119], v[140:143]
    v_mfma_f32_16x16x32_bf16 v[144:147], v[24:27], v[116:119], v[144:147]
    v_mfma_f32_16x16x32_bf16 v[148:151], v[28:31], v[116:119], v[148:151]
    s_cmp_eq_u32 s44, 0
    s_cbranch_scc1 L3_fin
    s_nop 5
    ds_write_b128 v152, v[132:135] offset:0
    ds_write_b128 v152, v[136:139] offset:1024
    ds_write_b128 v152, v[140:143] offset:2048
    ds_write_b128 v152, v[144:147] offset:3072
    ds_write_b128 v152, v[148:151] offset:4096
    s_setprio 0
    s_mul_i32 s46, s43, 6144
    s_mul_i32 s47, s41, 245760
    s_add_u32 s47, s47, s46
    s_add_u32 s47, s47, 12861440
    v_add_u32 v4, s47, v2
    s_and_b32 s3, s41, 7
    s_mul_i32 s3, s3, 10
    s_lshr_b32 s3, s3, 3
    s_and_b32 s14, s40, 3
    s_mul_i32 s14, s14, 10
    s_lshr_b32 s14, s14, 2
    s_add_u32 s3, s3, s14
    s_cmp_ge_u32 s3, 10
    s_cselect_b32 s14, 10, 0
    s_sub_u32 s3, s3, s14
    s_mov_b32 s3, 0
    s_lshl_b32 s48, s3, 11
    s_mul_i32 s49, s3, 24576
    s_cmp_eq_u32 s43, 0
    s_cselect_b32 s62, 255, 0
    s_mov_b32 s63, 0
    v_add_u32 v206, 18432, v206
    v_mov_b32 v207, 1
    v_add_u32 v212, 18432, v212
    s_and_b32 s3, s2, 7
    s_lshl_b32 s3, s3, 11
    s_add_u32 s3, s3, 18862080
    v_and_b32 v200, 7, v0
    v_lshl_add_u32 v200, v200, 8, s3
    v_mov_b32 v201, 1
    s_and_b64 exec, s[62:63], 1
    buffer_atomic_add v207, v206, s[24:27], 0 offen sc0 sc1
    s_mov_b64 exec, -1
    s_waitcnt lgkmcnt(0)
    s_barrier
    s_add_u32 m0, s46, 16384
    s_add_u32 s3, s49, 0
    buffer_load_dwordx4 v4, s[24:27], s3 offen sc1 lds
    s_add_u32 m0, s46, 17408
    s_add_u32 s3, s49, 1024
    buffer_load_dwordx4 v4, s[24:27], s3 offen sc1 lds
    s_add_u32 m0, s46, 18432
    s_add_u32 s3, s49, 2048
    buffer_load_dwordx4 v4, s[24:27], s3 offen sc1 lds
    s_add_u32 m0, s46, 19456
    s_add_u32 s3, s49, 3072
    buffer_load_dwordx4 v4, s[24:27], s3 offen sc1 lds
    s_add_u32 m0, s46, 20480
    s_add_u32 s3, s49, 4096
    buffer_load_dwordx4 v4, s[24:27], s3 offen sc1 lds
    s_add_u32 m0, s46, 21504
    s_add_u32 s3, s49, 5120
    buffer_load_dwordx4 v4, s[24:27], s3 offen sc1 lds
    s_add_u32 s49, s49, 24576
    s_cmp_eq_u32 s49, 245760
    s_cmov_b32 s49, 0
    s_barrier
    s_branch L3_done
L3_fin:
    s_barrier
    ds_read_b128 v[12:15], v152 offset:0
    ds_read_b128 v[16:19], v152 offset:1024
    ds_read_b128 v[20:23], v152 offset:2048
    ds_read_b128 v[24:27], v152 offset:3072
    ds_read_b128 v[28:31], v152 offset:4096
    s_waitcnt lgkmcnt(4)
    v_pk_add_f32 v[132:133], v[132:133], v[12:13]
    v_pk_add_f32 v[134:135], v[134:135], v[14:15]
    v_cvt_pk_bf16_f32 v80, v132, v133
    v_cvt_pk_bf16_f32 v81, v134, v135
    s_waitcnt lgkmcnt(3)
    v_pk_add_f32 v[136:137], v[136:137], v[16:17]
    v_pk_add_f32 v[138:139], v[138:139], v[18:19]
    v_cvt_pk_bf16_f32 v82, v136, v137
    v_cvt_pk_bf16_f32 v83, v138, v139
    s_waitcnt lgkmcnt(2)
    v_pk_add_f32 v[140:141], v[140:141], v[20:21]
    v_pk_add_f32 v[142:143], v[142:143], v[22:23]
    v_cvt_pk_bf16_f32 v84, v140, v141
    v_cvt_pk_bf16_f32 v85, v142, v143
    s_waitcnt lgkmcnt(1)
    v_pk_add_f32 v[144:145], v[144:145], v[24:25]
    v_pk_add_f32 v[146:147], v[146:147], v[26:27]
    v_cvt_pk_bf16_f32 v86, v144, v145
    v_cvt_pk_bf16_f32 v87, v146, v147
    s_waitcnt lgkmcnt(0)
    v_pk_add_f32 v[148:149], v[148:149], v[28:29]
    v_pk_add_f32 v[150:151], v[150:151], v[30:31]
    v_cvt_pk_bf16_f32 v88, v148, v149
    v_cvt_pk_bf16_f32 v89, v150, v151
    v_mov_b32 v90, v88
    v_mov_b32 v91, v89
    v_permlane16_swap_b32 v80, v82
    v_permlane16_swap_b32 v81, v83
    v_and_b32 v80, v245, v80
    buffer_store_dwordx4 v[80:83], v153, s[24:27], s51 offen offset:0 sc1
    v_permlane16_swap_b32 v84, v86
    v_permlane16_swap_b32 v85, v87
    v_and_b32 v84, v245, v84
    buffer_store_dwordx4 v[84:87], v153, s[24:27], s51 offen offset:1024 sc1
    v_permlane16_swap_b32 v88, v90
    v_permlane16_swap_b32 v89, v91
    v_and_b32 v88, v245, v88
    s_mov_b32 exec_lo, 0xffff
    s_mov_b32 exec_hi, 0xffff
    buffer_store_dwordx4 v[88:91], v153, s[24:27], s51 offen offset:2048 sc1
    s_mov_b64 exec, -1
    s_barrier
    v_cvt_pk_bf16_f32 v246, v132, v133
    v_cvt_pk_bf16_f32 v247, v134, v135
    v_cvt_pk_bf16_f32 v248, v136, v137
    v_cvt_pk_bf16_f32 v249, v138, v139
    v_cvt_pk_bf16_f32 v250, v140, v141
    v_cvt_pk_bf16_f32 v251, v142, v143
    v_cvt_pk_bf16_f32 v252, v144, v145
    v_cvt_pk_bf16_f32 v253, v146, v147
    v_cvt_pk_bf16_f32 v254, v148, v149
    v_cvt_pk_bf16_f32 v255, v150, v151
    v_dot2_f32_bf16 v156, v80, s53, 0
    v_dot2_f32_bf16 v157, v80, v80, 0
    v_dot2_f32_bf16 v156, v81, s53, v156
    v_dot2_f32_bf16 v157, v81, v81, v157
    v_dot2_f32_bf16 v156, v82, s53, v156
    v_dot2_f32_bf16 v157, v82, v82, v157
    v_dot2_f32_bf16 v156, v83, s53, v156
    v_dot2_f32_bf16 v157, v83, v83, v157
    v_dot2_f32_bf16 v156, v84, s53, v156
    v_dot2_f32_bf16 v157, v84, v84, v157
    v_dot2_f32_bf16 v156, v85, s53, v156
    v_dot2_f32_bf16 v157, v85, v85, v157
    v_dot2_f32_bf16 v156, v86, s53, v156
    v_dot2_f32_bf16 v157, v86, v86, v157
    v_dot2_f32_bf16 v156, v87, s53, v156
    v_dot2_f32_bf16 v157, v87, v87, v157
    v_dot2_f32_bf16 v156, v254, s53, v156
    v_dot2_f32_bf16 v157, v254, v254, v157
    v_dot2_f32_bf16 v156, v255, s53, v156
    v_dot2_f32_bf16 v157, v255, v255, v157
    s_nop 2
    v_mov_b32 v158, v156
    v_mov_b32 v159, v157
    s_nop 1
    v_permlane32_swap_b32 v158, v156
    v_permlane32_swap_b32 v159, v157
    v_add_f32 v156, v156, v158
    v_add_f32 v157, v157, v159
    v_mov_b32 v158, v156
    v_mov_b32 v159, v157
    s_nop 1
    v_permlane16_swap_b32 v158, v156
    v_permlane16_swap_b32 v159, v157
    v_add_f32 v156, v156, v158
    v_add_f32 v157, v157, v159
    v_and_b32 v156, -2, v156
    s_mov_b32 exec_lo, 0xffff
    s_mov_b32 exec_hi, 0
    buffer_store_dwordx2 v[156:157], v154, s[24:27], s52 offen sc1
    s_mov_b64 exec, -1
L3_done:
    s_cmp_lt_u32 s42, 4
    s_cbranch_scc1 L4_compute
    s_lshl_b32 s3, s40, 2
    s_add_u32 s3, s3, s43
    s_mul_i32 s3, s3, 40960
    v_add_u32 v5, s3, v2
    s_lshl_b32 s47, s43, 11
    v_add_u32 v7, s47, v2
    v_add_u32 v8, 81920, v7
    s_mov_b32 s14, 400000
    s_add_u32 m0, s46, 57344
    s_add_u32 s3, s49, 0
    buffer_load_dwordx4 v4, s[24:27], s3 offen sc1 lds
    s_add_u32 m0, s46, 58368
    s_add_u32 s3, s49, 1024
    buffer_load_dwordx4 v4, s[24:27], s3 offen sc1 lds
    s_add_u32 m0, s46, 59392
    s_add_u32 s3, s49, 2048
    buffer_load_dwordx4 v4, s[24:27], s3 offen sc1 lds
    s_add_u32 m0, s46, 60416
    s_add_u32 s3, s49, 3072
    buffer_load_dwordx4 v4, s[24:27], s3 offen sc1 lds
    s_add_u32 m0, s46, 61440
    s_add_u32 s3, s49, 4096
    buffer_load_dwordx4 v4, s[24:27], s3 offen sc1 lds
    s_add_u32 m0, s46, 62464
    s_add_u32 s3, s49, 5120
    buffer_load_dwordx4 v4, s[24:27], s3 offen sc1 lds
    s_add_u32 s49, s49, 24576
    s_cmp_eq_u32 s49, 245760
    s_cmov_b32 s49, 0
    s_mov_b32 s58, s48
    s_add_u32 m0, s47, 0
    s_add_u32 s3, s58, 0
    buffer_load_dwordx4 v5, s[24:27], s3 offen sc1 lds
    s_add_u32 m0, s47, 1024
    s_add_u32 s3, s58, 20480
    buffer_load_dwordx4 v5, s[24:27], s3 offen sc1 lds
    s_add_u32 m0, s47, 8192
    s_add_u32 s3, s58, 1024
    buffer_load_dwordx4 v5, s[24:27], s3 offen sc1 lds
    s_add_u32 m0, s47, 9216
    s_add_u32 s3, s58, 21504
    buffer_load_dwordx4 v5, s[24:27], s3 offen sc1 lds
    s_add_u32 s48, s48, 2048
    s_cmp_eq_u32 s48, 20480
    s_cmov_b32 s48, 0
    s_add_u32 m0, s46, 98304
    s_add_u32 s3, s49, 0
    buffer_load_dwordx4 v4, s[24:27], s3 offen sc1 lds
    s_add_u32 m0, s46, 99328
    s_add_u32 s3, s49, 1024
    buffer_load_dwordx4 v4, s[24:27], s3 offen sc1 lds
    s_add_u32 m0, s46, 100352
    s_add_u32 s3, s49, 2048
    buffer_load_dwordx4 v4, s[24:27], s3 offen sc1 lds
    s_add_u32 m0, s46, 101376
    s_add_u32 s3, s49, 3072
    buffer_load_dwordx4 v4, s[24:27], s3 offen sc1 lds
    s_add_u32 m0, s46, 102400
    s_add_u32 s3, s49, 4096
    buffer_load_dwordx4 v4, s[24:27], s3 offen sc1 lds
    s_add_u32 m0, s46, 103424
    s_add_u32 s3, s49, 5120
    buffer_load_dwordx4 v4, s[24:27], s3 offen sc1 lds
    s_add_u32 s49, s49, 24576
    s_cmp_eq_u32 s49, 245760
    s_cmov_b32 s49, 0
    s_add_u32 m0, s46, 139264
    s_add_u32 s3, s49, 0
    buffer_load_dwordx4 v4, s[24:27], s3 offen sc1 lds
    s_add_u32 m0, s46, 140288
    s_add_u32 s3, s49, 1024
    buffer_load_dwordx4 v4, s[24:27], s3 offen sc1 lds
    s_add_u32 m0, s46, 141312
    s_add_u32 s3, s49, 2048
    buffer_load_dwordx4 v4, s[24:27], s3 offen sc1 lds
    s_add_u32 m0, s46, 142336
    s_add_u32 s3, s49, 3072
    buffer_load_dwordx4 v4, s[24:27], s3 offen sc1 lds
    s_add_u32 m0, s46, 143360
    s_add_u32 s3, s49, 4096
    buffer_load_dwordx4 v4, s[24:27], s3 offen sc1 lds
    s_add_u32 m0, s46, 144384
    s_add_u32 s3, s49, 5120
    buffer_load_dwordx4 v4, s[24:27], s3 offen sc1 lds
    s_add_u32 s49, s49, 24576
    s_cmp_eq_u32 s49, 245760
    s_cmov_b32 s49, 0
    s_mul_i32 s50, s43, 10240
    s_lshr_b32 s3, s43, 1
    s_mul_i32 s3, s3, 122880
    s_and_b32 s15, s43, 1
    s_mul_i32 s15, s15, 10240
    s_add_u32 s3, s3, s15
    s_mul_i32 s15, s57, 245760
    s_add_u32 s3, s3, s15
    s_add_u32 s3, s3, 16793600
    v_add_u32 v6, s3, v2
    s_lshl_b32 s51, s40, 2
    s_add_u32 s51, s51, s43
    s_lshl_b32 s51, s51, 11
    s_add_u32 s51, s51, 11534336
    v_add_u32 v9, s50, v2
    s_waitcnt vmcnt(12)
    ds_read_b32 v12, v7 offset:0
    ds_read_b32 v13, v7 offset:1024
    ds_read_b32 v14, v7 offset:8192
    ds_read_b32 v15, v7 offset:9216
    s_waitcnt lgkmcnt(0)
    v_or3_b32 v12, v12, v13, v14
    v_or_b32 v12, v12, v15
    v_and_b32 v12, v244, v12
    v_cmp_ne_u32 vcc, 0, v12
    s_cbranch_vccnz L4_retry0
L4_ok0:
    s_waitcnt vmcnt(12)
    s_barrier
    s_mov_b32 s59, s48
    s_add_u32 m0, s47, 40960
    s_add_u32 s3, s59, 0
    buffer_load_dwordx4 v5, s[24:27], s3 offen sc1 lds
    s_add_u32 m0, s47, 41984
    s_add_u32 s3, s59, 20480
    buffer_load_dwordx4 v5, s[24:27], s3 offen sc1 lds
    s_add_u32 m0, s47, 49152
    s_add_u32 s3, s59, 1024
    buffer_load_dwordx4 v5, s[24:27], s3 offen sc1 lds
    s_add_u32 m0, s47, 50176
    s_add_u32 s3, s59, 21504
    buffer_load_dwordx4 v5, s[24:27], s3 offen sc1 lds
    s_add_u32 s48, s48, 2048
    s_cmp_eq_u32 s48, 20480
    s_cmov_b32 s48, 0
    s_mov_b32 s60, s48
    s_add_u32 m0, s47, 81920
    s_add_u32 s3, s60, 0
    buffer_load_dwordx4 v5, s[24:27], s3 offen sc1 lds
    s_add_u32 m0, s47, 82944
    s_add_u32 s3, s60, 20480
    buffer_load_dwordx4 v5, s[24:27], s3 offen sc1 lds
    s_add_u32 m0, s47, 90112
    s_add_u32 s3, s60, 1024
    buffer_load_dwordx4 v5, s[24:27], s3 offen sc1 lds
    s_add_u32 m0, s47, 91136
    s_add_u32 s3, s60, 21504
    buffer_load_dwordx4 v5, s[24:27], s3 offen sc1 lds
    s_add_u32 s48, s48, 2048
    s_cmp_eq_u32 s48, 20480
    s_cmov_b32 s48, 0
    s_mov_b32 s61, s48
    s_add_u32 m0, s47, 122880
    s_add_u32 s3, s61, 0
    buffer_load_dwordx4 v5, s[24:27], s3 offen sc1 lds
    s_add_u32 m0, s47, 123904
    s_add_u32 s3, s61, 20480
    buffer_load_dwordx4 v5, s[24:27], s3 offen sc1 lds
    s_add_u32 m0, s47, 131072
    s_add_u32 s3, s61, 1024
    buffer_load_dwordx4 v5, s[24:27], s3 offen sc1 lds
    s_add_u32 m0, s47, 132096
    s_add_u32 s3, s61, 21504
    buffer_load_dwordx4 v5, s[24:27], s3 offen sc1 lds
    s_add_u32 s48, s48, 2048
    s_cmp_eq_u32 s48, 20480
    s_cmov_b32 s48, 0
    v_cmp_eq_u32 vcc, 31, v207
    s_cmp_lg_u64 vcc, 0
    s_cselect_b64 exec, s[62:63], 0
    buffer_store_dword v213, v212, s[24:27], 0 offen sc1
    s_mov_b64 exec, -1
    s_waitcnt vmcnt(9)
    ds_read_b32 v12, v7 offset:40960
    ds_read_b32 v13, v7 offset:41984
    ds_read_b32 v14, v7 offset:49152
    ds_read_b32 v15, v7 offset:50176
    s_waitcnt lgkmcnt(0)
    v_or3_b32 v12, v12, v13, v14
    v_or_b32 v12, v12, v15
    v_and_b32 v12, v244, v12
    v_cmp_ne_u32 vcc, 0, v12
    s_cbranch_vccnz L4_retry1
L4_ok1:
    s_waitcnt vmcnt(9)
    s_barrier
    s_waitcnt vmcnt(5)
    ds_read_b32 v12, v8 offset:0
    ds_read_b32 v13, v8 offset:1024
    ds_read_b32 v14, v8 offset:8192
    ds_read_b32 v15, v8 offset:9216
    s_mov_b32 s58, s48
    s_add_u32 m0, s47, 0
    s_add_u32 s3, s58, 0
    buffer_load_dwordx4 v5, s[24:27], s3 offen sc1 lds
    s_add_u32 m0, s47, 1024
    s_add_u32 s3, s58, 20480
    buffer_load_dwordx4 v5, s[24:27], s3 offen sc1 lds
    s_add_u32 m0, s47, 8192
    s_add_u32 s3, s58, 1024
    buffer_load_dwordx4 v5, s[24:27], s3 offen sc1 lds
    s_add_u32 m0, s47, 9216
    s_add_u32 s3, s58, 21504
    buffer_load_dwordx4 v5, s[24:27], s3 offen sc1 lds
    s_add_u32 s48, s48, 2048
    s_cmp_eq_u32 s48, 20480
    s_cmov_b32 s48, 0
    s_add_u32 m0, s46, 16384
    s_add_u32 s3, s49, 0
    buffer_load_dwordx4 v4, s[24:27], s3 offen sc1 lds
    s_add_u32 m0, s46, 17408
    s_add_u32 s3, s49, 1024
    buffer_load_dwordx4 v4, s[24:27], s3 offen sc1 lds
    s_add_u32 m0, s46, 18432
    s_add_u32 s3, s49, 2048
    buffer_load_dwordx4 v4, s[24:27], s3 offen sc1 lds
    s_add_u32 m0, s46, 19456
    s_add_u32 s3, s49, 3072
    buffer_load_dwordx4 v4, s[24:27], s3 offen sc1 lds
    s_add_u32 m0, s46, 20480
    s_add_u32 s3, s49, 4096
    buffer_load_dwordx4 v4, s[24:27], s3 offen sc1 lds
    s_add_u32 m0, s46, 21504
    s_add_u32 s3, s49, 5120
    buffer_load_dwordx4 v4, s[24:27], s3 offen sc1 lds
    s_add_u32 s49, s49, 24576
    s_cmp_eq_u32 s49, 245760
    s_cmov_b32 s49, 0
    s_waitcnt lgkmcnt(0)
    v_or3_b32 v12, v12, v13, v14
    v_or_b32 v12, v12, v15
    v_and_b32 v12, v244, v12
    v_cmp_ne_u32 vcc, 0, v12
    s_cbranch_vccnz L4_retry2
L4_ok2:
    s_waitcnt vmcnt(15)
    s_barrier
    s_waitcnt vmcnt(11)
    ds_read_b32 v12, v8 offset:40960
    ds_read_b32 v13, v8 offset:41984
    ds_read_b32 v14, v8 offset:49152
    ds_read_b32 v15, v8 offset:50176
    s_mov_b32 s59, s48
    s_add_u32 m0, s47, 40960
    s_add_u32 s3, s59, 0
    buffer_load_dwordx4 v5, s[24:27], s3 offen sc1 lds
    s_add_u32 m0, s47, 41984
    s_add_u32 s3, s59, 20480
    buffer_load_dwordx4 v5, s[24:27], s3 offen sc1 lds
    s_add_u32 m0, s47, 49152
    s_add_u32 s3, s59, 1024
    buffer_load_dwordx4 v5, s[24:27], s3 offen sc1 lds
    s_add_u32 m0, s47, 50176
    s_add_u32 s3, s59, 21504
    buffer_load_dwordx4 v5, s[24:27], s3 offen sc1 lds
    s_add_u32 s48, s48, 2048
    s_cmp_eq_u32 s48, 20480
    s_cmov_b32 s48, 0
    s_add_u32 m0, s46, 57344
    s_add_u32 s3, s49, 0
    buffer_load_dwordx4 v4, s[24:27], s3 offen sc1 lds
    s_add_u32 m0, s46, 58368
    s_add_u32 s3, s49, 1024
    buffer_load_dwordx4 v4, s[24:27], s3 offen sc1 lds
    s_add_u32 m0, s46, 59392
    s_add_u32 s3, s49, 2048
    buffer_load_dwordx4 v4, s[24:27], s3 offen sc1 lds
    s_add_u32 m0, s46, 60416
    s_add_u32 s3, s49, 3072
    buffer_load_dwordx4 v4, s[24:27], s3 offen sc1 lds
    s_add_u32 m0, s46, 61440
    s_add_u32 s3, s49, 4096
    buffer_load_dwordx4 v4, s[24:27], s3 offen sc1 lds
    s_add_u32 m0, s46, 62464
    s_add_u32 s3, s49, 5120
    buffer_load_dwordx4 v4, s[24:27], s3 offen sc1 lds
    s_add_u32 s49, s49, 24576
    s_cmp_eq_u32 s49, 245760
    s_cmov_b32 s49, 0
    s_waitcnt lgkmcnt(0)
    v_or3_b32 v12, v12, v13, v14
    v_or_b32 v12, v12, v15
    v_and_b32 v12, v244, v12
    v_cmp_ne_u32 vcc, 0, v12
    s_cbranch_vccnz L4_retry3
L4_ok3:
    s_waitcnt vmcnt(21)
    s_barrier
    s_waitcnt vmcnt(16)
    ds_read_b32 v12, v7 offset:0
    ds_read_b32 v13, v7 offset:1024
    ds_read_b32 v14, v7 offset:8192
    ds_read_b32 v15, v7 offset:9216
    s_mov_b32 s60, s48
    s_add_u32 m0, s47, 81920
    s_add_u32 s3, s60, 0
    buffer_load_dwordx4 v5, s[24:27], s3 offen sc1 lds
    s_add_u32 m0, s47, 82944
    s_add_u32 s3, s60, 20480
    buffer_load_dwordx4 v5, s[24:27], s3 offen sc1 lds
    s_add_u32 m0, s47, 90112
    s_add_u32 s3, s60, 1024
    buffer_load_dwordx4 v5, s[24:27], s3 offen sc1 lds
    s_add_u32 m0, s47, 91136
    s_add_u32 s3, s60, 21504
    buffer_load_dwordx4 v5, s[24:27], s3 offen sc1 lds
    s_add_u32 s48, s48, 2048
    s_cmp_eq_u32 s48, 20480
    s_cmov_b32 s48, 0
    s_add_u32 m0, s46, 98304
    s_add_u32 s3, s49, 0
    buffer_load_dwordx4 v4, s[24:27], s3 offen sc1 lds
    s_add_u32 m0, s46, 99328
    s_add_u32 s3, s49, 1024
    buffer_load_dwordx4 v4, s[24:27], s3 offen sc1 lds
    s_add_u32 m0, s46, 100352
    s_add_u32 s3, s49, 2048
    buffer_load_dwordx4 v4, s[24:27], s3 offen sc1 lds
    s_add_u32 m0, s46, 101376
    s_add_u32 s3, s49, 3072
    buffer_load_dwordx4 v4, s[24:27], s3 offen sc1 lds
    s_add_u32 m0, s46, 102400
    s_add_u32 s3, s49, 4096
    buffer_load_dwordx4 v4, s[24:27], s3 offen sc1 lds
    s_add_u32 m0, s46, 103424
    s_add_u32 s3, s49, 5120
    buffer_load_dwordx4 v4, s[24:27], s3 offen sc1 lds
    s_add_u32 s49, s49, 24576
    s_cmp_eq_u32 s49, 245760
    s_cmov_b32 s49, 0
    s_waitcnt lgkmcnt(0)
    v_or3_b32 v12, v12, v13, v14
    v_or_b32 v12, v12, v15
    v_and_b32 v12, v244, v12
    v_cmp_ne_u32 vcc, 0, v12
    s_cbranch_vccnz L4_retry4
L4_ok4:
    s_waitcnt vmcnt(20)
    s_barrier
    s_waitcnt vmcnt(16)
    ds_read_b32 v12, v7 offset:40960
    ds_read_b32 v13, v7 offset:41984
    ds_read_b32 v14, v7 offset:49152
    ds_read_b32 v15, v7 offset:50176
    s_mov_b32 s61, s48
    s_add_u32 m0, s47, 122880
    s_add_u32 s3, s61, 0
    buffer_load_dwordx4 v5, s[24:27], s3 offen sc1 lds
    s_add_u32 m0, s47, 123904
    s_add_u32 s3, s61, 20480
    buffer_load_dwordx4 v5, s[24:27], s3 offen sc1 lds
    s_add_u32 m0, s47, 131072
    s_add_u32 s3, s61, 1024
    buffer_load_dwordx4 v5, s[24:27], s3 offen sc1 lds
    s_add_u32 m0, s47, 132096
    s_add_u32 s3, s61, 21504
    buffer_load_dwordx4 v5, s[24:27], s3 offen sc1 lds
    s_add_u32 s48, s48, 2048
    s_cmp_eq_u32 s48, 20480
    s_cmov_b32 s48, 0
    s_add_u32 m0, s46, 139264
    s_add_u32 s3, s49, 0
    buffer_load_dwordx4 v4, s[24:27], s3 offen sc1 lds
    s_add_u32 m0, s46, 140288
    s_add_u32 s3, s49, 1024
    buffer_load_dwordx4 v4, s[24:27], s3 offen sc1 lds
    s_add_u32 m0, s46, 141312
    s_add_u32 s3, s49, 2048
    buffer_load_dwordx4 v4, s[24:27], s3 offen sc1 lds
    s_add_u32 m0, s46, 142336
    s_add_u32 s3, s49, 3072
    buffer_load_dwordx4 v4, s[24:27], s3 offen sc1 lds
    s_add_u32 m0, s46, 143360
    s_add_u32 s3, s49, 4096
    buffer_load_dwordx4 v4, s[24:27], s3 offen sc1 lds
    s_add_u32 m0, s46, 144384
    s_add_u32 s3, s49, 5120
    buffer_load_dwordx4 v4, s[24:27], s3 offen sc1 lds
    s_add_u32 s49, s49, 24576
    s_cmp_eq_u32 s49, 245760
    s_cmov_b32 s49, 0
    s_waitcnt lgkmcnt(0)
    v_or3_b32 v12, v12, v13, v14
    v_or_b32 v12, v12, v15
    v_and_b32 v12, v244, v12
    v_cmp_ne_u32 vcc, 0, v12
    s_cbranch_vccnz L4_retry5
L4_ok5:
    s_waitcnt vmcnt(20)
    s_barrier
    s_waitcnt vmcnt(16)
    ds_read_b32 v12, v8 offset:0
    ds_read_b32 v13, v8 offset:1024
    ds_read_b32 v14, v8 offset:8192
    ds_read_b32 v15, v8 offset:9216
    buffer_load_dwordx4 v[16:19], v2, s[24:27], s51 offen offset:0 sc1
    buffer_load_dwordx4 v[20:23], v2, s[24:27], s51 offen offset:1024 sc1
    s_mov_b32 s58, s48
    s_add_u32 m0, s47, 0
    s_add_u32 s3, s58, 0
    buffer_load_dwordx4 v5, s[24:27], s3 offen sc1 lds
    s_add_u32 m0, s47, 1024
    s_add_u32 s3, s58, 20480
    buffer_load_dwordx4 v5, s[24:27], s3 offen sc1 lds
    s_add_u32 m0, s47, 8192
    s_add_u32 s3, s58, 1024
    buffer_load_dwordx4 v5, s[24:27], s3 offen sc1 lds
    s_add_u32 m0, s47, 9216
    s_add_u32 s3, s58, 21504
    buffer_load_dwordx4 v5, s[24:27], s3 offen sc1 lds
    s_add_u32 s48, s48, 2048
    s_cmp_eq_u32 s48, 20480
    s_cmov_b32 s48, 0
    s_add_u32 m0, s46, 16384
    s_add_u32 s3, s49, 0
    buffer_load_dwordx4 v4, s[24:27], s3 offen sc1 lds
    s_add_u32 m0, s46, 17408
    s_add_u32 s3, s49, 1024
    buffer_load_dwordx4 v4, s[24:27], s3 offen sc1 lds
    s_add_u32 m0, s46, 18432
    s_add_u32 s3, s49, 2048
    buffer_load_dwordx4 v4, s[24:27], s3 offen sc1 lds
    s_add_u32 m0, s46, 19456
    s_add_u32 s3, s49, 3072
    buffer_load_dwordx4 v4, s[24:27], s3 offen sc1 lds
    s_add_u32 m0, s46, 20480
    s_add_u32 s3, s49, 4096
    buffer_load_dwordx4 v4, s[24:27], s3 offen sc1 lds
    s_add_u32 m0, s46, 21504
    s_add_u32 s3, s49, 5120
    buffer_load_dwordx4 v4, s[24:27], s3 offen sc1 lds
    s_add_u32 s49, s49, 24576
    s_cmp_eq_u32 s49, 245760
    s_cmov_b32 s49, 0
    s_waitcnt lgkmcnt(0)
    v_or3_b32 v12, v12, v13, v14
    v_or_b32 v12, v12, v15
    v_and_b32 v12, v244, v12
    v_cmp_ne_u32 vcc, 0, v12
    s_cbranch_vccnz L4_retry6
L4_ok6:
    s_waitcnt vmcnt(22)
    s_barrier
    s_waitcnt vmcnt(18)
    ds_read_b32 v12, v8 offset:40960
    ds_read_b32 v13, v8 offset:41984
    ds_read_b32 v14, v8 offset:49152
    ds_read_b32 v15, v8 offset:50176
    s_mov_b64 exec, s[62:63]
    buffer_load_dword v201, v200, s[24:27], 0 offen sc1
    s_mov_b64 exec, -1
    s_mov_b32 s59, s48
    s_add_u32 m0, s47, 40960
    s_add_u32 s3, s59, 0
    buffer_load_dwordx4 v5, s[24:27], s3 offen sc1 lds
    s_add_u32 m0, s47, 41984
    s_add_u32 s3, s59, 20480
    buffer_load_dwordx4 v5, s[24:27], s3 offen sc1 lds
    s_add_u32 m0, s47, 49152
    s_add_u32 s3, s59, 1024
    buffer_load_dwordx4 v5, s[24:27], s3 offen sc1 lds
    s_add_u32 m0, s47, 50176
    s_add_u32 s3, s59, 21504
    buffer_load_dwordx4 v5, s[24:27], s3 offen sc1 lds
    s_add_u32 s48, s48, 2048
    s_cmp_eq_u32 s48, 20480
    s_cmov_b32 s48, 0
    s_add_u32 m0, s46, 57344
    s_add_u32 s3, s49, 0
    buffer_load_dwordx4 v4, s[24:27], s3 offen sc1 lds
    s_add_u32 m0, s46, 58368
    s_add_u32 s3, s49, 1024
    buffer_load_dwordx4 v4, s[24:27], s3 offen sc1 lds
    s_add_u32 m0, s46, 59392
    s_add_u32 s3, s49, 2048
    buffer_load_dwordx4 v4, s[24:27], s3 offen sc1 lds
    s_add_u32 m0, s46, 60416
    s_add_u32 s3, s49, 3072
    buffer_load_dwordx4 v4, s[24:27], s3 offen sc1 lds
    s_add_u32 m0, s46, 61440
    s_add_u32 s3, s49, 4096
    buffer_load_dwordx4 v4, s[24:27], s3 offen sc1 lds
    s_add_u32 m0, s46, 62464
    s_add_u32 s3, s49, 5120
    buffer_load_dwordx4 v4, s[24:27], s3 offen sc1 lds
    s_add_u32 s49, s49, 24576
    s_cmp_eq_u32 s49, 245760
    s_cmov_b32 s49, 0
    s_waitcnt lgkmcnt(0)
    v_or3_b32 v12, v12, v13, v14
    v_or_b32 v12, v12, v15
    v_and_b32 v12, v244, v12
    v_cmp_ne_u32 vcc, 0, v12
    s_cbranch_vccnz L4_retry7
L4_ok7:
    s_waitcnt vmcnt(23)
    s_barrier
    s_waitcnt vmcnt(17)
    ds_read_b32 v12, v7 offset:0
    ds_read_b32 v13, v7 offset:1024
    ds_read_b32 v14, v7 offset:8192
    ds_read_b32 v15, v7 offset:9216
    s_add_u32 m0, s50, 81920
    s_mov_b32 s3, 0
    buffer_load_dwordx4 v6, s[24:27], s3 offen sc1 lds
    s_add_u32 m0, s50, 82944
    s_mov_b32 s3, 1024
    buffer_load_dwordx4 v6, s[24:27], s3 offen sc1 lds
    s_waitcnt vmcnt(23)
    v_or3_b32 v10, v16, v18, v20
    v_or_b32 v10, v10, v22
    v_and_b32 v10, 1, v10
    v_cmp_ne_u32 vcc, 0, v10
    s_cbranch_vccnz L4_retryst
L4_okst:
    v_permlane32_swap_b32 v16, v20
    v_permlane32_swap_b32 v17, v21
    v_permlane32_swap_b32 v18, v22
    v_permlane32_swap_b32 v19, v23
    v_add_f32 v16, v16, v20
    s_add_u32 m0, s50, 83968
    s_mov_b32 s3, 2048
    buffer_load_dwordx4 v6, s[24:27], s3 offen sc1 lds
    v_add_f32 v17, v17, v21
    v_add_f32 v18, v18, v22
    v_add_f32 v19, v19, v23
    v_mov_b32 v20, v16
    v_mov_b32 v21, v17
    s_add_u32 m0, s50, 84992
    s_mov_b32 s3, 3072
    buffer_load_dwordx4 v6, s[24:27], s3 offen sc1 lds
    v_mov_b32 v22, v18
    v_mov_b32 v23, v19
    v_permlane16_swap_b32 v16, v20
    v_permlane16_swap_b32 v17, v21
    v_permlane16_swap_b32 v18, v22
    s_add_u32 m0, s50, 86016
    s_mov_b32 s3, 4096
    buffer_load_dwordx4 v6, s[24:27], s3 offen sc1 lds
    v_permlane16_swap_b32 v19, v23
    v_add_f32 v16, v16, v20
    v_add_f32 v17, v17, v21
    v_add_f32 v18, v18, v22
    v_add_f32 v19, v19, v23
    s_add_u32 m0, s50, 87040
    s_mov_b32 s3, 5120
    buffer_load_dwordx4 v6, s[24:27], s3 offen sc1 lds
    v_add_f32_dpp v16, v16, v16 row_ror:8 row_mask:0xf bank_mask:0xf
    v_add_f32_dpp v17, v17, v17 row_ror:8 row_mask:0xf bank_mask:0xf
    v_add_f32_dpp v18, v18, v18 row_ror:8 row_mask:0xf bank_mask:0xf
    v_add_f32_dpp v19, v19, v19 row_ror:8 row_mask:0xf bank_mask:0xf
    v_mul_f32 v16, 0x3acccccd, v16
    s_add_u32 m0, s50, 88064
    s_mov_b32 s3, 6144
    buffer_load_dwordx4 v6, s[24:27], s3 offen sc1 lds
    v_mul_f32 v17, 0x3acccccd, v17
    v_fma_f32 v17, -v16, v16, v17
    v_max_f32 v17, 0, v17
    v_add_f32 v17, 0x3727c5ac, v17
    v_rcp_f32 v17, v17
    s_add_u32 m0, s50, 89088
    s_mov_b32 s3, 7168
    buffer_load_dwordx4 v6, s[24:27], s3 offen sc1 lds
    v_mul_f32 v18, 0x3acccccd, v18
    v_mul_f32 v19, 0x3acccccd, v19
    v_fma_f32 v19, -v18, v18, v19
    v_max_f32 v19, 0, v19
    v_add_f32 v19, 0x3727c5ac, v19
    s_add_u32 m0, s50, 90112
    s_mov_b32 s3, 8192
    buffer_load_dwordx4 v6, s[24:27], s3 offen sc1 lds
    v_rcp_f32 v19, v19
    s_add_u32 m0, s50, 91136
    s_mov_b32 s3, 9216
    buffer_load_dwordx4 v6, s[24:27], s3 offen sc1 lds
    s_waitcnt lgkmcnt(0)
    v_or3_b32 v12, v12, v13, v14
    v_or_b32 v12, v12, v15
    v_and_b32 v12, v244, v12
    v_cmp_ne_u32 vcc, 0, v12
    s_cbranch_vccnz L4_retry8
L4_ok8:
    s_waitcnt vmcnt(21)
    s_barrier
    s_waitcnt vmcnt(16)
    ds_read_b32 v12, v7 offset:40960
    ds_read_b32 v13, v7 offset:41984
    ds_read_b32 v14, v7 offset:49152
    ds_read_b32 v15, v7 offset:50176
    s_add_u32 m0, s50, 122880
    s_mov_b32 s3, 20480
    buffer_load_dwordx4 v6, s[24:27], s3 offen sc1 lds
    s_add_u32 m0, s50, 123904
    s_mov_b32 s3, 21504
    buffer_load_dwordx4 v6, s[24:27], s3 offen sc1 lds
    s_add_u32 m0, s50, 124928
    s_mov_b32 s3, 22528
    buffer_load_dwordx4 v6, s[24:27], s3 offen sc1 lds
    s_add_u32 m0, s50, 125952
    s_mov_b32 s3, 23552
    buffer_load_dwordx4 v6, s[24:27], s3 offen sc1 lds
    s_add_u32 m0, s50, 126976
    s_mov_b32 s3, 24576
    buffer_load_dwordx4 v6, s[24:27], s3 offen sc1 lds
    s_add_u32 m0, s50, 128000
    s_mov_b32 s3, 25600
    buffer_load_dwordx4 v6, s[24:27], s3 offen sc1 lds
    s_add_u32 m0, s50, 129024
    s_mov_b32 s3, 26624
    buffer_load_dwordx4 v6, s[24:27], s3 offen sc1 lds
    s_add_u32 m0, s50, 130048
    s_mov_b32 s3, 27648
    buffer_load_dwordx4 v6, s[24:27], s3 offen sc1 lds
    s_add_u32 m0, s50, 131072
    s_mov_b32 s3, 28672
    buffer_load_dwordx4 v6, s[24:27], s3 offen sc1 lds
    s_add_u32 m0, s50, 132096
    s_mov_b32 s3, 29696
    buffer_load_dwordx4 v6, s[24:27], s3 offen sc1 lds
    s_waitcnt lgkmcnt(0)
    v_or3_b32 v12, v12, v13, v14
    v_or_b32 v12, v12, v15
    v_and_b32 v12, v244, v12
    v_cmp_ne_u32 vcc, 0, v12
    s_cbranch_vccnz L4_retry9
L4_ok9:
    s_waitcnt vmcnt(20)
    v_cmp_le_u32 vcc, 1, v201
    s_cmp_eq_u64 vcc, -1
    s_cbranch_scc0 L4_cawait
L4_caback:
    s_barrier
    ds_write_b128 v9, v[16:19]
    s_add_u32 m0, s50, 1024
    s_mov_b32 s3, 41984
    buffer_load_dwordx4 v6, s[24:27], s3 offen sc1 lds
    s_add_u32 m0, s50, 2048
    s_mov_b32 s3, 43008
    buffer_load_dwordx4 v6, s[24:27], s3 offen sc1 lds
    s_add_u32 m0, s50, 3072
    s_mov_b32 s3, 44032
    buffer_load_dwordx4 v6, s[24:27], s3 offen sc1 lds
    s_add_u32 m0, s50, 4096
    s_mov_b32 s3, 45056
    buffer_load_dwordx4 v6, s[24:27], s3 offen sc1 lds
    s_add_u32 m0, s50, 5120
    s_mov_b32 s3, 46080
    buffer_load_dwordx4 v6, s[24:27], s3 offen sc1 lds
    s_waitcnt lgkmcnt(0)
    s_barrier
    s_add_u32 m0, s50, 6144
    s_mov_b32 s3, 47104
    buffer_load_dwordx4 v6, s[24:27], s3 offen sc1 lds
    s_add_u32 m0, s50, 7168
    s_mov_b32 s3, 48128
    buffer_load_dwordx4 v6, s[24:27], s3 offen sc1 lds
    s_add_u32 m0, s50, 8192
    s_mov_b32 s3, 49152
    buffer_load_dwordx4 v6, s[24:27], s3 offen sc1 lds
    s_add_u32 m0, s50, 9216
    s_mov_b32 s3, 50176
    buffer_load_dwordx4 v6, s[24:27], s3 offen sc1 lds
    s_add_u32 m0, s50, 40960
    s_mov_b32 s3, 61440
    buffer_load_dwordx4 v6, s[24:27], s3 offen sc1 lds
    s_add_u32 m0, s50, 41984
    s_mov_b32 s3, 62464
    buffer_load_dwordx4 v6, s[24:27], s3 offen sc1 lds
    s_add_u32 m0, s50, 43008
    s_mov_b32 s3, 63488
    buffer_load_dwordx4 v6, s[24:27], s3 offen sc1 lds
    s_add_u32 m0, s50, 44032
    s_mov_b32 s3, 64512
    buffer_load_dwordx4 v6, s[24:27], s3 offen sc1 lds
    s_add_u32 m0, s50, 45056
    s_mov_b32 s3, 65536
    buffer_load_dwordx4 v6, s[24:27], s3 offen sc1 lds
    s_add_u32 m0, s50, 46080
    s_mov_b32 s3, 66560
    buffer_load_dwordx4 v6, s[24:27], s3 offen sc1 lds
    s_add_u32 m0, s50, 47104
    s_mov_b32 s3, 67584
    buffer_load_dwordx4 v6, s[24:27], s3 offen sc1 lds
    s_add_u32 m0, s50, 48128
    s_mov_b32 s3, 68608
    buffer_load_dwordx4 v6, s[24:27], s3 offen sc1 lds
    s_add_u32 m0, s50, 49152
    s_mov_b32 s3, 69632
    buffer_load_dwordx4 v6, s[24:27], s3 offen sc1 lds
    s_add_u32 m0, s50, 50176
    s_mov_b32 s3, 70656
    buffer_load_dwordx4 v6, s[24:27], s3 offen sc1 lds
    s_branch L4_done
L4_compute:
    s_lshr_b32 s45, s42, 1
    s_and_b32 s46, s42, 1
    s_lshl_b32 s3, s45, 12
    v_add_u32 v4, s3, v2
    s_lshl_b32 s3, s46, 10
    s_add_u32 s3, s3, 16384
    v_add_u32 v6, s3, v2
    v_lshrrev_b32 v10, 4, v0
    v_and_b32 v11, 15, v0
    s_mul_i32 s3, s45, 20480
    v_lshl_add_u32 v12, v11, 3, s3
    s_lshl_b32 s3, s40, 3
    s_lshl_b32 s15, s45, 2
    s_add_u32 s3, s3, s15
    s_mul_i32 s3, s3, 49152
    s_mul_i32 s15, s41, 3072
    s_add_u32 s3, s3, s15
    s_lshl_b32 s15, s46, 9
    s_add_u32 s3, s3, s15
    s_add_u32 s48, s3, 2621440
    s_add_u32 s49, s48, 98304
    v_and_b32 v14, 1, v10
    v_mul_u32_u24 v14, 49152, v14
    v_lshrrev_b32 v13, 1, v10
    v_lshl_add_u32 v14, v13, 8, v14
    v_lshl_add_u32 v14, v11, 4, v14
    s_mov_b32 s14, 400000
    s_mul_i32 s3, s41, 384
    s_lshl_b32 s15, s46, 6
    s_add_u32 s3, s3, s15
    s_add_u32 s50, s3, 11665408
    s_add_u32 s51, s50, 6144
    v_lshlrev_b32 v9, 4, v10
    buffer_load_dwordx4 v[216:219], v9, s[24:27], s50 offen offset:0 sc1
    buffer_load_dwordx4 v[220:223], v9, s[24:27], s50 offen offset:128 sc1
    buffer_load_dwordx4 v[224:227], v9, s[24:27], s50 offen offset:256 sc1
    buffer_load_dwordx4 v[228:231], v9, s[24:27], s51 offen offset:0 sc1
    buffer_load_dwordx4 v[232:235], v9, s[24:27], s51 offen offset:128 sc1
    buffer_load_dwordx4 v[236:239], v9, s[24:27], s51 offen offset:256 sc1
    s_lshl_b32 s15, s56, 2
    s_add_u32 s52, s15, s43
    s_xor_b32 s53, s52, 1
    s_mul_i32 s3, s46, 24576
    s_add_u32 s3, s3, 2621440
    s_mul_i32 s52, s52, 49152
    s_mul_i32 s53, s53, 49152
    s_add_u32 s58, s52, s3
    s_add_u32 s96, s53, s3
    s_add_u32 s59, s58, 4096
    s_add_u32 s60, s58, 8192
    s_add_u32 s61, s58, 12288
    s_add_u32 s62, s58, 16384
    s_add_u32 s63, s58, 20480
    s_add_u32 s97, s96, 4096
    s_add_u32 s98, s96, 8192
    s_add_u32 s99, s96, 12288
    s_add_u32 s100, s96, 16384
    s_add_u32 s101, s96, 20480
    v_add_u32 v5, 0, v4
    v_add_u32 v7, 0, v6
    s_barrier
    ds_read_b128 v[16:19], v5 offset:0
    ds_read_b128 v[20:23], v5 offset:1024
    ds_read_b128 v[24:27], v5 offset:2048
    ds_read_b128 v[28:31], v5 offset:3072
    ds_read_b128 v[48:51], v7 offset:0
    ds_read_b128 v[52:55], v7 offset:2048
    ds_read_b128 v[56:59], v7 offset:4096
    s_waitcnt lgkmcnt(0)
    v_mfma_f32_16x16x32_bf16 v[96:99], v[48:51], v[16:19], 0
    ds_read_b128 v[60:63], v7 offset:6144
    v_mfma_f32_16x16x32_bf16 v[100:103], v[48:51], v[20:23], 0
    ds_read_b128 v[64:67], v7 offset:8192
    v_mfma_f32_16x16x32_bf16 v[104:107], v[48:51], v[24:27], 0
    ds_read_b128 v[68:71], v7 offset:10240
    v_mfma_f32_16x16x32_bf16 v[108:111], v[48:51], v[28:31], 0
    ds_read_b128 v[32:35], v5 offset:8192
    v_mfma_f32_16x16x32_bf16 v[112:115], v[52:55], v[16:19], 0
    ds_read_b128 v[36:39], v5 offset:9216
    v_mfma_f32_16x16x32_bf16 v[116:119], v[52:55], v[20:23], 0
    ds_read_b128 v[40:43], v5 offset:10240
    v_mfma_f32_16x16x32_bf16 v[120:123], v[52:55], v[24:27], 0
    ds_read_b128 v[44:47], v5 offset:11264
    v_mfma_f32_16x16x32_bf16 v[124:127], v[52:55], v[28:31], 0
    v_mfma_f32_16x16x32_bf16 v[128:131], v[56:59], v[16:19], 0
    v_mfma_f32_16x16x32_bf16 v[132:135], v[56:59], v[20:23], 0
    v_mfma_f32_16x16x32_bf16 v[136:139], v[56:59], v[24:27], 0
    v_mfma_f32_16x16x32_bf16 v[140:143], v[56:59], v[28:31], 0
    s_waitcnt lgkmcnt(4)
    v_mfma_f32_16x16x32_bf16 v[144:147], v[60:63], v[16:19], 0
    ds_read_b128 v[48:51], v7 offset:12288
    v_mfma_f32_16x16x32_bf16 v[148:151], v[60:63], v[20:23], 0
    ds_read_b128 v[52:55], v7 offset:14336
    v_mfma_f32_16x16x32_bf16 v[152:155], v[60:63], v[24:27], 0
    ds_read_b128 v[56:59], v7 offset:16384
    v_mfma_f32_16x16x32_bf16 v[156:159], v[60:63], v[28:31], 0
    v_mfma_f32_16x16x32_bf16 v[160:163], v[64:67], v[16:19], 0
    v_mfma_f32_16x16x32_bf16 v[164:167], v[64:67], v[20:23], 0
    v_mfma_f32_16x16x32_bf16 v[168:171], v[64:67], v[24:27], 0
    v_mfma_f32_16x16x32_bf16 v[172:175], v[64:67], v[28:31], 0
    v_mfma_f32_16x16x32_bf16 v[176:179], v[68:71], v[16:19], 0
    v_mfma_f32_16x16x32_bf16 v[180:183], v[68:71], v[20:23], 0
    v_mfma_f32_16x16x32_bf16 v[184:187], v[68:71], v[24:27], 0
    v_mfma_f32_16x16x32_bf16 v[188:191], v[68:71], v[28:31], 0
    s_waitcnt lgkmcnt(0)
    v_mfma_f32_16x16x32_bf16 v[96:99], v[48:51], v[32:35], v[96:99]
    ds_read_b128 v[60:63], v7 offset:18432
    v_mfma_f32_16x16x32_bf16 v[100:103], v[48:51], v[36:39], v[100:103]
    ds_read_b128 v[64:67], v7 offset:20480
    v_mfma_f32_16x16x32_bf16 v[104:107], v[48:51], v[40:43], v[104:107]
    ds_read_b128 v[68:71], v7 offset:22528
    v_mfma_f32_16x16x32_bf16 v[108:111], v[48:51], v[44:47], v[108:111]
    v_mfma_f32_16x16x32_bf16 v[112:115], v[52:55], v[32:35], v[112:115]
    v_mfma_f32_16x16x32_bf16 v[116:119], v[52:55], v[36:39], v[116:119]
    v_mfma_f32_16x16x32_bf16 v[120:123], v[52:55], v[40:43], v[120:123]
    v_mfma_f32_16x16x32_bf16 v[124:127], v[52:55], v[44:47], v[124:127]
    v_mfma_f32_16x16x32_bf16 v[128:131], v[56:59], v[32:35], v[128:131]
    v_mfma_f32_16x16x32_bf16 v[132:135], v[56:59], v[36:39], v[132:135]
    v_mfma_f32_16x16x32_bf16 v[136:139], v[56:59], v[40:43], v[136:139]
    v_mfma_f32_16x16x32_bf16 v[140:143], v[56:59], v[44:47], v[140:143]
    s_waitcnt lgkmcnt(0)
    v_add_u32 v5, 40960, v4
    v_add_u32 v7, 40960, v6
    s_barrier
    v_mfma_f32_16x16x32_bf16 v[144:147], v[60:63], v[32:35], v[144:147]
    ds_read_b128 v[48:51], v7 offset:0
    v_mfma_f32_16x16x32_bf16 v[148:151], v[60:63], v[36:39], v[148:151]
    ds_read_b128 v[52:55], v7 offset:2048
    v_mfma_f32_16x16x32_bf16 v[152:155], v[60:63], v[40:43], v[152:155]
    ds_read_b128 v[56:59], v7 offset:4096
    v_mfma_f32_16x16x32_bf16 v[156:159], v[60:63], v[44:47], v[156:159]
    ds_read_b128 v[16:19], v5 offset:0
    v_mfma_f32_16x16x32_bf16 v[160:163], v[64:67], v[32:35], v[160:163]
    ds_read_b128 v[20:23], v5 offset:1024
    v_mfma_f32_16x16x32_bf16 v[164:167], v[64:67], v[36:39], v[164:167]
    ds_read_b128 v[24:27], v5 offset:2048
    v_mfma_f32_16x16x32_bf16 v[168:171], v[64:67], v[40:43], v[168:171]
    ds_read_b128 v[28:31], v5 offset:3072
    v_mfma_f32_16x16x32_bf16 v[172:175], v[64:67], v[44:47], v[172:175]
    v_mfma_f32_16x16x32_bf16 v[176:179], v[68:71], v[32:35], v[176:179]
    v_mfma_f32_16x16x32_bf16 v[180:183], v[68:71], v[36:39], v[180:183]
    v_mfma_f32_16x16x32_bf16 v[184:187], v[68:71], v[40:43], v[184:187]
    v_mfma_f32_16x16x32_bf16 v[188:191], v[68:71], v[44:47], v[188:191]
    s_waitcnt lgkmcnt(0)
    v_mfma_f32_16x16x32_bf16 v[96:99], v[48:51], v[16:19], v[96:99]
    ds_read_b128 v[60:63], v7 offset:6144
    v_mfma_f32_16x16x32_bf16 v[100:103], v[48:51], v[20:23], v[100:103]
    ds_read_b128 v[64:67], v7 offset:8192
    v_mfma_f32_16x16x32_bf16 v[104:107], v[48:51], v[24:27], v[104:107]
    ds_read_b128 v[68:71], v7 offset:10240
    v_mfma_f32_16x16x32_bf16 v[108:111], v[48:51], v[28:31], v[108:111]
    ds_read_b128 v[32:35], v5 offset:8192
    v_mfma_f32_16x16x32_bf16 v[112:115], v[52:55], v[16:19], v[112:115]
    ds_read_b128 v[36:39], v5 offset:9216
    v_mfma_f32_16x16x32_bf16 v[116:119], v[52:55], v[20:23], v[116:119]
    ds_read_b128 v[40:43], v5 offset:10240
    v_mfma_f32_16x16x32_bf16 v[120:123], v[52:55], v[24:27], v[120:123]
    ds_read_b128 v[44:47], v5 offset:11264
    v_mfma_f32_16x16x32_bf16 v[124:127], v[52:55], v[28:31], v[124:127]
    v_mfma_f32_16x16x32_bf16 v[128:131], v[56:59], v[16:19], v[128:131]
    v_mfma_f32_16x16x32_bf16 v[132:135], v[56:59], v[20:23], v[132:135]
    v_mfma_f32_16x16x32_bf16 v[136:139], v[56:59], v[24:27], v[136:139]
    v_mfma_f32_16x16x32_bf16 v[140:143], v[56:59], v[28:31], v[140:143]
    s_waitcnt lgkmcnt(4)
    v_mfma_f32_16x16x32_bf16 v[144:147], v[60:63], v[16:19], v[144:147]
    ds_read_b128 v[48:51], v7 offset:12288
    v_mfma_f32_16x16x32_bf16 v[148:151], v[60:63], v[20:23], v[148:151]
    ds_read_b128 v[52:55], v7 offset:14336
    v_mfma_f32_16x16x32_bf16 v[152:155], v[60:63], v[24:27], v[152:155]
    ds_read_b128 v[56:59], v7 offset:16384
    v_mfma_f32_16x16x32_bf16 v[156:159], v[60:63], v[28:31], v[156:159]
    v_mfma_f32_16x16x32_bf16 v[160:163], v[64:67], v[16:19], v[160:163]
    v_mfma_f32_16x16x32_bf16 v[164:167], v[64:67], v[20:23], v[164:167]
    v_mfma_f32_16x16x32_bf16 v[168:171], v[64:67], v[24:27], v[168:171]
    v_mfma_f32_16x16x32_bf16 v[172:175], v[64:67], v[28:31], v[172:175]
    v_mfma_f32_16x16x32_bf16 v[176:179], v[68:71], v[16:19], v[176:179]
    v_mfma_f32_16x16x32_bf16 v[180:183], v[68:71], v[20:23], v[180:183]
    v_mfma_f32_16x16x32_bf16 v[184:187], v[68:71], v[24:27], v[184:187]
    v_mfma_f32_16x16x32_bf16 v[188:191], v[68:71], v[28:31], v[188:191]
    s_waitcnt lgkmcnt(0)
    v_mfma_f32_16x16x32_bf16 v[96:99], v[48:51], v[32:35], v[96:99]
    ds_read_b128 v[60:63], v7 offset:18432
    v_mfma_f32_16x16x32_bf16 v[100:103], v[48:51], v[36:39], v[100:103]
    ds_read_b128 v[64:67], v7 offset:20480
    v_mfma_f32_16x16x32_bf16 v[104:107], v[48:51], v[40:43], v[104:107]
    ds_read_b128 v[68:71], v7 offset:22528
    v_mfma_f32_16x16x32_bf16 v[108:111], v[48:51], v[44:47], v[108:111]
    v_mfma_f32_16x16x32_bf16 v[112:115], v[52:55], v[32:35], v[112:115]
    v_mfma_f32_16x16x32_bf16 v[116:119], v[52:55], v[36:39], v[116:119]
    v_mfma_f32_16x16x32_bf16 v[120:123], v[52:55], v[40:43], v[120:123]
    v_mfma_f32_16x16x32_bf16 v[124:127], v[52:55], v[44:47], v[124:127]
    v_mfma_f32_16x16x32_bf16 v[128:131], v[56:59], v[32:35], v[128:131]
    v_mfma_f32_16x16x32_bf16 v[132:135], v[56:59], v[36:39], v[132:135]
    v_mfma_f32_16x16x32_bf16 v[136:139], v[56:59], v[40:43], v[136:139]
    v_mfma_f32_16x16x32_bf16 v[140:143], v[56:59], v[44:47], v[140:143]
    s_waitcnt lgkmcnt(0)
    v_add_u32 v5, 81920, v4
    v_add_u32 v7, 81920, v6
    s_barrier
    v_mfma_f32_16x16x32_bf16 v[144:147], v[60:63], v[32:35], v[144:147]
    ds_read_b128 v[48:51], v7 offset:0
    v_mfma_f32_16x16x32_bf16 v[148:151], v[60:63], v[36:39], v[148:151]
    ds_read_b128 v[52:55], v7 offset:2048
    v_mfma_f32_16x16x32_bf16 v[152:155], v[60:63], v[40:43], v[152:155]
    ds_read_b128 v[56:59], v7 offset:4096
    v_mfma_f32_16x16x32_bf16 v[156:159], v[60:63], v[44:47], v[156:159]
    ds_read_b128 v[16:19], v5 offset:0
    v_mfma_f32_16x16x32_bf16 v[160:163], v[64:67], v[32:35], v[160:163]
    ds_read_b128 v[20:23], v5 offset:1024
    v_mfma_f32_16x16x32_bf16 v[164:167], v[64:67], v[36:39], v[164:167]
    ds_read_b128 v[24:27], v5 offset:2048
    v_mfma_f32_16x16x32_bf16 v[168:171], v[64:67], v[40:43], v[168:171]
    ds_read_b128 v[28:31], v5 offset:3072
    v_mfma_f32_16x16x32_bf16 v[172:175], v[64:67], v[44:47], v[172:175]
    v_mfma_f32_16x16x32_bf16 v[176:179], v[68:71], v[32:35], v[176:179]
    v_mfma_f32_16x16x32_bf16 v[180:183], v[68:71], v[36:39], v[180:183]
    v_mfma_f32_16x16x32_bf16 v[184:187], v[68:71], v[40:43], v[184:187]
    v_mfma_f32_16x16x32_bf16 v[188:191], v[68:71], v[44:47], v[188:191]
    s_waitcnt lgkmcnt(0)
    v_mfma_f32_16x16x32_bf16 v[96:99], v[48:51], v[16:19], v[96:99]
    ds_read_b128 v[60:63], v7 offset:6144
    v_mfma_f32_16x16x32_bf16 v[100:103], v[48:51], v[20:23], v[100:103]
    ds_read_b128 v[64:67], v7 offset:8192
    v_mfma_f32_16x16x32_bf16 v[104:107], v[48:51], v[24:27], v[104:107]
    ds_read_b128 v[68:71], v7 offset:10240
    v_mfma_f32_16x16x32_bf16 v[108:111], v[48:51], v[28:31], v[108:111]
    ds_read_b128 v[32:35], v5 offset:8192
    v_mfma_f32_16x16x32_bf16 v[112:115], v[52:55], v[16:19], v[112:115]
    ds_read_b128 v[36:39], v5 offset:9216
    v_mfma_f32_16x16x32_bf16 v[116:119], v[52:55], v[20:23], v[116:119]
    ds_read_b128 v[40:43], v5 offset:10240
    v_mfma_f32_16x16x32_bf16 v[120:123], v[52:55], v[24:27], v[120:123]
    ds_read_b128 v[44:47], v5 offset:11264
    v_mfma_f32_16x16x32_bf16 v[124:127], v[52:55], v[28:31], v[124:127]
    v_mfma_f32_16x16x32_bf16 v[128:131], v[56:59], v[16:19], v[128:131]
    v_mfma_f32_16x16x32_bf16 v[132:135], v[56:59], v[20:23], v[132:135]
    v_mfma_f32_16x16x32_bf16 v[136:139], v[56:59], v[24:27], v[136:139]
    v_mfma_f32_16x16x32_bf16 v[140:143], v[56:59], v[28:31], v[140:143]
    s_waitcnt lgkmcnt(4)
    v_mfma_f32_16x16x32_bf16 v[144:147], v[60:63], v[16:19], v[144:147]
    ds_read_b128 v[48:51], v7 offset:12288
    v_mfma_f32_16x16x32_bf16 v[148:151], v[60:63], v[20:23], v[148:151]
    ds_read_b128 v[52:55], v7 offset:14336
    v_mfma_f32_16x16x32_bf16 v[152:155], v[60:63], v[24:27], v[152:155]
    ds_read_b128 v[56:59], v7 offset:16384
    v_mfma_f32_16x16x32_bf16 v[156:159], v[60:63], v[28:31], v[156:159]
    v_mfma_f32_16x16x32_bf16 v[160:163], v[64:67], v[16:19], v[160:163]
    v_mfma_f32_16x16x32_bf16 v[164:167], v[64:67], v[20:23], v[164:167]
    v_mfma_f32_16x16x32_bf16 v[168:171], v[64:67], v[24:27], v[168:171]
    v_mfma_f32_16x16x32_bf16 v[172:175], v[64:67], v[28:31], v[172:175]
    v_mfma_f32_16x16x32_bf16 v[176:179], v[68:71], v[16:19], v[176:179]
    v_mfma_f32_16x16x32_bf16 v[180:183], v[68:71], v[20:23], v[180:183]
    v_mfma_f32_16x16x32_bf16 v[184:187], v[68:71], v[24:27], v[184:187]
    v_mfma_f32_16x16x32_bf16 v[188:191], v[68:71], v[28:31], v[188:191]
    s_waitcnt lgkmcnt(0)
    v_mfma_f32_16x16x32_bf16 v[96:99], v[48:51], v[32:35], v[96:99]
    ds_read_b128 v[60:63], v7 offset:18432
    v_mfma_f32_16x16x32_bf16 v[100:103], v[48:51], v[36:39], v[100:103]
    ds_read_b128 v[64:67], v7 offset:20480
    v_mfma_f32_16x16x32_bf16 v[104:107], v[48:51], v[40:43], v[104:107]
    ds_read_b128 v[68:71], v7 offset:22528
    v_mfma_f32_16x16x32_bf16 v[108:111], v[48:51], v[44:47], v[108:111]
    v_mfma_f32_16x16x32_bf16 v[112:115], v[52:55], v[32:35], v[112:115]
    v_mfma_f32_16x16x32_bf16 v[116:119], v[52:55], v[36:39], v[116:119]
    v_mfma_f32_16x16x32_bf16 v[120:123], v[52:55], v[40:43], v[120:123]
    v_mfma_f32_16x16x32_bf16 v[124:127], v[52:55], v[44:47], v[124:127]
    v_mfma_f32_16x16x32_bf16 v[128:131], v[56:59], v[32:35], v[128:131]
    v_mfma_f32_16x16x32_bf16 v[132:135], v[56:59], v[36:39], v[132:135]
    v_mfma_f32_16x16x32_bf16 v[136:139], v[56:59], v[40:43], v[136:139]
    v_mfma_f32_16x16x32_bf16 v[140:143], v[56:59], v[44:47], v[140:143]
    s_waitcnt lgkmcnt(0)
    v_add_u32 v5, 122880, v4
    v_add_u32 v7, 122880, v6
    s_barrier
    v_mfma_f32_16x16x32_bf16 v[144:147], v[60:63], v[32:35], v[144:147]
    ds_read_b128 v[48:51], v7 offset:0
    v_mfma_f32_16x16x32_bf16 v[148:151], v[60:63], v[36:39], v[148:151]
    ds_read_b128 v[52:55], v7 offset:2048
    v_mfma_f32_16x16x32_bf16 v[152:155], v[60:63], v[40:43], v[152:155]
    ds_read_b128 v[56:59], v7 offset:4096
    v_mfma_f32_16x16x32_bf16 v[156:159], v[60:63], v[44:47], v[156:159]
    ds_read_b128 v[16:19], v5 offset:0
    v_mfma_f32_16x16x32_bf16 v[160:163], v[64:67], v[32:35], v[160:163]
    ds_read_b128 v[20:23], v5 offset:1024
    v_mfma_f32_16x16x32_bf16 v[164:167], v[64:67], v[36:39], v[164:167]
    ds_read_b128 v[24:27], v5 offset:2048
    v_mfma_f32_16x16x32_bf16 v[168:171], v[64:67], v[40:43], v[168:171]
    ds_read_b128 v[28:31], v5 offset:3072
    v_mfma_f32_16x16x32_bf16 v[172:175], v[64:67], v[44:47], v[172:175]
    v_mfma_f32_16x16x32_bf16 v[176:179], v[68:71], v[32:35], v[176:179]
    v_mfma_f32_16x16x32_bf16 v[180:183], v[68:71], v[36:39], v[180:183]
    v_mfma_f32_16x16x32_bf16 v[184:187], v[68:71], v[40:43], v[184:187]
    v_mfma_f32_16x16x32_bf16 v[188:191], v[68:71], v[44:47], v[188:191]
    s_waitcnt lgkmcnt(0)
    v_mfma_f32_16x16x32_bf16 v[96:99], v[48:51], v[16:19], v[96:99]
    ds_read_b128 v[60:63], v7 offset:6144
    v_mfma_f32_16x16x32_bf16 v[100:103], v[48:51], v[20:23], v[100:103]
    ds_read_b128 v[64:67], v7 offset:8192
    v_mfma_f32_16x16x32_bf16 v[104:107], v[48:51], v[24:27], v[104:107]
    ds_read_b128 v[68:71], v7 offset:10240
    v_mfma_f32_16x16x32_bf16 v[108:111], v[48:51], v[28:31], v[108:111]
    ds_read_b128 v[32:35], v5 offset:8192
    v_mfma_f32_16x16x32_bf16 v[112:115], v[52:55], v[16:19], v[112:115]
    ds_read_b128 v[36:39], v5 offset:9216
    v_mfma_f32_16x16x32_bf16 v[116:119], v[52:55], v[20:23], v[116:119]
    ds_read_b128 v[40:43], v5 offset:10240
    v_mfma_f32_16x16x32_bf16 v[120:123], v[52:55], v[24:27], v[120:123]
    ds_read_b128 v[44:47], v5 offset:11264
    v_mfma_f32_16x16x32_bf16 v[124:127], v[52:55], v[28:31], v[124:127]
    v_mfma_f32_16x16x32_bf16 v[128:131], v[56:59], v[16:19], v[128:131]
    v_mfma_f32_16x16x32_bf16 v[132:135], v[56:59], v[20:23], v[132:135]
    v_mfma_f32_16x16x32_bf16 v[136:139], v[56:59], v[24:27], v[136:139]
    v_mfma_f32_16x16x32_bf16 v[140:143], v[56:59], v[28:31], v[140:143]
    s_waitcnt lgkmcnt(4)
    v_mfma_f32_16x16x32_bf16 v[144:147], v[60:63], v[16:19], v[144:147]
    ds_read_b128 v[48:51], v7 offset:12288
    v_mfma_f32_16x16x32_bf16 v[148:151], v[60:63], v[20:23], v[148:151]
    ds_read_b128 v[52:55], v7 offset:14336
    v_mfma_f32_16x16x32_bf16 v[152:155], v[60:63], v[24:27], v[152:155]
    ds_read_b128 v[56:59], v7 offset:16384
    v_mfma_f32_16x16x32_bf16 v[156:159], v[60:63], v[28:31], v[156:159]
    v_mfma_f32_16x16x32_bf16 v[160:163], v[64:67], v[16:19], v[160:163]
    v_mfma_f32_16x16x32_bf16 v[164:167], v[64:67], v[20:23], v[164:167]
    v_mfma_f32_16x16x32_bf16 v[168:171], v[64:67], v[24:27], v[168:171]
    v_mfma_f32_16x16x32_bf16 v[172:175], v[64:67], v[28:31], v[172:175]
    v_mfma_f32_16x16x32_bf16 v[176:179], v[68:71], v[16:19], v[176:179]
    v_mfma_f32_16x16x32_bf16 v[180:183], v[68:71], v[20:23], v[180:183]
    v_mfma_f32_16x16x32_bf16 v[184:187], v[68:71], v[24:27], v[184:187]
    v_mfma_f32_16x16x32_bf16 v[188:191], v[68:71], v[28:31], v[188:191]
    s_waitcnt lgkmcnt(0)
    v_mfma_f32_16x16x32_bf16 v[96:99], v[48:51], v[32:35], v[96:99]
    ds_read_b128 v[60:63], v7 offset:18432
    v_mfma_f32_16x16x32_bf16 v[100:103], v[48:51], v[36:39], v[100:103]
    ds_read_b128 v[64:67], v7 offset:20480
    v_mfma_f32_16x16x32_bf16 v[104:107], v[48:51], v[40:43], v[104:107]
    ds_read_b128 v[68:71], v7 offset:22528
    v_mfma_f32_16x16x32_bf16 v[108:111], v[48:51], v[44:47], v[108:111]
    v_mfma_f32_16x16x32_bf16 v[112:115], v[52:55], v[32:35], v[112:115]
    v_mfma_f32_16x16x32_bf16 v[116:119], v[52:55], v[36:39], v[116:119]
    v_mfma_f32_16x16x32_bf16 v[120:123], v[52:55], v[40:43], v[120:123]
    v_mfma_f32_16x16x32_bf16 v[124:127], v[52:55], v[44:47], v[124:127]
    v_mfma_f32_16x16x32_bf16 v[128:131], v[56:59], v[32:35], v[128:131]
    v_mfma_f32_16x16x32_bf16 v[132:135], v[56:59], v[36:39], v[132:135]
    v_mfma_f32_16x16x32_bf16 v[136:139], v[56:59], v[40:43], v[136:139]
    v_mfma_f32_16x16x32_bf16 v[140:143], v[56:59], v[44:47], v[140:143]
    s_waitcnt lgkmcnt(0)
    v_add_u32 v5, 0, v4
    v_add_u32 v7, 0, v6
    s_barrier
    v_mfma_f32_16x16x32_bf16 v[144:147], v[60:63], v[32:35], v[144:147]
    ds_read_b128 v[48:51], v7 offset:0
    v_mfma_f32_16x16x32_bf16 v[148:151], v[60:63], v[36:39], v[148:151]
    ds_read_b128 v[52:55], v7 offset:2048
    v_mfma_f32_16x16x32_bf16 v[152:155], v[60:63], v[40:43], v[152:155]
    ds_read_b128 v[56:59], v7 offset:4096
    v_mfma_f32_16x16x32_bf16 v[156:159], v[60:63], v[44:47], v[156:159]
    ds_read_b128 v[16:19], v5 offset:0
    v_mfma_f32_16x16x32_bf16 v[160:163], v[64:67], v[32:35], v[160:163]
    ds_read_b128 v[20:23], v5 offset:1024
    v_mfma_f32_16x16x32_bf16 v[164:167], v[64:67], v[36:39], v[164:167]
    ds_read_b128 v[24:27], v5 offset:2048
    v_mfma_f32_16x16x32_bf16 v[168:171], v[64:67], v[40:43], v[168:171]
    ds_read_b128 v[28:31], v5 offset:3072
    v_mfma_f32_16x16x32_bf16 v[172:175], v[64:67], v[44:47], v[172:175]
    v_mfma_f32_16x16x32_bf16 v[176:179], v[68:71], v[32:35], v[176:179]
    v_mfma_f32_16x16x32_bf16 v[180:183], v[68:71], v[36:39], v[180:183]
    v_mfma_f32_16x16x32_bf16 v[184:187], v[68:71], v[40:43], v[184:187]
    v_mfma_f32_16x16x32_bf16 v[188:191], v[68:71], v[44:47], v[188:191]
    s_waitcnt lgkmcnt(0)
    v_mfma_f32_16x16x32_bf16 v[96:99], v[48:51], v[16:19], v[96:99]
    ds_read_b128 v[60:63], v7 offset:6144
    v_mfma_f32_16x16x32_bf16 v[100:103], v[48:51], v[20:23], v[100:103]
    ds_read_b128 v[64:67], v7 offset:8192
    v_mfma_f32_16x16x32_bf16 v[104:107], v[48:51], v[24:27], v[104:107]
    ds_read_b128 v[68:71], v7 offset:10240
    v_mfma_f32_16x16x32_bf16 v[108:111], v[48:51], v[28:31], v[108:111]
    ds_read_b128 v[32:35], v5 offset:8192
    v_mfma_f32_16x16x32_bf16 v[112:115], v[52:55], v[16:19], v[112:115]
    ds_read_b128 v[36:39], v5 offset:9216
    v_mfma_f32_16x16x32_bf16 v[116:119], v[52:55], v[20:23], v[116:119]
    ds_read_b128 v[40:43], v5 offset:10240
    v_mfma_f32_16x16x32_bf16 v[120:123], v[52:55], v[24:27], v[120:123]
    ds_read_b128 v[44:47], v5 offset:11264
    v_mfma_f32_16x16x32_bf16 v[124:127], v[52:55], v[28:31], v[124:127]
    v_mfma_f32_16x16x32_bf16 v[128:131], v[56:59], v[16:19], v[128:131]
    v_mfma_f32_16x16x32_bf16 v[132:135], v[56:59], v[20:23], v[132:135]
    v_mfma_f32_16x16x32_bf16 v[136:139], v[56:59], v[24:27], v[136:139]
    v_mfma_f32_16x16x32_bf16 v[140:143], v[56:59], v[28:31], v[140:143]
    s_waitcnt lgkmcnt(4)
    v_mfma_f32_16x16x32_bf16 v[144:147], v[60:63], v[16:19], v[144:147]
    ds_read_b128 v[48:51], v7 offset:12288
    v_mfma_f32_16x16x32_bf16 v[148:151], v[60:63], v[20:23], v[148:151]
    ds_read_b128 v[52:55], v7 offset:14336
    v_mfma_f32_16x16x32_bf16 v[152:155], v[60:63], v[24:27], v[152:155]
    ds_read_b128 v[56:59], v7 offset:16384
    v_mfma_f32_16x16x32_bf16 v[156:159], v[60:63], v[28:31], v[156:159]
    v_mfma_f32_16x16x32_bf16 v[160:163], v[64:67], v[16:19], v[160:163]
    v_mfma_f32_16x16x32_bf16 v[164:167], v[64:67], v[20:23], v[164:167]
    v_mfma_f32_16x16x32_bf16 v[168:171], v[64:67], v[24:27], v[168:171]
    v_mfma_f32_16x16x32_bf16 v[172:175], v[64:67], v[28:31], v[172:175]
    v_mfma_f32_16x16x32_bf16 v[176:179], v[68:71], v[16:19], v[176:179]
    v_mfma_f32_16x16x32_bf16 v[180:183], v[68:71], v[20:23], v[180:183]
    v_mfma_f32_16x16x32_bf16 v[184:187], v[68:71], v[24:27], v[184:187]
    v_mfma_f32_16x16x32_bf16 v[188:191], v[68:71], v[28:31], v[188:191]
    s_waitcnt lgkmcnt(0)
    v_mfma_f32_16x16x32_bf16 v[96:99], v[48:51], v[32:35], v[96:99]
    ds_read_b128 v[60:63], v7 offset:18432
    v_mfma_f32_16x16x32_bf16 v[100:103], v[48:51], v[36:39], v[100:103]
    ds_read_b128 v[64:67], v7 offset:20480
    v_mfma_f32_16x16x32_bf16 v[104:107], v[48:51], v[40:43], v[104:107]
    ds_read_b128 v[68:71], v7 offset:22528
    v_mfma_f32_16x16x32_bf16 v[108:111], v[48:51], v[44:47], v[108:111]
    v_mfma_f32_16x16x32_bf16 v[112:115], v[52:55], v[32:35], v[112:115]
    v_mfma_f32_16x16x32_bf16 v[116:119], v[52:55], v[36:39], v[116:119]
    v_mfma_f32_16x16x32_bf16 v[120:123], v[52:55], v[40:43], v[120:123]
    v_mfma_f32_16x16x32_bf16 v[124:127], v[52:55], v[44:47], v[124:127]
    v_mfma_f32_16x16x32_bf16 v[128:131], v[56:59], v[32:35], v[128:131]
    v_mfma_f32_16x16x32_bf16 v[132:135], v[56:59], v[36:39], v[132:135]
    v_mfma_f32_16x16x32_bf16 v[136:139], v[56:59], v[40:43], v[136:139]
    v_mfma_f32_16x16x32_bf16 v[140:143], v[56:59], v[44:47], v[140:143]
    s_waitcnt lgkmcnt(0)
    v_add_u32 v5, 40960, v4
    v_add_u32 v7, 40960, v6
    s_barrier
    v_mfma_f32_16x16x32_bf16 v[144:147], v[60:63], v[32:35], v[144:147]
    ds_read_b128 v[48:51], v7 offset:0
    v_mfma_f32_16x16x32_bf16 v[148:151], v[60:63], v[36:39], v[148:151]
    ds_read_b128 v[52:55], v7 offset:2048
    v_mfma_f32_16x16x32_bf16 v[152:155], v[60:63], v[40:43], v[152:155]
    ds_read_b128 v[56:59], v7 offset:4096
    v_mfma_f32_16x16x32_bf16 v[156:159], v[60:63], v[44:47], v[156:159]
    ds_read_b128 v[16:19], v5 offset:0
    v_mfma_f32_16x16x32_bf16 v[160:163], v[64:67], v[32:35], v[160:163]
    ds_read_b128 v[20:23], v5 offset:1024
    v_mfma_f32_16x16x32_bf16 v[164:167], v[64:67], v[36:39], v[164:167]
    ds_read_b128 v[24:27], v5 offset:2048
    v_mfma_f32_16x16x32_bf16 v[168:171], v[64:67], v[40:43], v[168:171]
    ds_read_b128 v[28:31], v5 offset:3072
    v_mfma_f32_16x16x32_bf16 v[172:175], v[64:67], v[44:47], v[172:175]
    v_mfma_f32_16x16x32_bf16 v[176:179], v[68:71], v[32:35], v[176:179]
    v_mfma_f32_16x16x32_bf16 v[180:183], v[68:71], v[36:39], v[180:183]
    v_mfma_f32_16x16x32_bf16 v[184:187], v[68:71], v[40:43], v[184:187]
    v_mfma_f32_16x16x32_bf16 v[188:191], v[68:71], v[44:47], v[188:191]
    s_waitcnt lgkmcnt(0)
    v_mfma_f32_16x16x32_bf16 v[96:99], v[48:51], v[16:19], v[96:99]
    ds_read_b128 v[60:63], v7 offset:6144
    v_mfma_f32_16x16x32_bf16 v[100:103], v[48:51], v[20:23], v[100:103]
    ds_read_b128 v[64:67], v7 offset:8192
    v_mfma_f32_16x16x32_bf16 v[104:107], v[48:51], v[24:27], v[104:107]
    ds_read_b128 v[68:71], v7 offset:10240
    v_mfma_f32_16x16x32_bf16 v[108:111], v[48:51], v[28:31], v[108:111]
    ds_read_b128 v[32:35], v5 offset:8192
    v_mfma_f32_16x16x32_bf16 v[112:115], v[52:55], v[16:19], v[112:115]
    ds_read_b128 v[36:39], v5 offset:9216
    v_mfma_f32_16x16x32_bf16 v[116:119], v[52:55], v[20:23], v[116:119]
    ds_read_b128 v[40:43], v5 offset:10240
    v_mfma_f32_16x16x32_bf16 v[120:123], v[52:55], v[24:27], v[120:123]
    ds_read_b128 v[44:47], v5 offset:11264
    v_mfma_f32_16x16x32_bf16 v[124:127], v[52:55], v[28:31], v[124:127]
    v_mfma_f32_16x16x32_bf16 v[128:131], v[56:59], v[16:19], v[128:131]
    v_mfma_f32_16x16x32_bf16 v[132:135], v[56:59], v[20:23], v[132:135]
    v_mfma_f32_16x16x32_bf16 v[136:139], v[56:59], v[24:27], v[136:139]
    v_mfma_f32_16x16x32_bf16 v[140:143], v[56:59], v[28:31], v[140:143]
    s_waitcnt lgkmcnt(4)
    v_mfma_f32_16x16x32_bf16 v[144:147], v[60:63], v[16:19], v[144:147]
    ds_read_b128 v[48:51], v7 offset:12288
    v_mfma_f32_16x16x32_bf16 v[148:151], v[60:63], v[20:23], v[148:151]
    ds_read_b128 v[52:55], v7 offset:14336
    v_mfma_f32_16x16x32_bf16 v[152:155], v[60:63], v[24:27], v[152:155]
    ds_read_b128 v[56:59], v7 offset:16384
    v_mfma_f32_16x16x32_bf16 v[156:159], v[60:63], v[28:31], v[156:159]
    v_mfma_f32_16x16x32_bf16 v[160:163], v[64:67], v[16:19], v[160:163]
    v_mfma_f32_16x16x32_bf16 v[164:167], v[64:67], v[20:23], v[164:167]
    v_mfma_f32_16x16x32_bf16 v[168:171], v[64:67], v[24:27], v[168:171]
    v_mfma_f32_16x16x32_bf16 v[172:175], v[64:67], v[28:31], v[172:175]
    v_mfma_f32_16x16x32_bf16 v[176:179], v[68:71], v[16:19], v[176:179]
    v_mfma_f32_16x16x32_bf16 v[180:183], v[68:71], v[20:23], v[180:183]
    v_mfma_f32_16x16x32_bf16 v[184:187], v[68:71], v[24:27], v[184:187]
    v_mfma_f32_16x16x32_bf16 v[188:191], v[68:71], v[28:31], v[188:191]
    s_waitcnt lgkmcnt(0)
    v_mfma_f32_16x16x32_bf16 v[96:99], v[48:51], v[32:35], v[96:99]
    ds_read_b128 v[60:63], v7 offset:18432
    v_mfma_f32_16x16x32_bf16 v[100:103], v[48:51], v[36:39], v[100:103]
    ds_read_b128 v[64:67], v7 offset:20480
    v_mfma_f32_16x16x32_bf16 v[104:107], v[48:51], v[40:43], v[104:107]
    ds_read_b128 v[68:71], v7 offset:22528
    v_mfma_f32_16x16x32_bf16 v[108:111], v[48:51], v[44:47], v[108:111]
    v_mfma_f32_16x16x32_bf16 v[112:115], v[52:55], v[32:35], v[112:115]
    v_mfma_f32_16x16x32_bf16 v[116:119], v[52:55], v[36:39], v[116:119]
    v_mfma_f32_16x16x32_bf16 v[120:123], v[52:55], v[40:43], v[120:123]
    v_mfma_f32_16x16x32_bf16 v[124:127], v[52:55], v[44:47], v[124:127]
    v_mfma_f32_16x16x32_bf16 v[128:131], v[56:59], v[32:35], v[128:131]
    v_mfma_f32_16x16x32_bf16 v[132:135], v[56:59], v[36:39], v[132:135]
    v_mfma_f32_16x16x32_bf16 v[136:139], v[56:59], v[40:43], v[136:139]
    v_mfma_f32_16x16x32_bf16 v[140:143], v[56:59], v[44:47], v[140:143]
    s_waitcnt lgkmcnt(0)
    v_add_u32 v5, 81920, v4
    v_add_u32 v7, 81920, v6
    s_barrier
    v_mfma_f32_16x16x32_bf16 v[144:147], v[60:63], v[32:35], v[144:147]
    ds_read_b128 v[48:51], v7 offset:0
    v_mfma_f32_16x16x32_bf16 v[148:151], v[60:63], v[36:39], v[148:151]
    ds_read_b128 v[52:55], v7 offset:2048
    v_mfma_f32_16x16x32_bf16 v[152:155], v[60:63], v[40:43], v[152:155]
    ds_read_b128 v[56:59], v7 offset:4096
    v_mfma_f32_16x16x32_bf16 v[156:159], v[60:63], v[44:47], v[156:159]
    ds_read_b128 v[16:19], v5 offset:0
    v_mfma_f32_16x16x32_bf16 v[160:163], v[64:67], v[32:35], v[160:163]
    ds_read_b128 v[20:23], v5 offset:1024
    v_mfma_f32_16x16x32_bf16 v[164:167], v[64:67], v[36:39], v[164:167]
    ds_read_b128 v[24:27], v5 offset:2048
    v_mfma_f32_16x16x32_bf16 v[168:171], v[64:67], v[40:43], v[168:171]
    ds_read_b128 v[28:31], v5 offset:3072
    v_mfma_f32_16x16x32_bf16 v[172:175], v[64:67], v[44:47], v[172:175]
    v_mfma_f32_16x16x32_bf16 v[176:179], v[68:71], v[32:35], v[176:179]
    v_mfma_f32_16x16x32_bf16 v[180:183], v[68:71], v[36:39], v[180:183]
    v_mfma_f32_16x16x32_bf16 v[184:187], v[68:71], v[40:43], v[184:187]
    v_mfma_f32_16x16x32_bf16 v[188:191], v[68:71], v[44:47], v[188:191]
    s_waitcnt lgkmcnt(0)
    v_mfma_f32_16x16x32_bf16 v[96:99], v[48:51], v[16:19], v[96:99]
    ds_read_b128 v[60:63], v7 offset:6144
    v_mfma_f32_16x16x32_bf16 v[100:103], v[48:51], v[20:23], v[100:103]
    ds_read_b128 v[64:67], v7 offset:8192
    v_mfma_f32_16x16x32_bf16 v[104:107], v[48:51], v[24:27], v[104:107]
    ds_read_b128 v[68:71], v7 offset:10240
    v_mfma_f32_16x16x32_bf16 v[108:111], v[48:51], v[28:31], v[108:111]
    ds_read_b128 v[32:35], v5 offset:8192
    v_mfma_f32_16x16x32_bf16 v[112:115], v[52:55], v[16:19], v[112:115]
    ds_read_b128 v[36:39], v5 offset:9216
    v_mfma_f32_16x16x32_bf16 v[116:119], v[52:55], v[20:23], v[116:119]
    ds_read_b128 v[40:43], v5 offset:10240
    v_mfma_f32_16x16x32_bf16 v[120:123], v[52:55], v[24:27], v[120:123]
    ds_read_b128 v[44:47], v5 offset:11264
    v_mfma_f32_16x16x32_bf16 v[124:127], v[52:55], v[28:31], v[124:127]
    v_mfma_f32_16x16x32_bf16 v[128:131], v[56:59], v[16:19], v[128:131]
    v_mfma_f32_16x16x32_bf16 v[132:135], v[56:59], v[20:23], v[132:135]
    v_mfma_f32_16x16x32_bf16 v[136:139], v[56:59], v[24:27], v[136:139]
    v_mfma_f32_16x16x32_bf16 v[140:143], v[56:59], v[28:31], v[140:143]
    s_waitcnt lgkmcnt(4)
    v_mfma_f32_16x16x32_bf16 v[144:147], v[60:63], v[16:19], v[144:147]
    ds_read_b128 v[48:51], v7 offset:12288
    v_mfma_f32_16x16x32_bf16 v[148:151], v[60:63], v[20:23], v[148:151]
    ds_read_b128 v[52:55], v7 offset:14336
    v_mfma_f32_16x16x32_bf16 v[152:155], v[60:63], v[24:27], v[152:155]
    ds_read_b128 v[56:59], v7 offset:16384
    v_mfma_f32_16x16x32_bf16 v[156:159], v[60:63], v[28:31], v[156:159]
    v_mfma_f32_16x16x32_bf16 v[160:163], v[64:67], v[16:19], v[160:163]
    v_mfma_f32_16x16x32_bf16 v[164:167], v[64:67], v[20:23], v[164:167]
    v_mfma_f32_16x16x32_bf16 v[168:171], v[64:67], v[24:27], v[168:171]
    v_mfma_f32_16x16x32_bf16 v[172:175], v[64:67], v[28:31], v[172:175]
    v_mfma_f32_16x16x32_bf16 v[176:179], v[68:71], v[16:19], v[176:179]
    v_mfma_f32_16x16x32_bf16 v[180:183], v[68:71], v[20:23], v[180:183]
    v_mfma_f32_16x16x32_bf16 v[184:187], v[68:71], v[24:27], v[184:187]
    v_mfma_f32_16x16x32_bf16 v[188:191], v[68:71], v[28:31], v[188:191]
    s_waitcnt lgkmcnt(0)
    v_mfma_f32_16x16x32_bf16 v[96:99], v[48:51], v[32:35], v[96:99]
    ds_read_b128 v[60:63], v7 offset:18432
    v_mfma_f32_16x16x32_bf16 v[100:103], v[48:51], v[36:39], v[100:103]
    ds_read_b128 v[64:67], v7 offset:20480
    v_mfma_f32_16x16x32_bf16 v[104:107], v[48:51], v[40:43], v[104:107]
    ds_read_b128 v[68:71], v7 offset:22528
    v_mfma_f32_16x16x32_bf16 v[108:111], v[48:51], v[44:47], v[108:111]
    v_mfma_f32_16x16x32_bf16 v[112:115], v[52:55], v[32:35], v[112:115]
    v_mfma_f32_16x16x32_bf16 v[116:119], v[52:55], v[36:39], v[116:119]
    v_mfma_f32_16x16x32_bf16 v[120:123], v[52:55], v[40:43], v[120:123]
    v_mfma_f32_16x16x32_bf16 v[124:127], v[52:55], v[44:47], v[124:127]
    v_mfma_f32_16x16x32_bf16 v[128:131], v[56:59], v[32:35], v[128:131]
    v_mfma_f32_16x16x32_bf16 v[132:135], v[56:59], v[36:39], v[132:135]
    v_mfma_f32_16x16x32_bf16 v[136:139], v[56:59], v[40:43], v[136:139]
    v_mfma_f32_16x16x32_bf16 v[140:143], v[56:59], v[44:47], v[140:143]
    s_waitcnt lgkmcnt(0)
    v_add_u32 v5, 122880, v4
    v_add_u32 v7, 122880, v6
    s_barrier
    v_mfma_f32_16x16x32_bf16 v[144:147], v[60:63], v[32:35], v[144:147]
    ds_read_b128 v[48:51], v7 offset:0
    v_mfma_f32_16x16x32_bf16 v[148:151], v[60:63], v[36:39], v[148:151]
    ds_read_b128 v[52:55], v7 offset:2048
    v_mfma_f32_16x16x32_bf16 v[152:155], v[60:63], v[40:43], v[152:155]
    ds_read_b128 v[56:59], v7 offset:4096
    v_mfma_f32_16x16x32_bf16 v[156:159], v[60:63], v[44:47], v[156:159]
    ds_read_b128 v[16:19], v5 offset:0
    v_mfma_f32_16x16x32_bf16 v[160:163], v[64:67], v[32:35], v[160:163]
    ds_read_b128 v[20:23], v5 offset:1024
    v_mfma_f32_16x16x32_bf16 v[164:167], v[64:67], v[36:39], v[164:167]
    ds_read_b128 v[24:27], v5 offset:2048
    v_mfma_f32_16x16x32_bf16 v[168:171], v[64:67], v[40:43], v[168:171]
    ds_read_b128 v[28:31], v5 offset:3072
    v_mfma_f32_16x16x32_bf16 v[172:175], v[64:67], v[44:47], v[172:175]
    v_mfma_f32_16x16x32_bf16 v[176:179], v[68:71], v[32:35], v[176:179]
    v_mfma_f32_16x16x32_bf16 v[180:183], v[68:71], v[36:39], v[180:183]
    v_mfma_f32_16x16x32_bf16 v[184:187], v[68:71], v[40:43], v[184:187]
    v_mfma_f32_16x16x32_bf16 v[188:191], v[68:71], v[44:47], v[188:191]
    s_waitcnt lgkmcnt(0)
    v_mfma_f32_16x16x32_bf16 v[96:99], v[48:51], v[16:19], v[96:99]
    ds_read_b128 v[60:63], v7 offset:6144
    v_mfma_f32_16x16x32_bf16 v[100:103], v[48:51], v[20:23], v[100:103]
    ds_read_b128 v[64:67], v7 offset:8192
    v_mfma_f32_16x16x32_bf16 v[104:107], v[48:51], v[24:27], v[104:107]
    ds_read_b128 v[68:71], v7 offset:10240
    v_mfma_f32_16x16x32_bf16 v[108:111], v[48:51], v[28:31], v[108:111]
    ds_read_b128 v[32:35], v5 offset:8192
    v_mfma_f32_16x16x32_bf16 v[112:115], v[52:55], v[16:19], v[112:115]
    ds_read_b128 v[36:39], v5 offset:9216
    v_mfma_f32_16x16x32_bf16 v[116:119], v[52:55], v[20:23], v[116:119]
    ds_read_b128 v[40:43], v5 offset:10240
    v_mfma_f32_16x16x32_bf16 v[120:123], v[52:55], v[24:27], v[120:123]
    ds_read_b128 v[44:47], v5 offset:11264
    v_mfma_f32_16x16x32_bf16 v[124:127], v[52:55], v[28:31], v[124:127]
    v_mfma_f32_16x16x32_bf16 v[128:131], v[56:59], v[16:19], v[128:131]
    v_mfma_f32_16x16x32_bf16 v[132:135], v[56:59], v[20:23], v[132:135]
    v_mfma_f32_16x16x32_bf16 v[136:139], v[56:59], v[24:27], v[136:139]
    v_mfma_f32_16x16x32_bf16 v[140:143], v[56:59], v[28:31], v[140:143]
    s_waitcnt lgkmcnt(4)
    v_mfma_f32_16x16x32_bf16 v[144:147], v[60:63], v[16:19], v[144:147]
    ds_read_b128 v[48:51], v7 offset:12288
    v_mfma_f32_16x16x32_bf16 v[148:151], v[60:63], v[20:23], v[148:151]
    ds_read_b128 v[52:55], v7 offset:14336
    v_mfma_f32_16x16x32_bf16 v[152:155], v[60:63], v[24:27], v[152:155]
    ds_read_b128 v[56:59], v7 offset:16384
    v_mfma_f32_16x16x32_bf16 v[156:159], v[60:63], v[28:31], v[156:159]
    v_mfma_f32_16x16x32_bf16 v[160:163], v[64:67], v[16:19], v[160:163]
    v_mfma_f32_16x16x32_bf16 v[164:167], v[64:67], v[20:23], v[164:167]
    v_mfma_f32_16x16x32_bf16 v[168:171], v[64:67], v[24:27], v[168:171]
    v_mfma_f32_16x16x32_bf16 v[172:175], v[64:67], v[28:31], v[172:175]
    v_mfma_f32_16x16x32_bf16 v[176:179], v[68:71], v[16:19], v[176:179]
    v_mfma_f32_16x16x32_bf16 v[180:183], v[68:71], v[20:23], v[180:183]
    v_mfma_f32_16x16x32_bf16 v[184:187], v[68:71], v[24:27], v[184:187]
    v_mfma_f32_16x16x32_bf16 v[188:191], v[68:71], v[28:31], v[188:191]
    s_waitcnt lgkmcnt(0)
    v_mfma_f32_16x16x32_bf16 v[96:99], v[48:51], v[32:35], v[96:99]
    ds_read_b128 v[60:63], v7 offset:18432
    v_mfma_f32_16x16x32_bf16 v[100:103], v[48:51], v[36:39], v[100:103]
    ds_read_b128 v[64:67], v7 offset:20480
    v_mfma_f32_16x16x32_bf16 v[104:107], v[48:51], v[40:43], v[104:107]
    ds_read_b128 v[68:71], v7 offset:22528
    v_mfma_f32_16x16x32_bf16 v[108:111], v[48:51], v[44:47], v[108:111]
    v_mfma_f32_16x16x32_bf16 v[112:115], v[52:55], v[32:35], v[112:115]
    v_mfma_f32_16x16x32_bf16 v[116:119], v[52:55], v[36:39], v[116:119]
    v_mfma_f32_16x16x32_bf16 v[120:123], v[52:55], v[40:43], v[120:123]
    v_mfma_f32_16x16x32_bf16 v[124:127], v[52:55], v[44:47], v[124:127]
    v_mfma_f32_16x16x32_bf16 v[128:131], v[56:59], v[32:35], v[128:131]
    v_mfma_f32_16x16x32_bf16 v[132:135], v[56:59], v[36:39], v[132:135]
    v_mfma_f32_16x16x32_bf16 v[136:139], v[56:59], v[40:43], v[136:139]
    v_mfma_f32_16x16x32_bf16 v[140:143], v[56:59], v[44:47], v[140:143]
    s_waitcnt lgkmcnt(0)
    v_add_u32 v5, 0, v4
    v_add_u32 v7, 0, v6
    s_barrier
    v_mfma_f32_16x16x32_bf16 v[144:147], v[60:63], v[32:35], v[144:147]
    ds_read_b128 v[48:51], v7 offset:0
    v_mfma_f32_16x16x32_bf16 v[148:151], v[60:63], v[36:39], v[148:151]
    ds_read_b128 v[52:55], v7 offset:2048
    v_mfma_f32_16x16x32_bf16 v[152:155], v[60:63], v[40:43], v[152:155]
    ds_read_b128 v[56:59], v7 offset:4096
    v_mfma_f32_16x16x32_bf16 v[156:159], v[60:63], v[44:47], v[156:159]
    ds_read_b128 v[16:19], v5 offset:0
    v_mfma_f32_16x16x32_bf16 v[160:163], v[64:67], v[32:35], v[160:163]
    ds_read_b128 v[20:23], v5 offset:1024
    v_mfma_f32_16x16x32_bf16 v[164:167], v[64:67], v[36:39], v[164:167]
    ds_read_b128 v[24:27], v5 offset:2048
    v_mfma_f32_16x16x32_bf16 v[168:171], v[64:67], v[40:43], v[168:171]
    ds_read_b128 v[28:31], v5 offset:3072
    v_mfma_f32_16x16x32_bf16 v[172:175], v[64:67], v[44:47], v[172:175]
    v_mfma_f32_16x16x32_bf16 v[176:179], v[68:71], v[32:35], v[176:179]
    v_mfma_f32_16x16x32_bf16 v[180:183], v[68:71], v[36:39], v[180:183]
    v_mfma_f32_16x16x32_bf16 v[184:187], v[68:71], v[40:43], v[184:187]
    v_mfma_f32_16x16x32_bf16 v[188:191], v[68:71], v[44:47], v[188:191]
    s_waitcnt lgkmcnt(0)
    v_mfma_f32_16x16x32_bf16 v[96:99], v[48:51], v[16:19], v[96:99]
    ds_read_b128 v[60:63], v7 offset:6144
    v_mfma_f32_16x16x32_bf16 v[100:103], v[48:51], v[20:23], v[100:103]
    ds_read_b128 v[64:67], v7 offset:8192
    v_mfma_f32_16x16x32_bf16 v[104:107], v[48:51], v[24:27], v[104:107]
    ds_read_b128 v[68:71], v7 offset:10240
    v_mfma_f32_16x16x32_bf16 v[108:111], v[48:51], v[28:31], v[108:111]
    ds_read_b128 v[32:35], v5 offset:8192
    v_mfma_f32_16x16x32_bf16 v[112:115], v[52:55], v[16:19], v[112:115]
    ds_read_b128 v[36:39], v5 offset:9216
    v_mfma_f32_16x16x32_bf16 v[116:119], v[52:55], v[20:23], v[116:119]
    ds_read_b128 v[40:43], v5 offset:10240
    v_mfma_f32_16x16x32_bf16 v[120:123], v[52:55], v[24:27], v[120:123]
    ds_read_b128 v[44:47], v5 offset:11264
    v_mfma_f32_16x16x32_bf16 v[124:127], v[52:55], v[28:31], v[124:127]
    v_mfma_f32_16x16x32_bf16 v[128:131], v[56:59], v[16:19], v[128:131]
    v_mfma_f32_16x16x32_bf16 v[132:135], v[56:59], v[20:23], v[132:135]
    v_mfma_f32_16x16x32_bf16 v[136:139], v[56:59], v[24:27], v[136:139]
    v_mfma_f32_16x16x32_bf16 v[140:143], v[56:59], v[28:31], v[140:143]
    s_waitcnt lgkmcnt(4)
    v_mfma_f32_16x16x32_bf16 v[144:147], v[60:63], v[16:19], v[144:147]
    ds_read_b128 v[48:51], v7 offset:12288
    v_mfma_f32_16x16x32_bf16 v[148:151], v[60:63], v[20:23], v[148:151]
    ds_read_b128 v[52:55], v7 offset:14336
    v_mfma_f32_16x16x32_bf16 v[152:155], v[60:63], v[24:27], v[152:155]
    ds_read_b128 v[56:59], v7 offset:16384
    v_mfma_f32_16x16x32_bf16 v[156:159], v[60:63], v[28:31], v[156:159]
    v_mfma_f32_16x16x32_bf16 v[160:163], v[64:67], v[16:19], v[160:163]
    v_mfma_f32_16x16x32_bf16 v[164:167], v[64:67], v[20:23], v[164:167]
    v_mfma_f32_16x16x32_bf16 v[168:171], v[64:67], v[24:27], v[168:171]
    v_mfma_f32_16x16x32_bf16 v[172:175], v[64:67], v[28:31], v[172:175]
    v_mfma_f32_16x16x32_bf16 v[176:179], v[68:71], v[16:19], v[176:179]
    v_mfma_f32_16x16x32_bf16 v[180:183], v[68:71], v[20:23], v[180:183]
    v_mfma_f32_16x16x32_bf16 v[184:187], v[68:71], v[24:27], v[184:187]
    v_mfma_f32_16x16x32_bf16 v[188:191], v[68:71], v[28:31], v[188:191]
    s_waitcnt lgkmcnt(0)
    v_mfma_f32_16x16x32_bf16 v[96:99], v[48:51], v[32:35], v[96:99]
    ds_read_b128 v[60:63], v7 offset:18432
    v_mfma_f32_16x16x32_bf16 v[100:103], v[48:51], v[36:39], v[100:103]
    ds_read_b128 v[64:67], v7 offset:20480
    v_mfma_f32_16x16x32_bf16 v[104:107], v[48:51], v[40:43], v[104:107]
    ds_read_b128 v[68:71], v7 offset:22528
    v_mfma_f32_16x16x32_bf16 v[108:111], v[48:51], v[44:47], v[108:111]
    s_waitcnt vmcnt(0)
    v_mfma_f32_16x16x32_bf16 v[112:115], v[52:55], v[32:35], v[112:115]
    v_max3_u32 v15, v216, v220, v224
    v_mfma_f32_16x16x32_bf16 v[116:119], v[52:55], v[36:39], v[116:119]
    v_max3_u32 v8, v228, v232, v236
    v_mfma_f32_16x16x32_bf16 v[120:123], v[52:55], v[40:43], v[120:123]
    v_max_u32 v15, v15, v8
    v_mfma_f32_16x16x32_bf16 v[124:127], v[52:55], v[44:47], v[124:127]
    v_cmp_eq_u32 vcc, -1, v15
    v_mfma_f32_16x16x32_bf16 v[128:131], v[56:59], v[32:35], v[128:131]
    v_mfma_f32_16x16x32_bf16 v[132:135], v[56:59], v[36:39], v[132:135]
    v_mfma_f32_16x16x32_bf16 v[136:139], v[56:59], v[40:43], v[136:139]
    v_mfma_f32_16x16x32_bf16 v[140:143], v[56:59], v[44:47], v[140:143]
    s_waitcnt lgkmcnt(0)
    v_add_u32 v5, 40960, v4
    v_add_u32 v7, 40960, v6
    s_barrier
    v_mfma_f32_16x16x32_bf16 v[144:147], v[60:63], v[32:35], v[144:147]
    ds_read_b128 v[48:51], v7 offset:0
    v_mfma_f32_16x16x32_bf16 v[148:151], v[60:63], v[36:39], v[148:151]
    ds_read_b128 v[52:55], v7 offset:2048
    v_mfma_f32_16x16x32_bf16 v[152:155], v[60:63], v[40:43], v[152:155]
    ds_read_b128 v[56:59], v7 offset:4096
    v_mfma_f32_16x16x32_bf16 v[156:159], v[60:63], v[44:47], v[156:159]
    ds_read_b128 v[16:19], v5 offset:0
    v_mfma_f32_16x16x32_bf16 v[160:163], v[64:67], v[32:35], v[160:163]
    ds_read_b128 v[20:23], v5 offset:1024
    v_mfma_f32_16x16x32_bf16 v[164:167], v[64:67], v[36:39], v[164:167]
    ds_read_b128 v[24:27], v5 offset:2048
    v_mfma_f32_16x16x32_bf16 v[168:171], v[64:67], v[40:43], v[168:171]
    ds_read_b128 v[28:31], v5 offset:3072
    v_mfma_f32_16x16x32_bf16 v[172:175], v[64:67], v[44:47], v[172:175]
    v_mfma_f32_16x16x32_bf16 v[176:179], v[68:71], v[32:35], v[176:179]
    v_mfma_f32_16x16x32_bf16 v[180:183], v[68:71], v[36:39], v[180:183]
    v_mfma_f32_16x16x32_bf16 v[184:187], v[68:71], v[40:43], v[184:187]
    v_mfma_f32_16x16x32_bf16 v[188:191], v[68:71], v[44:47], v[188:191]
    s_waitcnt lgkmcnt(0)
    ds_read_b128 v[60:63], v7 offset:6144
    v_mfma_f32_16x16x32_bf16 v[96:99], v[48:51], v[16:19], v[96:99]
    ds_read_b128 v[64:67], v7 offset:8192
    v_mfma_f32_16x16x32_bf16 v[100:103], v[48:51], v[20:23], v[100:103]
    ds_read_b128 v[68:71], v7 offset:10240
    v_mfma_f32_16x16x32_bf16 v[104:107], v[48:51], v[24:27], v[104:107]
    ds_read_b128 v[32:35], v5 offset:8192
    v_mfma_f32_16x16x32_bf16 v[108:111], v[48:51], v[28:31], v[108:111]
    ds_read_b128 v[36:39], v5 offset:9216
    v_mfma_f32_16x16x32_bf16 v[112:115], v[52:55], v[16:19], v[112:115]
    ds_read_b128 v[40:43], v5 offset:10240
    v_mfma_f32_16x16x32_bf16 v[116:119], v[52:55], v[20:23], v[116:119]
    ds_read_b128 v[44:47], v5 offset:11264
    v_mfma_f32_16x16x32_bf16 v[120:123], v[52:55], v[24:27], v[120:123]
    ds_read_b128 v[72:75], v7 offset:12288
    v_mfma_f32_16x16x32_bf16 v[124:127], v[52:55], v[28:31], v[124:127]
    ds_read_b128 v[84:87], v7 offset:18432
    v_mfma_f32_16x16x32_bf16 v[128:131], v[56:59], v[16:19], v[128:131]
    ds_read_b128 v[76:79], v7 offset:14336
    v_mfma_f32_16x16x32_bf16 v[132:135], v[56:59], v[20:23], v[132:135]
    ds_read_b128 v[88:91], v7 offset:20480
    v_mfma_f32_16x16x32_bf16 v[136:139], v[56:59], v[24:27], v[136:139]
    ds_read_b128 v[80:83], v7 offset:16384
    v_mfma_f32_16x16x32_bf16 v[140:143], v[56:59], v[28:31], v[140:143]
    ds_read_b128 v[92:95], v7 offset:22528
    s_waitcnt lgkmcnt(0)
    s_barrier
    ds_read_b64 v[192:193], v12 offset:0
    ds_read_b64 v[196:197], v12 offset:512
    ds_read_b64 v[200:201], v12 offset:10240
    ds_read_b64 v[204:205], v12 offset:10752
    v_mfma_f32_16x16x32_bf16 v[96:99], v[72:75], v[32:35], v[96:99]
    v_mfma_f32_16x16x32_bf16 v[100:103], v[72:75], v[36:39], v[100:103]
    v_mfma_f32_16x16x32_bf16 v[104:107], v[72:75], v[40:43], v[104:107]
    v_mfma_f32_16x16x32_bf16 v[108:111], v[72:75], v[44:47], v[108:111]
    v_mfma_f32_16x16x32_bf16 v[144:147], v[60:63], v[16:19], v[144:147]
    v_mfma_f32_16x16x32_bf16 v[148:151], v[60:63], v[20:23], v[148:151]
    v_mfma_f32_16x16x32_bf16 v[152:155], v[60:63], v[24:27], v[152:155]
    v_mfma_f32_16x16x32_bf16 v[156:159], v[60:63], v[28:31], v[156:159]
    v_mfma_f32_16x16x32_bf16 v[144:147], v[84:87], v[32:35], v[144:147]
    v_mfma_f32_16x16x32_bf16 v[148:151], v[84:87], v[36:39], v[148:151]
    v_mfma_f32_16x16x32_bf16 v[152:155], v[84:87], v[40:43], v[152:155]
    v_mfma_f32_16x16x32_bf16 v[156:159], v[84:87], v[44:47], v[156:159]
    s_cbranch_vccnz L4_retrycs
L4_okcs:
    s_waitcnt lgkmcnt(0)
    v_pk_fma_f32 v[96:97], v[192:193], v[216:217], v[96:97] op_sel_hi:[0,1,1] neg_lo:[1,0,0] neg_hi:[1,0,0]
    v_pk_fma_f32 v[98:99], v[192:193], v[218:219], v[98:99] op_sel_hi:[0,1,1] neg_lo:[1,0,0] neg_hi:[1,0,0]
    v_max_f32 v96, 0, v96
    v_max_f32 v97, 0, v97
    v_max_f32 v98, 0, v98
    v_max_f32 v99, 0, v99
    v_pk_mul_f32 v[96:97], v[192:193], v[96:97] op_sel:[1,0] op_sel_hi:[1,1]
    v_pk_mul_f32 v[98:99], v[192:193], v[98:99] op_sel:[1,0] op_sel_hi:[1,1]
    v_pk_fma_f32 v[100:101], v[196:197], v[216:217], v[100:101] op_sel_hi:[0,1,1] neg_lo:[1,0,0] neg_hi:[1,0,0]
    v_pk_fma_f32 v[102:103], v[196:197], v[218:219], v[102:103] op_sel_hi:[0,1,1] neg_lo:[1,0,0] neg_hi:[1,0,0]
    v_max_f32 v100, 0, v100
    v_max_f32 v101, 0, v101
    v_max_f32 v102, 0, v102
    v_max_f32 v103, 0, v103
    v_pk_mul_f32 v[100:101], v[196:197], v[100:101] op_sel:[1,0] op_sel_hi:[1,1]
    v_pk_mul_f32 v[102:103], v[196:197], v[102:103] op_sel:[1,0] op_sel_hi:[1,1]
    v_pk_fma_f32 v[144:145], v[192:193], v[228:229], v[144:145] op_sel_hi:[0,1,1] neg_lo:[1,0,0] neg_hi:[1,0,0]
    v_pk_fma_f32 v[146:147], v[192:193], v[230:231], v[146:147] op_sel_hi:[0,1,1] neg_lo:[1,0,0] neg_hi:[1,0,0]
    v_pk_mul_f32 v[144:145], v[96:97], v[144:145]
    v_pk_mul_f32 v[146:147], v[98:99], v[146:147]
    v_pk_fma_f32 v[148:149], v[196:197], v[228:229], v[148:149] op_sel_hi:[0,1,1] neg_lo:[1,0,0] neg_hi:[1,0,0]
    v_pk_fma_f32 v[150:151], v[196:197], v[230:231], v[150:151] op_sel_hi:[0,1,1] neg_lo:[1,0,0] neg_hi:[1,0,0]
    v_pk_mul_f32 v[148:149], v[100:101], v[148:149]
    v_pk_mul_f32 v[150:151], v[102:103], v[150:151]
    v_cvt_pk_bf16_f32 v96, v144, v145
    v_cvt_pk_bf16_f32 v97, v146, v147
    v_cvt_pk_bf16_f32 v98, v148, v149
    v_cvt_pk_bf16_f32 v99, v150, v151
    s_nop 0
    v_permlane16_swap_b32 v96, v98
    v_permlane16_swap_b32 v97, v99
    v_and_b32 v96, v245, v96
    buffer_store_dwordx4 v[96:99], v14, s[24:27], s48 offen offset:0 sc1
    v_pk_fma_f32 v[104:105], v[200:201], v[216:217], v[104:105] op_sel_hi:[0,1,1] neg_lo:[1,0,0] neg_hi:[1,0,0]
    v_pk_fma_f32 v[106:107], v[200:201], v[218:219], v[106:107] op_sel_hi:[0,1,1] neg_lo:[1,0,0] neg_hi:[1,0,0]
    v_max_f32 v104, 0, v104
    v_max_f32 v105, 0, v105
    v_max_f32 v106, 0, v106
    v_max_f32 v107, 0, v107
    v_pk_mul_f32 v[104:105], v[200:201], v[104:105] op_sel:[1,0] op_sel_hi:[1,1]
    v_pk_mul_f32 v[106:107], v[200:201], v[106:107] op_sel:[1,0] op_sel_hi:[1,1]
    v_pk_fma_f32 v[108:109], v[204:205], v[216:217], v[108:109] op_sel_hi:[0,1,1] neg_lo:[1,0,0] neg_hi:[1,0,0]
    v_pk_fma_f32 v[110:111], v[204:205], v[218:219], v[110:111] op_sel_hi:[0,1,1] neg_lo:[1,0,0] neg_hi:[1,0,0]
    v_max_f32 v108, 0, v108
    v_max_f32 v109, 0, v109
    v_max_f32 v110, 0, v110
    v_max_f32 v111, 0, v111
    v_pk_mul_f32 v[108:109], v[204:205], v[108:109] op_sel:[1,0] op_sel_hi:[1,1]
    v_pk_mul_f32 v[110:111], v[204:205], v[110:111] op_sel:[1,0] op_sel_hi:[1,1]
    v_pk_fma_f32 v[152:153], v[200:201], v[228:229], v[152:153] op_sel_hi:[0,1,1] neg_lo:[1,0,0] neg_hi:[1,0,0]
    v_pk_fma_f32 v[154:155], v[200:201], v[230:231], v[154:155] op_sel_hi:[0,1,1] neg_lo:[1,0,0] neg_hi:[1,0,0]
    v_pk_mul_f32 v[152:153], v[104:105], v[152:153]
    v_pk_mul_f32 v[154:155], v[106:107], v[154:155]
    v_pk_fma_f32 v[156:157], v[204:205], v[228:229], v[156:157] op_sel_hi:[0,1,1] neg_lo:[1,0,0] neg_hi:[1,0,0]
    v_pk_fma_f32 v[158:159], v[204:205], v[230:231], v[158:159] op_sel_hi:[0,1,1] neg_lo:[1,0,0] neg_hi:[1,0,0]
    v_pk_mul_f32 v[156:157], v[108:109], v[156:157]
    v_pk_mul_f32 v[158:159], v[110:111], v[158:159]
    v_cvt_pk_bf16_f32 v104, v152, v153
    v_cvt_pk_bf16_f32 v105, v154, v155
    v_cvt_pk_bf16_f32 v106, v156, v157
    v_cvt_pk_bf16_f32 v107, v158, v159
    s_nop 0
    v_permlane16_swap_b32 v104, v106
    v_permlane16_swap_b32 v105, v107
    v_and_b32 v104, v245, v104
    buffer_store_dwordx4 v[104:107], v14, s[24:27], s49 offen offset:0 sc1
    v_mfma_f32_16x16x32_bf16 v[112:115], v[76:79], v[32:35], v[112:115]
    v_mfma_f32_16x16x32_bf16 v[116:119], v[76:79], v[36:39], v[116:119]
    v_mfma_f32_16x16x32_bf16 v[120:123], v[76:79], v[40:43], v[120:123]
    v_mfma_f32_16x16x32_bf16 v[124:127], v[76:79], v[44:47], v[124:127]
    v_mfma_f32_16x16x32_bf16 v[160:163], v[64:67], v[16:19], v[160:163]
    v_mfma_f32_16x16x32_bf16 v[164:167], v[64:67], v[20:23], v[164:167]
    v_mfma_f32_16x16x32_bf16 v[168:171], v[64:67], v[24:27], v[168:171]
    v_mfma_f32_16x16x32_bf16 v[172:175], v[64:67], v[28:31], v[172:175]
    v_mfma_f32_16x16x32_bf16 v[160:163], v[88:91], v[32:35], v[160:163]
    v_mfma_f32_16x16x32_bf16 v[164:167], v[88:91], v[36:39], v[164:167]
    v_mfma_f32_16x16x32_bf16 v[168:171], v[88:91], v[40:43], v[168:171]
    v_mfma_f32_16x16x32_bf16 v[172:175], v[88:91], v[44:47], v[172:175]
    v_pk_fma_f32 v[112:113], v[192:193], v[220:221], v[112:113] op_sel_hi:[0,1,1] neg_lo:[1,0,0] neg_hi:[1,0,0]
    v_pk_fma_f32 v[114:115], v[192:193], v[222:223], v[114:115] op_sel_hi:[0,1,1] neg_lo:[1,0,0] neg_hi:[1,0,0]
    v_max_f32 v112, 0, v112
    v_max_f32 v113, 0, v113
    v_max_f32 v114, 0, v114
    v_max_f32 v115, 0, v115
    v_pk_mul_f32 v[112:113], v[192:193], v[112:113] op_sel:[1,0] op_sel_hi:[1,1]
    v_pk_mul_f32 v[114:115], v[192:193], v[114:115] op_sel:[1,0] op_sel_hi:[1,1]
    v_pk_fma_f32 v[116:117], v[196:197], v[220:221], v[116:117] op_sel_hi:[0,1,1] neg_lo:[1,0,0] neg_hi:[1,0,0]
    v_pk_fma_f32 v[118:119], v[196:197], v[222:223], v[118:119] op_sel_hi:[0,1,1] neg_lo:[1,0,0] neg_hi:[1,0,0]
    v_max_f32 v116, 0, v116
    v_max_f32 v117, 0, v117
    v_max_f32 v118, 0, v118
    v_max_f32 v119, 0, v119
    v_pk_mul_f32 v[116:117], v[196:197], v[116:117] op_sel:[1,0] op_sel_hi:[1,1]
    v_pk_mul_f32 v[118:119], v[196:197], v[118:119] op_sel:[1,0] op_sel_hi:[1,1]
    v_pk_fma_f32 v[160:161], v[192:193], v[232:233], v[160:161] op_sel_hi:[0,1,1] neg_lo:[1,0,0] neg_hi:[1,0,0]
    v_pk_fma_f32 v[162:163], v[192:193], v[234:235], v[162:163] op_sel_hi:[0,1,1] neg_lo:[1,0,0] neg_hi:[1,0,0]
    v_pk_mul_f32 v[160:161], v[112:113], v[160:161]
    v_pk_mul_f32 v[162:163], v[114:115], v[162:163]
    v_pk_fma_f32 v[164:165], v[196:197], v[232:233], v[164:165] op_sel_hi:[0,1,1] neg_lo:[1,0,0] neg_hi:[1,0,0]
    v_pk_fma_f32 v[166:167], v[196:197], v[234:235], v[166:167] op_sel_hi:[0,1,1] neg_lo:[1,0,0] neg_hi:[1,0,0]
    v_pk_mul_f32 v[164:165], v[116:117], v[164:165]
    v_pk_mul_f32 v[166:167], v[118:119], v[166:167]
    v_cvt_pk_bf16_f32 v112, v160, v161
    v_cvt_pk_bf16_f32 v113, v162, v163
    v_cvt_pk_bf16_f32 v114, v164, v165
    v_cvt_pk_bf16_f32 v115, v166, v167
    s_nop 0
    v_permlane16_swap_b32 v112, v114
    v_permlane16_swap_b32 v113, v115
    v_and_b32 v112, v245, v112
    buffer_store_dwordx4 v[112:115], v14, s[24:27], s48 offen offset:1024 sc1
    v_pk_fma_f32 v[120:121], v[200:201], v[220:221], v[120:121] op_sel_hi:[0,1,1] neg_lo:[1,0,0] neg_hi:[1,0,0]
    v_pk_fma_f32 v[122:123], v[200:201], v[222:223], v[122:123] op_sel_hi:[0,1,1] neg_lo:[1,0,0] neg_hi:[1,0,0]
    v_max_f32 v120, 0, v120
    v_max_f32 v121, 0, v121
    v_max_f32 v122, 0, v122
    v_max_f32 v123, 0, v123
    v_pk_mul_f32 v[120:121], v[200:201], v[120:121] op_sel:[1,0] op_sel_hi:[1,1]
    v_pk_mul_f32 v[122:123], v[200:201], v[122:123] op_sel:[1,0] op_sel_hi:[1,1]
    v_pk_fma_f32 v[124:125], v[204:205], v[220:221], v[124:125] op_sel_hi:[0,1,1] neg_lo:[1,0,0] neg_hi:[1,0,0]
    v_pk_fma_f32 v[126:127], v[204:205], v[222:223], v[126:127] op_sel_hi:[0,1,1] neg_lo:[1,0,0] neg_hi:[1,0,0]
    v_max_f32 v124, 0, v124
    v_max_f32 v125, 0, v125
    v_max_f32 v126, 0, v126
    v_max_f32 v127, 0, v127
    v_pk_mul_f32 v[124:125], v[204:205], v[124:125] op_sel:[1,0] op_sel_hi:[1,1]
    v_pk_mul_f32 v[126:127], v[204:205], v[126:127] op_sel:[1,0] op_sel_hi:[1,1]
    v_pk_fma_f32 v[168:169], v[200:201], v[232:233], v[168:169] op_sel_hi:[0,1,1] neg_lo:[1,0,0] neg_hi:[1,0,0]
    v_pk_fma_f32 v[170:171], v[200:201], v[234:235], v[170:171] op_sel_hi:[0,1,1] neg_lo:[1,0,0] neg_hi:[1,0,0]
    v_pk_mul_f32 v[168:169], v[120:121], v[168:169]
    v_pk_mul_f32 v[170:171], v[122:123], v[170:171]
    v_pk_fma_f32 v[172:173], v[204:205], v[232:233], v[172:173] op_sel_hi:[0,1,1] neg_lo:[1,0,0] neg_hi:[1,0,0]
    v_pk_fma_f32 v[174:175], v[204:205], v[234:235], v[174:175] op_sel_hi:[0,1,1] neg_lo:[1,0,0] neg_hi:[1,0,0]
    v_pk_mul_f32 v[172:173], v[124:125], v[172:173]
    v_pk_mul_f32 v[174:175], v[126:127], v[174:175]
    v_cvt_pk_bf16_f32 v120, v168, v169
    v_cvt_pk_bf16_f32 v121, v170, v171
    v_cvt_pk_bf16_f32 v122, v172, v173
    v_cvt_pk_bf16_f32 v123, v174, v175
    s_nop 0
    v_permlane16_swap_b32 v120, v122
    v_permlane16_swap_b32 v121, v123
    v_and_b32 v120, v245, v120
    buffer_store_dwordx4 v[120:123], v14, s[24:27], s49 offen offset:1024 sc1
    v_mfma_f32_16x16x32_bf16 v[128:131], v[80:83], v[32:35], v[128:131]
    v_mfma_f32_16x16x32_bf16 v[132:135], v[80:83], v[36:39], v[132:135]
    v_mfma_f32_16x16x32_bf16 v[136:139], v[80:83], v[40:43], v[136:139]
    v_mfma_f32_16x16x32_bf16 v[140:143], v[80:83], v[44:47], v[140:143]
    v_mfma_f32_16x16x32_bf16 v[176:179], v[68:71], v[16:19], v[176:179]
    v_mfma_f32_16x16x32_bf16 v[180:183], v[68:71], v[20:23], v[180:183]
    v_mfma_f32_16x16x32_bf16 v[184:187], v[68:71], v[24:27], v[184:187]
    v_mfma_f32_16x16x32_bf16 v[188:191], v[68:71], v[28:31], v[188:191]
    v_mfma_f32_16x16x32_bf16 v[176:179], v[92:95], v[32:35], v[176:179]
    v_mfma_f32_16x16x32_bf16 v[180:183], v[92:95], v[36:39], v[180:183]
    v_mfma_f32_16x16x32_bf16 v[184:187], v[92:95], v[40:43], v[184:187]
    v_mfma_f32_16x16x32_bf16 v[188:191], v[92:95], v[44:47], v[188:191]
    v_pk_fma_f32 v[128:129], v[192:193], v[224:225], v[128:129] op_sel_hi:[0,1,1] neg_lo:[1,0,0] neg_hi:[1,0,0]
    v_pk_fma_f32 v[130:131], v[192:193], v[226:227], v[130:131] op_sel_hi:[0,1,1] neg_lo:[1,0,0] neg_hi:[1,0,0]
    v_max_f32 v128, 0, v128
    v_max_f32 v129, 0, v129
    v_max_f32 v130, 0, v130
    v_max_f32 v131, 0, v131
    v_pk_mul_f32 v[128:129], v[192:193], v[128:129] op_sel:[1,0] op_sel_hi:[1,1]
    v_pk_mul_f32 v[130:131], v[192:193], v[130:131] op_sel:[1,0] op_sel_hi:[1,1]
    v_pk_fma_f32 v[132:133], v[196:197], v[224:225], v[132:133] op_sel_hi:[0,1,1] neg_lo:[1,0,0] neg_hi:[1,0,0]
    v_pk_fma_f32 v[134:135], v[196:197], v[226:227], v[134:135] op_sel_hi:[0,1,1] neg_lo:[1,0,0] neg_hi:[1,0,0]
    v_max_f32 v132, 0, v132
    v_max_f32 v133, 0, v133
    v_max_f32 v134, 0, v134
    v_max_f32 v135, 0, v135
    v_pk_mul_f32 v[132:133], v[196:197], v[132:133] op_sel:[1,0] op_sel_hi:[1,1]
    v_pk_mul_f32 v[134:135], v[196:197], v[134:135] op_sel:[1,0] op_sel_hi:[1,1]
    v_pk_fma_f32 v[176:177], v[192:193], v[236:237], v[176:177] op_sel_hi:[0,1,1] neg_lo:[1,0,0] neg_hi:[1,0,0]
    v_pk_fma_f32 v[178:179], v[192:193], v[238:239], v[178:179] op_sel_hi:[0,1,1] neg_lo:[1,0,0] neg_hi:[1,0,0]
    v_pk_mul_f32 v[176:177], v[128:129], v[176:177]
    v_pk_mul_f32 v[178:179], v[130:131], v[178:179]
    v_pk_fma_f32 v[180:181], v[196:197], v[236:237], v[180:181] op_sel_hi:[0,1,1] neg_lo:[1,0,0] neg_hi:[1,0,0]
    v_pk_fma_f32 v[182:183], v[196:197], v[238:239], v[182:183] op_sel_hi:[0,1,1] neg_lo:[1,0,0] neg_hi:[1,0,0]
    v_pk_mul_f32 v[180:181], v[132:133], v[180:181]
    v_pk_mul_f32 v[182:183], v[134:135], v[182:183]
    v_cvt_pk_bf16_f32 v128, v176, v177
    v_cvt_pk_bf16_f32 v129, v178, v179
    v_cvt_pk_bf16_f32 v130, v180, v181
    v_cvt_pk_bf16_f32 v131, v182, v183
    s_nop 0
    v_permlane16_swap_b32 v128, v130
    v_permlane16_swap_b32 v129, v131
    v_and_b32 v128, v245, v128
    buffer_store_dwordx4 v[128:131], v14, s[24:27], s48 offen offset:2048 sc1
    v_pk_fma_f32 v[136:137], v[200:201], v[224:225], v[136:137] op_sel_hi:[0,1,1] neg_lo:[1,0,0] neg_hi:[1,0,0]
    v_pk_fma_f32 v[138:139], v[200:201], v[226:227], v[138:139] op_sel_hi:[0,1,1] neg_lo:[1,0,0] neg_hi:[1,0,0]
    v_max_f32 v136, 0, v136
    v_max_f32 v137, 0, v137
    v_max_f32 v138, 0, v138
    v_max_f32 v139, 0, v139
    v_pk_mul_f32 v[136:137], v[200:201], v[136:137] op_sel:[1,0] op_sel_hi:[1,1]
    v_pk_mul_f32 v[138:139], v[200:201], v[138:139] op_sel:[1,0] op_sel_hi:[1,1]
    v_pk_fma_f32 v[140:141], v[204:205], v[224:225], v[140:141] op_sel_hi:[0,1,1] neg_lo:[1,0,0] neg_hi:[1,0,0]
    v_pk_fma_f32 v[142:143], v[204:205], v[226:227], v[142:143] op_sel_hi:[0,1,1] neg_lo:[1,0,0] neg_hi:[1,0,0]
    v_max_f32 v140, 0, v140
    v_max_f32 v141, 0, v141
    v_max_f32 v142, 0, v142
    v_max_f32 v143, 0, v143
    v_pk_mul_f32 v[140:141], v[204:205], v[140:141] op_sel:[1,0] op_sel_hi:[1,1]
    v_pk_mul_f32 v[142:143], v[204:205], v[142:143] op_sel:[1,0] op_sel_hi:[1,1]
    v_pk_fma_f32 v[184:185], v[200:201], v[236:237], v[184:185] op_sel_hi:[0,1,1] neg_lo:[1,0,0] neg_hi:[1,0,0]
    v_pk_fma_f32 v[186:187], v[200:201], v[238:239], v[186:187] op_sel_hi:[0,1,1] neg_lo:[1,0,0] neg_hi:[1,0,0]
    v_pk_mul_f32 v[184:185], v[136:137], v[184:185]
    v_pk_mul_f32 v[186:187], v[138:139], v[186:187]
    v_pk_fma_f32 v[188:189], v[204:205], v[236:237], v[188:189] op_sel_hi:[0,1,1] neg_lo:[1,0,0] neg_hi:[1,0,0]
    v_pk_fma_f32 v[190:191], v[204:205], v[238:239], v[190:191] op_sel_hi:[0,1,1] neg_lo:[1,0,0] neg_hi:[1,0,0]
    v_pk_mul_f32 v[188:189], v[140:141], v[188:189]
    v_pk_mul_f32 v[190:191], v[142:143], v[190:191]
    v_cvt_pk_bf16_f32 v136, v184, v185
    v_cvt_pk_bf16_f32 v137, v186, v187
    v_cvt_pk_bf16_f32 v138, v188, v189
    v_cvt_pk_bf16_f32 v139, v190, v191
    s_nop 0
    v_permlane16_swap_b32 v136, v138
    v_permlane16_swap_b32 v137, v139
    v_and_b32 v136, v245, v136
    buffer_store_dwordx4 v[136:139], v14, s[24:27], s49 offen offset:2048 sc1
    buffer_load_dwordx4 v[32:35], v2, s[24:27], s58 offen offset:0 sc1
    buffer_load_dwordx4 v[36:39], v2, s[24:27], s96 offen offset:0 sc1
    buffer_load_dwordx4 v[40:43], v2, s[24:27], s58 offen offset:3072 sc1
    buffer_load_dwordx4 v[44:47], v2, s[24:27], s96 offen offset:3072 sc1
    buffer_load_dwordx4 v[48:51], v2, s[24:27], s59 offen offset:2048 sc1
    buffer_load_dwordx4 v[52:55], v2, s[24:27], s97 offen offset:2048 sc1
    buffer_load_dwordx4 v[56:59], v2, s[24:27], s60 offen offset:1024 sc1
    buffer_load_dwordx4 v[60:63], v2, s[24:27], s98 offen offset:1024 sc1
L4_done:
    s_mov_b32 s16, s34
    s_mov_b32 s17, s35
    s_mov_b32 s18, 2621440
    s_mov_b32 s19, 0x00020000
    s_lshl_b32 s3, s42, 6
    v_add_u32 v22, s3, v0
    v_mul_u32_u24 v23, 6554, v22
    v_lshrrev_b32 v23, 16, v23
    v_mul_u32_u24 v24, 10, v23
    v_sub_u32 v24, v22, v24
    v_mul_u32_u24 v25, 336, v23
    v_lshl_add_u32 v25, v24, 5, v25
    v_mul_u32_u24 v26, 1280, v23
    v_lshl_add_u32 v26, v24, 4, v26
    s_mul_i32 s51, s56, 81920
    s_mul_i32 s3, s57, 160
    s_add_u32 s51, s51, s3
    s_cmp_eq_u32 s44, 0
    s_cbranch_scc1 L5_compute
    v_add_u32 v22, 256, v22
    v_mul_u32_u24 v23, 6554, v22
    v_lshrrev_b32 v23, 16, v23
    v_mul_u32_u24 v24, 10, v23
    v_sub_u32 v24, v22, v24
    v_mul_u32_u24 v27, 336, v23
    v_lshl_add_u32 v27, v24, 5, v27
    v_mul_u32_u24 v28, 1280, v23
    v_lshl_add_u32 v28, v24, 4, v28
    s_add_u32 s3, s50, 81920
    v_add_u32 v7, s3, v2
    s_waitcnt vmcnt(0)
    s_barrier
    s_add_u32 m0, s50, 0
    s_mov_b32 s3, 40960
    buffer_load_dwordx4 v6, s[24:27], s3 offen sc1 lds
    s_waitcnt vmcnt(0)
    s_barrier
    s_add_u32 m0, s50, 81920
    s_mov_b32 s3, 81920
    buffer_load_dwordx4 v6, s[24:27], s3 offen sc1 lds
    s_add_u32 m0, s50, 82944
    s_mov_b32 s3, 82944
    buffer_load_dwordx4 v6, s[24:27], s3 offen sc1 lds
    s_add_u32 m0, s50, 83968
    s_mov_b32 s3, 83968
    buffer_load_dwordx4 v6, s[24:27], s3 offen sc1 lds
    s_add_u32 m0, s50, 84992
    s_mov_b32 s3, 84992
    buffer_load_dwordx4 v6, s[24:27], s3 offen sc1 lds
    s_add_u32 m0, s50, 86016
    s_mov_b32 s3, 86016
    buffer_load_dwordx4 v6, s[24:27], s3 offen sc1 lds
    s_add_u32 m0, s50, 87040
    s_mov_b32 s3, 87040
    buffer_load_dwordx4 v6, s[24:27], s3 offen sc1 lds
    s_add_u32 m0, s50, 88064
    s_mov_b32 s3, 88064
    buffer_load_dwordx4 v6, s[24:27], s3 offen sc1 lds
    s_add_u32 m0, s50, 89088
    s_mov_b32 s3, 89088
    buffer_load_dwordx4 v6, s[24:27], s3 offen sc1 lds
    s_add_u32 m0, s50, 90112
    s_mov_b32 s3, 90112
    buffer_load_dwordx4 v6, s[24:27], s3 offen sc1 lds
    s_add_u32 m0, s50, 91136
    s_mov_b32 s3, 91136
    buffer_load_dwordx4 v6, s[24:27], s3 offen sc1 lds
    s_barrier
    s_add_u32 m0, s50, 122880
    s_mov_b32 s3, 102400
    buffer_load_dwordx4 v6, s[24:27], s3 offen sc1 lds
    s_add_u32 m0, s50, 123904
    s_mov_b32 s3, 103424
    buffer_load_dwordx4 v6, s[24:27], s3 offen sc1 lds
    s_add_u32 m0, s50, 124928
    s_mov_b32 s3, 104448
    buffer_load_dwordx4 v6, s[24:27], s3 offen sc1 lds
    s_add_u32 m0, s50, 125952
    s_mov_b32 s3, 105472
    buffer_load_dwordx4 v6, s[24:27], s3 offen sc1 lds
    s_add_u32 m0, s50, 126976
    s_mov_b32 s3, 106496
    buffer_load_dwordx4 v6, s[24:27], s3 offen sc1 lds
    s_add_u32 m0, s50, 128000
    s_mov_b32 s3, 107520
    buffer_load_dwordx4 v6, s[24:27], s3 offen sc1 lds
    s_add_u32 m0, s50, 129024
    s_mov_b32 s3, 108544
    buffer_load_dwordx4 v6, s[24:27], s3 offen sc1 lds
    s_add_u32 m0, s50, 130048
    s_mov_b32 s3, 109568
    buffer_load_dwordx4 v6, s[24:27], s3 offen sc1 lds
    s_add_u32 m0, s50, 131072
    s_mov_b32 s3, 110592
    buffer_load_dwordx4 v6, s[24:27], s3 offen sc1 lds
    s_add_u32 m0, s50, 132096
    s_mov_b32 s3, 111616
    buffer_load_dwordx4 v6, s[24:27], s3 offen sc1 lds
    s_waitcnt vmcnt(10) lgkmcnt(0)
    s_barrier
    s_waitcnt vmcnt(0)
    s_barrier
    s_branch L5_red
L5_compute:
    s_and_b32 s48, s42, 1
    s_mul_i32 s3, s48, 20480
    v_add_u32 v4, s3, v2
    v_add_u32 v5, 81920, v4
    v_and_b32 v20, 15, v0
    v_lshrrev_b32 v21, 4, v0
    s_lshl_b32 s3, s48, 2
    s_add_u32 s3, s3, s43
    s_lshl_b32 s3, s3, 4
    v_add_u32 v20, s3, v20
    v_xor_b32 v19, 16, v20
    v_mul_u32_u24 v20, 336, v20
    v_lshl_add_u32 v20, v21, 4, v20
    v_mul_u32_u24 v19, 336, v19
    v_lshl_add_u32 v19, v21, 4, v19
    v_lshlrev_b32 v112, 16, v246
    v_and_b32 v113, 0xffff0000, v246
    v_lshlrev_b32 v114, 16, v247
    v_and_b32 v115, 0xffff0000, v247
    v_lshlrev_b32 v116, 16, v248
    v_and_b32 v117, 0xffff0000, v248
    v_lshlrev_b32 v118, 16, v249
    v_and_b32 v119, 0xffff0000, v249
    v_lshlrev_b32 v120, 16, v250
    v_and_b32 v121, 0xffff0000, v250
    v_lshlrev_b32 v122, 16, v251
    v_and_b32 v123, 0xffff0000, v251
    v_lshlrev_b32 v124, 16, v252
    v_and_b32 v125, 0xffff0000, v252
    v_lshlrev_b32 v126, 16, v253
    v_and_b32 v127, 0xffff0000, v253
    v_lshlrev_b32 v128, 16, v254
    v_and_b32 v129, 0xffff0000, v254
    v_lshlrev_b32 v130, 16, v255
    v_and_b32 v131, 0xffff0000, v255
    s_barrier
    ds_read_b128 v[72:75], v5 offset:0
    ds_read_b128 v[76:79], v5 offset:1024
    ds_read_b128 v[80:83], v5 offset:2048
    ds_read_b128 v[84:87], v5 offset:3072
    ds_read_b128 v[88:91], v5 offset:4096
    s_mov_b32 s14, 400000
    s_waitcnt vmcnt(6)
    v_or_b32 v30, v32, v36
    v_and_b32 v30, v244, v30
    v_cmp_ne_u32 vcc, 0, v30
    s_cbranch_vccnz L5_retry0
L5_ok0:
    s_waitcnt lgkmcnt(0)
    v_mfma_f32_16x16x32_bf16 v[112:115], v[72:75], v[32:35], v[112:115]
    ds_read_b128 v[92:95], v5 offset:5120
    buffer_load_dwordx4 v[64:67], v2, s[24:27], s61 offen offset:0 sc1
    v_mfma_f32_16x16x32_bf16 v[116:119], v[76:79], v[32:35], v[116:119]
    ds_read_b128 v[96:99], v5 offset:6144
    buffer_load_dwordx4 v[68:71], v2, s[24:27], s99 offen offset:0 sc1
    v_mfma_f32_16x16x32_bf16 v[120:123], v[80:83], v[32:35], v[120:123]
    ds_read_b128 v[100:103], v5 offset:7168
    v_mfma_f32_16x16x32_bf16 v[124:127], v[84:87], v[32:35], v[124:127]
    ds_read_b128 v[104:107], v5 offset:8192
    v_mfma_f32_16x16x32_bf16 v[128:131], v[88:91], v[32:35], v[128:131]
    ds_read_b128 v[108:111], v5 offset:9216
    v_mfma_f32_16x16x32_bf16 v[132:135], v[72:75], v[36:39], 0
    v_mfma_f32_16x16x32_bf16 v[136:139], v[76:79], v[36:39], 0
    v_mfma_f32_16x16x32_bf16 v[140:143], v[80:83], v[36:39], 0
    s_waitcnt vmcnt(6)
    v_or_b32 v30, v40, v44
    v_mfma_f32_16x16x32_bf16 v[144:147], v[84:87], v[36:39], 0
    v_and_b32 v30, v244, v30
    v_cmp_ne_u32 vcc, 0, v30
    v_mfma_f32_16x16x32_bf16 v[148:151], v[88:91], v[36:39], 0
    s_cbranch_vccnz L5_retry1
L5_ok1:
    s_waitcnt lgkmcnt(0)
    v_mfma_f32_16x16x32_bf16 v[112:115], v[92:95], v[40:43], v[112:115]
    ds_read_b128 v[72:75], v5 offset:10240
    buffer_load_dwordx4 v[32:35], v2, s[24:27], s61 offen offset:3072 sc1
    v_mfma_f32_16x16x32_bf16 v[116:119], v[96:99], v[40:43], v[116:119]
    ds_read_b128 v[76:79], v5 offset:11264
    buffer_load_dwordx4 v[36:39], v2, s[24:27], s99 offen offset:3072 sc1
    v_mfma_f32_16x16x32_bf16 v[120:123], v[100:103], v[40:43], v[120:123]
    ds_read_b128 v[80:83], v5 offset:12288
    v_mfma_f32_16x16x32_bf16 v[124:127], v[104:107], v[40:43], v[124:127]
    ds_read_b128 v[84:87], v5 offset:13312
    v_mfma_f32_16x16x32_bf16 v[128:131], v[108:111], v[40:43], v[128:131]
    ds_read_b128 v[88:91], v5 offset:14336
    v_mfma_f32_16x16x32_bf16 v[132:135], v[92:95], v[44:47], v[132:135]
    v_mfma_f32_16x16x32_bf16 v[136:139], v[96:99], v[44:47], v[136:139]
    v_mfma_f32_16x16x32_bf16 v[140:143], v[100:103], v[44:47], v[140:143]
    s_waitcnt vmcnt(6)
    v_or_b32 v30, v48, v52
    v_mfma_f32_16x16x32_bf16 v[144:147], v[104:107], v[44:47], v[144:147]
    v_and_b32 v30, v244, v30
    v_cmp_ne_u32 vcc, 0, v30
    v_mfma_f32_16x16x32_bf16 v[148:151], v[108:111], v[44:47], v[148:151]
    s_cbranch_vccnz L5_retry2
L5_ok2:
    s_waitcnt lgkmcnt(0)
    v_mfma_f32_16x16x32_bf16 v[112:115], v[72:75], v[48:51], v[112:115]
    ds_read_b128 v[92:95], v5 offset:15360
    buffer_load_dwordx4 v[40:43], v2, s[24:27], s62 offen offset:2048 sc1
    v_mfma_f32_16x16x32_bf16 v[116:119], v[76:79], v[48:51], v[116:119]
    ds_read_b128 v[96:99], v5 offset:16384
    buffer_load_dwordx4 v[44:47], v2, s[24:27], s100 offen offset:2048 sc1
    v_mfma_f32_16x16x32_bf16 v[120:123], v[80:83], v[48:51], v[120:123]
    ds_read_b128 v[100:103], v5 offset:17408
    v_mfma_f32_16x16x32_bf16 v[124:127], v[84:87], v[48:51], v[124:127]
    ds_read_b128 v[104:107], v5 offset:18432
    v_mfma_f32_16x16x32_bf16 v[128:131], v[88:91], v[48:51], v[128:131]
    ds_read_b128 v[108:111], v5 offset:19456
    v_mfma_f32_16x16x32_bf16 v[132:135], v[72:75], v[52:55], v[132:135]
    v_mfma_f32_16x16x32_bf16 v[136:139], v[76:79], v[52:55], v[136:139]
    v_mfma_f32_16x16x32_bf16 v[140:143], v[80:83], v[52:55], v[140:143]
    s_waitcnt vmcnt(6)
    v_or_b32 v30, v56, v60
    v_mfma_f32_16x16x32_bf16 v[144:147], v[84:87], v[52:55], v[144:147]
    v_and_b32 v30, v244, v30
    v_cmp_ne_u32 vcc, 0, v30
    v_mfma_f32_16x16x32_bf16 v[148:151], v[88:91], v[52:55], v[148:151]
    s_cbranch_vccnz L5_retry3
L5_ok3:
    s_waitcnt lgkmcnt(0)
    s_barrier
    v_mfma_f32_16x16x32_bf16 v[112:115], v[92:95], v[56:59], v[112:115]
    ds_read_b128 v[72:75], v5 offset:40960
    buffer_load_dwordx4 v[48:51], v2, s[24:27], s63 offen offset:1024 sc1
    v_mfma_f32_16x16x32_bf16 v[116:119], v[96:99], v[56:59], v[116:119]
    ds_read_b128 v[76:79], v5 offset:41984
    buffer_load_dwordx4 v[52:55], v2, s[24:27], s101 offen offset:1024 sc1
    v_mfma_f32_16x16x32_bf16 v[120:123], v[100:103], v[56:59], v[120:123]
    ds_read_b128 v[80:83], v5 offset:43008
    v_mfma_f32_16x16x32_bf16 v[124:127], v[104:107], v[56:59], v[124:127]
    ds_read_b128 v[84:87], v5 offset:44032
    v_mfma_f32_16x16x32_bf16 v[128:131], v[108:111], v[56:59], v[128:131]
    ds_read_b128 v[88:91], v5 offset:45056
    v_mfma_f32_16x16x32_bf16 v[132:135], v[92:95], v[60:63], v[132:135]
    v_mfma_f32_16x16x32_bf16 v[136:139], v[96:99], v[60:63], v[136:139]
    v_mfma_f32_16x16x32_bf16 v[140:143], v[100:103], v[60:63], v[140:143]
    s_waitcnt vmcnt(6)
    v_or_b32 v30, v64, v68
    v_mfma_f32_16x16x32_bf16 v[144:147], v[104:107], v[60:63], v[144:147]
    v_and_b32 v30, v244, v30
    v_cmp_ne_u32 vcc, 0, v30
    v_mfma_f32_16x16x32_bf16 v[148:151], v[108:111], v[60:63], v[148:151]
    s_cbranch_vccnz L5_retry4
L5_ok4:
    s_waitcnt lgkmcnt(0)
    v_mfma_f32_16x16x32_bf16 v[112:115], v[72:75], v[64:67], v[112:115]
    ds_read_b128 v[92:95], v5 offset:46080
    buffer_load_dwordx4 v[56:59], v2, s[24:27], s58 offen offset:1024 sc1
    v_mfma_f32_16x16x32_bf16 v[116:119], v[76:79], v[64:67], v[116:119]
    ds_read_b128 v[96:99], v5 offset:47104
    buffer_load_dwordx4 v[60:63], v2, s[24:27], s96 offen offset:1024 sc1
    v_mfma_f32_16x16x32_bf16 v[120:123], v[80:83], v[64:67], v[120:123]
    ds_read_b128 v[100:103], v5 offset:48128
    v_mfma_f32_16x16x32_bf16 v[124:127], v[84:87], v[64:67], v[124:127]
    ds_read_b128 v[104:107], v5 offset:49152
    v_mfma_f32_16x16x32_bf16 v[128:131], v[88:91], v[64:67], v[128:131]
    ds_read_b128 v[108:111], v5 offset:50176
    v_mfma_f32_16x16x32_bf16 v[132:135], v[72:75], v[68:71], v[132:135]
    v_mfma_f32_16x16x32_bf16 v[136:139], v[76:79], v[68:71], v[136:139]
    v_mfma_f32_16x16x32_bf16 v[140:143], v[80:83], v[68:71], v[140:143]
    s_waitcnt vmcnt(6)
    v_or_b32 v30, v32, v36
    v_mfma_f32_16x16x32_bf16 v[144:147], v[84:87], v[68:71], v[144:147]
    v_and_b32 v30, v244, v30
    v_cmp_ne_u32 vcc, 0, v30
    v_mfma_f32_16x16x32_bf16 v[148:151], v[88:91], v[68:71], v[148:151]
    s_cbranch_vccnz L5_retry5
L5_ok5:
    s_waitcnt lgkmcnt(0)
    v_mfma_f32_16x16x32_bf16 v[112:115], v[92:95], v[32:35], v[112:115]
    ds_read_b128 v[72:75], v5 offset:51200
    buffer_load_dwordx4 v[64:67], v2, s[24:27], s59 offen offset:0 sc1
    v_mfma_f32_16x16x32_bf16 v[116:119], v[96:99], v[32:35], v[116:119]
    ds_read_b128 v[76:79], v5 offset:52224
    buffer_load_dwordx4 v[68:71], v2, s[24:27], s97 offen offset:0 sc1
    v_mfma_f32_16x16x32_bf16 v[120:123], v[100:103], v[32:35], v[120:123]
    ds_read_b128 v[80:83], v5 offset:53248
    v_mfma_f32_16x16x32_bf16 v[124:127], v[104:107], v[32:35], v[124:127]
    ds_read_b128 v[84:87], v5 offset:54272
    v_mfma_f32_16x16x32_bf16 v[128:131], v[108:111], v[32:35], v[128:131]
    ds_read_b128 v[88:91], v5 offset:55296
    v_mfma_f32_16x16x32_bf16 v[132:135], v[92:95], v[36:39], v[132:135]
    v_mfma_f32_16x16x32_bf16 v[136:139], v[96:99], v[36:39], v[136:139]
    v_mfma_f32_16x16x32_bf16 v[140:143], v[100:103], v[36:39], v[140:143]
    s_waitcnt vmcnt(6)
    v_or_b32 v30, v40, v44
    v_mfma_f32_16x16x32_bf16 v[144:147], v[104:107], v[36:39], v[144:147]
    v_and_b32 v30, v244, v30
    v_cmp_ne_u32 vcc, 0, v30
    v_mfma_f32_16x16x32_bf16 v[148:151], v[108:111], v[36:39], v[148:151]
    s_cbranch_vccnz L5_retry6
L5_ok6:
    s_waitcnt lgkmcnt(0)
    v_mfma_f32_16x16x32_bf16 v[112:115], v[72:75], v[40:43], v[112:115]
    ds_read_b128 v[92:95], v5 offset:56320
    buffer_load_dwordx4 v[32:35], v2, s[24:27], s59 offen offset:3072 sc1
    v_mfma_f32_16x16x32_bf16 v[116:119], v[76:79], v[40:43], v[116:119]
    ds_read_b128 v[96:99], v5 offset:57344
    buffer_load_dwordx4 v[36:39], v2, s[24:27], s97 offen offset:3072 sc1
    v_mfma_f32_16x16x32_bf16 v[120:123], v[80:83], v[40:43], v[120:123]
    ds_read_b128 v[100:103], v5 offset:58368
    v_mfma_f32_16x16x32_bf16 v[124:127], v[84:87], v[40:43], v[124:127]
    ds_read_b128 v[104:107], v5 offset:59392
    v_mfma_f32_16x16x32_bf16 v[128:131], v[88:91], v[40:43], v[128:131]
    ds_read_b128 v[108:111], v5 offset:60416
    v_mfma_f32_16x16x32_bf16 v[132:135], v[72:75], v[44:47], v[132:135]
    v_mfma_f32_16x16x32_bf16 v[136:139], v[76:79], v[44:47], v[136:139]
    v_mfma_f32_16x16x32_bf16 v[140:143], v[80:83], v[44:47], v[140:143]
    s_waitcnt vmcnt(6)
    v_or_b32 v30, v48, v52
    v_mfma_f32_16x16x32_bf16 v[144:147], v[84:87], v[44:47], v[144:147]
    v_and_b32 v30, v244, v30
    v_cmp_ne_u32 vcc, 0, v30
    v_mfma_f32_16x16x32_bf16 v[148:151], v[88:91], v[44:47], v[148:151]
    s_cbranch_vccnz L5_retry7
L5_ok7:
    s_waitcnt lgkmcnt(0)
    s_barrier
    v_mfma_f32_16x16x32_bf16 v[112:115], v[92:95], v[48:51], v[112:115]
    ds_read_b128 v[72:75], v4 offset:0
    buffer_load_dwordx4 v[40:43], v2, s[24:27], s60 offen offset:2048 sc1
    v_mfma_f32_16x16x32_bf16 v[116:119], v[96:99], v[48:51], v[116:119]
    ds_read_b128 v[76:79], v4 offset:1024
    buffer_load_dwordx4 v[44:47], v2, s[24:27], s98 offen offset:2048 sc1
    v_mfma_f32_16x16x32_bf16 v[120:123], v[100:103], v[48:51], v[120:123]
    ds_read_b128 v[80:83], v4 offset:2048
    v_mfma_f32_16x16x32_bf16 v[124:127], v[104:107], v[48:51], v[124:127]
    ds_read_b128 v[84:87], v4 offset:3072
    v_mfma_f32_16x16x32_bf16 v[128:131], v[108:111], v[48:51], v[128:131]
    ds_read_b128 v[88:91], v4 offset:4096
    v_mfma_f32_16x16x32_bf16 v[132:135], v[92:95], v[52:55], v[132:135]
    v_mfma_f32_16x16x32_bf16 v[136:139], v[96:99], v[52:55], v[136:139]
    v_mfma_f32_16x16x32_bf16 v[140:143], v[100:103], v[52:55], v[140:143]
    s_waitcnt vmcnt(6)
    v_or_b32 v30, v56, v60
    v_mfma_f32_16x16x32_bf16 v[144:147], v[104:107], v[52:55], v[144:147]
    v_and_b32 v30, v244, v30
    v_cmp_ne_u32 vcc, 0, v30
    v_mfma_f32_16x16x32_bf16 v[148:151], v[108:111], v[52:55], v[148:151]
    s_cbranch_vccnz L5_retry8
L5_ok8:
    s_waitcnt lgkmcnt(0)
    v_mfma_f32_16x16x32_bf16 v[112:115], v[72:75], v[56:59], v[112:115]
    ds_read_b128 v[92:95], v4 offset:5120
    buffer_load_dwordx4 v[48:51], v2, s[24:27], s61 offen offset:1024 sc1
    v_mfma_f32_16x16x32_bf16 v[116:119], v[76:79], v[56:59], v[116:119]
    ds_read_b128 v[96:99], v4 offset:6144
    buffer_load_dwordx4 v[52:55], v2, s[24:27], s99 offen offset:1024 sc1
    v_mfma_f32_16x16x32_bf16 v[120:123], v[80:83], v[56:59], v[120:123]
    ds_read_b128 v[100:103], v4 offset:7168
    v_mfma_f32_16x16x32_bf16 v[124:127], v[84:87], v[56:59], v[124:127]
    ds_read_b128 v[104:107], v4 offset:8192
    v_mfma_f32_16x16x32_bf16 v[128:131], v[88:91], v[56:59], v[128:131]
    ds_read_b128 v[108:111], v4 offset:9216
    v_mfma_f32_16x16x32_bf16 v[132:135], v[72:75], v[60:63], v[132:135]
    v_mfma_f32_16x16x32_bf16 v[136:139], v[76:79], v[60:63], v[136:139]
    v_mfma_f32_16x16x32_bf16 v[140:143], v[80:83], v[60:63], v[140:143]
    s_waitcnt vmcnt(6)
    v_or_b32 v30, v64, v68
    v_mfma_f32_16x16x32_bf16 v[144:147], v[84:87], v[60:63], v[144:147]
    v_and_b32 v30, v244, v30
    v_cmp_ne_u32 vcc, 0, v30
    v_mfma_f32_16x16x32_bf16 v[148:151], v[88:91], v[60:63], v[148:151]
    s_cbranch_vccnz L5_retry9
L5_ok9:
    s_waitcnt lgkmcnt(0)
    v_mfma_f32_16x16x32_bf16 v[112:115], v[92:95], v[64:67], v[112:115]
    ds_read_b128 v[72:75], v4 offset:10240
    buffer_load_dwordx4 v[56:59], v2, s[24:27], s62 offen offset:0 sc1
    v_mfma_f32_16x16x32_bf16 v[116:119], v[96:99], v[64:67], v[116:119]
    ds_read_b128 v[76:79], v4 offset:11264
    buffer_load_dwordx4 v[60:63], v2, s[24:27], s100 offen offset:0 sc1
    v_mfma_f32_16x16x32_bf16 v[120:123], v[100:103], v[64:67], v[120:123]
    ds_read_b128 v[80:83], v4 offset:12288
    v_mfma_f32_16x16x32_bf16 v[124:127], v[104:107], v[64:67], v[124:127]
    ds_read_b128 v[84:87], v4 offset:13312
    v_mfma_f32_16x16x32_bf16 v[128:131], v[108:111], v[64:67], v[128:131]
    ds_read_b128 v[88:91], v4 offset:14336
    v_mfma_f32_16x16x32_bf16 v[132:135], v[92:95], v[68:71], v[132:135]
    v_mfma_f32_16x16x32_bf16 v[136:139], v[96:99], v[68:71], v[136:139]
    v_mfma_f32_16x16x32_bf16 v[140:143], v[100:103], v[68:71], v[140:143]
    s_waitcnt vmcnt(6)
    v_or_b32 v30, v32, v36
    v_mfma_f32_16x16x32_bf16 v[144:147], v[104:107], v[68:71], v[144:147]
    v_and_b32 v30, v244, v30
    v_cmp_ne_u32 vcc, 0, v30
    v_mfma_f32_16x16x32_bf16 v[148:151], v[108:111], v[68:71], v[148:151]
    s_cbranch_vccnz L5_retry10
L5_ok10:
    s_waitcnt lgkmcnt(0)
    v_mfma_f32_16x16x32_bf16 v[112:115], v[72:75], v[32:35], v[112:115]
    ds_read_b128 v[92:95], v4 offset:15360
    buffer_load_dwordx4 v[64:67], v2, s[24:27], s62 offen offset:3072 sc1
    v_mfma_f32_16x16x32_bf16 v[116:119], v[76:79], v[32:35], v[116:119]
    ds_read_b128 v[96:99], v4 offset:16384
    buffer_load_dwordx4 v[68:71], v2, s[24:27], s100 offen offset:3072 sc1
    v_mfma_f32_16x16x32_bf16 v[120:123], v[80:83], v[32:35], v[120:123]
    ds_read_b128 v[100:103], v4 offset:17408
    v_mfma_f32_16x16x32_bf16 v[124:127], v[84:87], v[32:35], v[124:127]
    ds_read_b128 v[104:107], v4 offset:18432
    v_mfma_f32_16x16x32_bf16 v[128:131], v[88:91], v[32:35], v[128:131]
    ds_read_b128 v[108:111], v4 offset:19456
    v_mfma_f32_16x16x32_bf16 v[132:135], v[72:75], v[36:39], v[132:135]
    v_mfma_f32_16x16x32_bf16 v[136:139], v[76:79], v[36:39], v[136:139]
    v_mfma_f32_16x16x32_bf16 v[140:143], v[80:83], v[36:39], v[140:143]
    s_waitcnt vmcnt(6)
    v_or_b32 v30, v40, v44
    v_mfma_f32_16x16x32_bf16 v[144:147], v[84:87], v[36:39], v[144:147]
    v_and_b32 v30, v244, v30
    v_cmp_ne_u32 vcc, 0, v30
    v_mfma_f32_16x16x32_bf16 v[148:151], v[88:91], v[36:39], v[148:151]
    s_cbranch_vccnz L5_retry11
L5_ok11:
    s_waitcnt lgkmcnt(0)
    v_mfma_f32_16x16x32_bf16 v[112:115], v[92:95], v[40:43], v[112:115]
    ds_read_b128 v[72:75], v4 offset:40960
    buffer_load_dwordx4 v[32:35], v2, s[24:27], s63 offen offset:2048 sc1
    v_mfma_f32_16x16x32_bf16 v[116:119], v[96:99], v[40:43], v[116:119]
    ds_read_b128 v[76:79], v4 offset:41984
    buffer_load_dwordx4 v[36:39], v2, s[24:27], s101 offen offset:2048 sc1
    v_mfma_f32_16x16x32_bf16 v[120:123], v[100:103], v[40:43], v[120:123]
    ds_read_b128 v[80:83], v4 offset:43008
    v_mfma_f32_16x16x32_bf16 v[124:127], v[104:107], v[40:43], v[124:127]
    ds_read_b128 v[84:87], v4 offset:44032
    v_mfma_f32_16x16x32_bf16 v[128:131], v[108:111], v[40:43], v[128:131]
    ds_read_b128 v[88:91], v4 offset:45056
    v_mfma_f32_16x16x32_bf16 v[132:135], v[92:95], v[44:47], v[132:135]
    v_mfma_f32_16x16x32_bf16 v[136:139], v[96:99], v[44:47], v[136:139]
    v_mfma_f32_16x16x32_bf16 v[140:143], v[100:103], v[44:47], v[140:143]
    s_waitcnt vmcnt(6)
    v_or_b32 v30, v48, v52
    v_mfma_f32_16x16x32_bf16 v[144:147], v[104:107], v[44:47], v[144:147]
    v_and_b32 v30, v244, v30
    v_cmp_ne_u32 vcc, 0, v30
    v_mfma_f32_16x16x32_bf16 v[148:151], v[108:111], v[44:47], v[148:151]
    s_cbranch_vccnz L5_retry12
L5_ok12:
    s_waitcnt lgkmcnt(0)
    v_mfma_f32_16x16x32_bf16 v[112:115], v[72:75], v[48:51], v[112:115]
    ds_read_b128 v[92:95], v4 offset:46080
    buffer_load_dwordx4 v[40:43], v2, s[24:27], s58 offen offset:2048 sc1
    v_mfma_f32_16x16x32_bf16 v[116:119], v[76:79], v[48:51], v[116:119]
    ds_read_b128 v[96:99], v4 offset:47104
    buffer_load_dwordx4 v[44:47], v2, s[24:27], s96 offen offset:2048 sc1
    v_mfma_f32_16x16x32_bf16 v[120:123], v[80:83], v[48:51], v[120:123]
    ds_read_b128 v[100:103], v4 offset:48128
    v_mfma_f32_16x16x32_bf16 v[124:127], v[84:87], v[48:51], v[124:127]
    ds_read_b128 v[104:107], v4 offset:49152
    v_mfma_f32_16x16x32_bf16 v[128:131], v[88:91], v[48:51], v[128:131]
    ds_read_b128 v[108:111], v4 offset:50176
    v_mfma_f32_16x16x32_bf16 v[132:135], v[72:75], v[52:55], v[132:135]
    v_mfma_f32_16x16x32_bf16 v[136:139], v[76:79], v[52:55], v[136:139]
    v_mfma_f32_16x16x32_bf16 v[140:143], v[80:83], v[52:55], v[140:143]
    s_waitcnt vmcnt(6)
    v_or_b32 v30, v56, v60
    v_mfma_f32_16x16x32_bf16 v[144:147], v[84:87], v[52:55], v[144:147]
    v_and_b32 v30, v244, v30
    v_cmp_ne_u32 vcc, 0, v30
    v_mfma_f32_16x16x32_bf16 v[148:151], v[88:91], v[52:55], v[148:151]
    s_cbranch_vccnz L5_retry13
L5_ok13:
    s_waitcnt lgkmcnt(0)
    v_mfma_f32_16x16x32_bf16 v[112:115], v[92:95], v[56:59], v[112:115]
    ds_read_b128 v[72:75], v4 offset:51200
    buffer_load_dwordx4 v[48:51], v2, s[24:27], s59 offen offset:1024 sc1
    v_mfma_f32_16x16x32_bf16 v[116:119], v[96:99], v[56:59], v[116:119]
    ds_read_b128 v[76:79], v4 offset:52224
    buffer_load_dwordx4 v[52:55], v2, s[24:27], s97 offen offset:1024 sc1
    v_mfma_f32_16x16x32_bf16 v[120:123], v[100:103], v[56:59], v[120:123]
    ds_read_b128 v[80:83], v4 offset:53248
    v_mfma_f32_16x16x32_bf16 v[124:127], v[104:107], v[56:59], v[124:127]
    ds_read_b128 v[84:87], v4 offset:54272
    v_mfma_f32_16x16x32_bf16 v[128:131], v[108:111], v[56:59], v[128:131]
    ds_read_b128 v[88:91], v4 offset:55296
    v_mfma_f32_16x16x32_bf16 v[132:135], v[92:95], v[60:63], v[132:135]
    v_mfma_f32_16x16x32_bf16 v[136:139], v[96:99], v[60:63], v[136:139]
    v_mfma_f32_16x16x32_bf16 v[140:143], v[100:103], v[60:63], v[140:143]
    s_waitcnt vmcnt(6)
    v_or_b32 v30, v64, v68
    v_mfma_f32_16x16x32_bf16 v[144:147], v[104:107], v[60:63], v[144:147]
    v_and_b32 v30, v244, v30
    v_cmp_ne_u32 vcc, 0, v30
    v_mfma_f32_16x16x32_bf16 v[148:151], v[108:111], v[60:63], v[148:151]
    s_cbranch_vccnz L5_retry14
L5_ok14:
    s_waitcnt lgkmcnt(0)
    v_mfma_f32_16x16x32_bf16 v[112:115], v[72:75], v[64:67], v[112:115]
    ds_read_b128 v[92:95], v4 offset:56320
    buffer_load_dwordx4 v[56:59], v2, s[24:27], s60 offen offset:0 sc1
    v_mfma_f32_16x16x32_bf16 v[116:119], v[76:79], v[64:67], v[116:119]
    ds_read_b128 v[96:99], v4 offset:57344
    buffer_load_dwordx4 v[60:63], v2, s[24:27], s98 offen offset:0 sc1
    v_mfma_f32_16x16x32_bf16 v[120:123], v[80:83], v[64:67], v[120:123]
    ds_read_b128 v[100:103], v4 offset:58368
    v_mfma_f32_16x16x32_bf16 v[124:127], v[84:87], v[64:67], v[124:127]
    ds_read_b128 v[104:107], v4 offset:59392
    v_mfma_f32_16x16x32_bf16 v[128:131], v[88:91], v[64:67], v[128:131]
    ds_read_b128 v[108:111], v4 offset:60416
    v_mfma_f32_16x16x32_bf16 v[132:135], v[72:75], v[68:71], v[132:135]
    v_mfma_f32_16x16x32_bf16 v[136:139], v[76:79], v[68:71], v[136:139]
    v_mfma_f32_16x16x32_bf16 v[140:143], v[80:83], v[68:71], v[140:143]
    s_waitcnt vmcnt(6)
    v_or_b32 v30, v32, v36
    v_mfma_f32_16x16x32_bf16 v[144:147], v[84:87], v[68:71], v[144:147]
    v_and_b32 v30, v244, v30
    v_cmp_ne_u32 vcc, 0, v30
    v_mfma_f32_16x16x32_bf16 v[148:151], v[88:91], v[68:71], v[148:151]
    s_cbranch_vccnz L5_retry15
L5_ok15:
    s_waitcnt lgkmcnt(0)
    s_barrier
    v_mfma_f32_16x16x32_bf16 v[112:115], v[92:95], v[32:35], v[112:115]
    ds_read_b128 v[72:75], v5 offset:0
    buffer_load_dwordx4 v[64:67], v2, s[24:27], s60 offen offset:3072 sc1
    v_mfma_f32_16x16x32_bf16 v[116:119], v[96:99], v[32:35], v[116:119]
    ds_read_b128 v[76:79], v5 offset:1024
    buffer_load_dwordx4 v[68:71], v2, s[24:27], s98 offen offset:3072 sc1
    v_mfma_f32_16x16x32_bf16 v[120:123], v[100:103], v[32:35], v[120:123]
    ds_read_b128 v[80:83], v5 offset:2048
    v_mfma_f32_16x16x32_bf16 v[124:127], v[104:107], v[32:35], v[124:127]
    ds_read_b128 v[84:87], v5 offset:3072
    v_mfma_f32_16x16x32_bf16 v[128:131], v[108:111], v[32:35], v[128:131]
    ds_read_b128 v[88:91], v5 offset:4096
    v_mfma_f32_16x16x32_bf16 v[132:135], v[92:95], v[36:39], v[132:135]
    v_mfma_f32_16x16x32_bf16 v[136:139], v[96:99], v[36:39], v[136:139]
    v_mfma_f32_16x16x32_bf16 v[140:143], v[100:103], v[36:39], v[140:143]
    s_waitcnt vmcnt(6)
    v_or_b32 v30, v40, v44
    v_mfma_f32_16x16x32_bf16 v[144:147], v[104:107], v[36:39], v[144:147]
    v_and_b32 v30, v244, v30
    v_cmp_ne_u32 vcc, 0, v30
    v_mfma_f32_16x16x32_bf16 v[148:151], v[108:111], v[36:39], v[148:151]
    s_cbranch_vccnz L5_retry16
L5_ok16:
    s_waitcnt lgkmcnt(0)
    v_mfma_f32_16x16x32_bf16 v[112:115], v[72:75], v[40:43], v[112:115]
    ds_read_b128 v[92:95], v5 offset:5120
    buffer_load_dwordx4 v[32:35], v2, s[24:27], s61 offen offset:2048 sc1
    v_mfma_f32_16x16x32_bf16 v[116:119], v[76:79], v[40:43], v[116:119]
    ds_read_b128 v[96:99], v5 offset:6144
    buffer_load_dwordx4 v[36:39], v2, s[24:27], s99 offen offset:2048 sc1
    v_mfma_f32_16x16x32_bf16 v[120:123], v[80:83], v[40:43], v[120:123]
    ds_read_b128 v[100:103], v5 offset:7168
    v_mfma_f32_16x16x32_bf16 v[124:127], v[84:87], v[40:43], v[124:127]
    ds_read_b128 v[104:107], v5 offset:8192
    v_mfma_f32_16x16x32_bf16 v[128:131], v[88:91], v[40:43], v[128:131]
    ds_read_b128 v[108:111], v5 offset:9216
    v_mfma_f32_16x16x32_bf16 v[132:135], v[72:75], v[44:47], v[132:135]
    v_mfma_f32_16x16x32_bf16 v[136:139], v[76:79], v[44:47], v[136:139]
    v_mfma_f32_16x16x32_bf16 v[140:143], v[80:83], v[44:47], v[140:143]
    s_waitcnt vmcnt(6)
    v_or_b32 v30, v48, v52
    v_mfma_f32_16x16x32_bf16 v[144:147], v[84:87], v[44:47], v[144:147]
    v_and_b32 v30, v244, v30
    v_cmp_ne_u32 vcc, 0, v30
    v_mfma_f32_16x16x32_bf16 v[148:151], v[88:91], v[44:47], v[148:151]
    s_cbranch_vccnz L5_retry17
L5_ok17:
    s_waitcnt lgkmcnt(0)
    v_mfma_f32_16x16x32_bf16 v[112:115], v[92:95], v[48:51], v[112:115]
    ds_read_b128 v[72:75], v5 offset:10240
    buffer_load_dwordx4 v[40:43], v2, s[24:27], s62 offen offset:1024 sc1
    v_mfma_f32_16x16x32_bf16 v[116:119], v[96:99], v[48:51], v[116:119]
    ds_read_b128 v[76:79], v5 offset:11264
    buffer_load_dwordx4 v[44:47], v2, s[24:27], s100 offen offset:1024 sc1
    v_mfma_f32_16x16x32_bf16 v[120:123], v[100:103], v[48:51], v[120:123]
    ds_read_b128 v[80:83], v5 offset:12288
    v_mfma_f32_16x16x32_bf16 v[124:127], v[104:107], v[48:51], v[124:127]
    ds_read_b128 v[84:87], v5 offset:13312
    v_mfma_f32_16x16x32_bf16 v[128:131], v[108:111], v[48:51], v[128:131]
    ds_read_b128 v[88:91], v5 offset:14336
    v_mfma_f32_16x16x32_bf16 v[132:135], v[92:95], v[52:55], v[132:135]
    v_mfma_f32_16x16x32_bf16 v[136:139], v[96:99], v[52:55], v[136:139]
    v_mfma_f32_16x16x32_bf16 v[140:143], v[100:103], v[52:55], v[140:143]
    s_waitcnt vmcnt(6)
    v_or_b32 v30, v56, v60
    v_mfma_f32_16x16x32_bf16 v[144:147], v[104:107], v[52:55], v[144:147]
    v_and_b32 v30, v244, v30
    v_cmp_ne_u32 vcc, 0, v30
    v_mfma_f32_16x16x32_bf16 v[148:151], v[108:111], v[52:55], v[148:151]
    s_cbranch_vccnz L5_retry18
L5_ok18:
    s_waitcnt lgkmcnt(0)
    v_mfma_f32_16x16x32_bf16 v[112:115], v[72:75], v[56:59], v[112:115]
    ds_read_b128 v[92:95], v5 offset:15360
    buffer_load_dwordx4 v[48:51], v2, s[24:27], s63 offen offset:0 sc1
    v_mfma_f32_16x16x32_bf16 v[116:119], v[76:79], v[56:59], v[116:119]
    ds_read_b128 v[96:99], v5 offset:16384
    buffer_load_dwordx4 v[52:55], v2, s[24:27], s101 offen offset:0 sc1
    v_mfma_f32_16x16x32_bf16 v[120:123], v[80:83], v[56:59], v[120:123]
    ds_read_b128 v[100:103], v5 offset:17408
    v_mfma_f32_16x16x32_bf16 v[124:127], v[84:87], v[56:59], v[124:127]
    ds_read_b128 v[104:107], v5 offset:18432
    v_mfma_f32_16x16x32_bf16 v[128:131], v[88:91], v[56:59], v[128:131]
    ds_read_b128 v[108:111], v5 offset:19456
    v_mfma_f32_16x16x32_bf16 v[132:135], v[72:75], v[60:63], v[132:135]
    v_mfma_f32_16x16x32_bf16 v[136:139], v[76:79], v[60:63], v[136:139]
    v_mfma_f32_16x16x32_bf16 v[140:143], v[80:83], v[60:63], v[140:143]
    s_waitcnt vmcnt(6)
    v_or_b32 v30, v64, v68
    v_mfma_f32_16x16x32_bf16 v[144:147], v[84:87], v[60:63], v[144:147]
    v_and_b32 v30, v244, v30
    v_cmp_ne_u32 vcc, 0, v30
    v_mfma_f32_16x16x32_bf16 v[148:151], v[88:91], v[60:63], v[148:151]
    s_cbranch_vccnz L5_retry19
L5_ok19:
    s_waitcnt lgkmcnt(0)
    s_barrier
    v_mfma_f32_16x16x32_bf16 v[112:115], v[92:95], v[64:67], v[112:115]
    ds_read_b128 v[72:75], v5 offset:40960
    buffer_load_dwordx4 v[56:59], v2, s[24:27], s63 offen offset:3072 sc1
    v_mfma_f32_16x16x32_bf16 v[116:119], v[96:99], v[64:67], v[116:119]
    ds_read_b128 v[76:79], v5 offset:41984
    buffer_load_dwordx4 v[60:63], v2, s[24:27], s101 offen offset:3072 sc1
    v_mfma_f32_16x16x32_bf16 v[120:123], v[100:103], v[64:67], v[120:123]
    ds_read_b128 v[80:83], v5 offset:43008
    v_mfma_f32_16x16x32_bf16 v[124:127], v[104:107], v[64:67], v[124:127]
    ds_read_b128 v[84:87], v5 offset:44032
    v_mfma_f32_16x16x32_bf16 v[128:131], v[108:111], v[64:67], v[128:131]
    ds_read_b128 v[88:91], v5 offset:45056
    v_mfma_f32_16x16x32_bf16 v[132:135], v[92:95], v[68:71], v[132:135]
    v_mfma_f32_16x16x32_bf16 v[136:139], v[96:99], v[68:71], v[136:139]
    v_mfma_f32_16x16x32_bf16 v[140:143], v[100:103], v[68:71], v[140:143]
    s_waitcnt vmcnt(6)
    v_or_b32 v30, v32, v36
    v_mfma_f32_16x16x32_bf16 v[144:147], v[104:107], v[68:71], v[144:147]
    v_and_b32 v30, v244, v30
    v_cmp_ne_u32 vcc, 0, v30
    v_mfma_f32_16x16x32_bf16 v[148:151], v[108:111], v[68:71], v[148:151]
    s_cbranch_vccnz L5_retry20
L5_ok20:
    s_waitcnt lgkmcnt(0)
    v_mfma_f32_16x16x32_bf16 v[112:115], v[72:75], v[32:35], v[112:115]
    ds_read_b128 v[92:95], v5 offset:46080
    v_mfma_f32_16x16x32_bf16 v[116:119], v[76:79], v[32:35], v[116:119]
    ds_read_b128 v[96:99], v5 offset:47104
    v_mfma_f32_16x16x32_bf16 v[120:123], v[80:83], v[32:35], v[120:123]
    ds_read_b128 v[100:103], v5 offset:48128
    v_mfma_f32_16x16x32_bf16 v[124:127], v[84:87], v[32:35], v[124:127]
    ds_read_b128 v[104:107], v5 offset:49152
    v_mfma_f32_16x16x32_bf16 v[128:131], v[88:91], v[32:35], v[128:131]
    ds_read_b128 v[108:111], v5 offset:50176
    v_mfma_f32_16x16x32_bf16 v[132:135], v[72:75], v[36:39], v[132:135]
    v_mfma_f32_16x16x32_bf16 v[136:139], v[76:79], v[36:39], v[136:139]
    v_mfma_f32_16x16x32_bf16 v[140:143], v[80:83], v[36:39], v[140:143]
    s_waitcnt vmcnt(4)
    v_or_b32 v30, v40, v44
    v_mfma_f32_16x16x32_bf16 v[144:147], v[84:87], v[36:39], v[144:147]
    v_and_b32 v30, v244, v30
    v_cmp_ne_u32 vcc, 0, v30
    v_mfma_f32_16x16x32_bf16 v[148:151], v[88:91], v[36:39], v[148:151]
    s_cbranch_vccnz L5_retry21
L5_ok21:
    s_waitcnt lgkmcnt(0)
    v_mfma_f32_16x16x32_bf16 v[112:115], v[92:95], v[40:43], v[112:115]
    ds_read_b128 v[72:75], v5 offset:51200
    v_mfma_f32_16x16x32_bf16 v[116:119], v[96:99], v[40:43], v[116:119]
    ds_read_b128 v[76:79], v5 offset:52224
    v_mfma_f32_16x16x32_bf16 v[120:123], v[100:103], v[40:43], v[120:123]
    ds_read_b128 v[80:83], v5 offset:53248
    v_mfma_f32_16x16x32_bf16 v[124:127], v[104:107], v[40:43], v[124:127]
    ds_read_b128 v[84:87], v5 offset:54272
    v_mfma_f32_16x16x32_bf16 v[128:131], v[108:111], v[40:43], v[128:131]
    ds_read_b128 v[88:91], v5 offset:55296
    v_mfma_f32_16x16x32_bf16 v[132:135], v[92:95], v[44:47], v[132:135]
    v_mfma_f32_16x16x32_bf16 v[136:139], v[96:99], v[44:47], v[136:139]
    v_mfma_f32_16x16x32_bf16 v[140:143], v[100:103], v[44:47], v[140:143]
    s_waitcnt vmcnt(2)
    v_or_b32 v30, v48, v52
    v_mfma_f32_16x16x32_bf16 v[144:147], v[104:107], v[44:47], v[144:147]
    v_and_b32 v30, v244, v30
    v_cmp_ne_u32 vcc, 0, v30
    v_mfma_f32_16x16x32_bf16 v[148:151], v[108:111], v[44:47], v[148:151]
    s_cbranch_vccnz L5_retry22
L5_ok22:
    s_waitcnt lgkmcnt(0)
    v_mfma_f32_16x16x32_bf16 v[112:115], v[72:75], v[48:51], v[112:115]
    ds_read_b128 v[92:95], v5 offset:56320
    v_mfma_f32_16x16x32_bf16 v[116:119], v[76:79], v[48:51], v[116:119]
    ds_read_b128 v[96:99], v5 offset:57344
    v_mfma_f32_16x16x32_bf16 v[120:123], v[80:83], v[48:51], v[120:123]
    ds_read_b128 v[100:103], v5 offset:58368
    v_mfma_f32_16x16x32_bf16 v[124:127], v[84:87], v[48:51], v[124:127]
    ds_read_b128 v[104:107], v5 offset:59392
    v_mfma_f32_16x16x32_bf16 v[128:131], v[88:91], v[48:51], v[128:131]
    ds_read_b128 v[108:111], v5 offset:60416
    v_mfma_f32_16x16x32_bf16 v[132:135], v[72:75], v[52:55], v[132:135]
    v_mfma_f32_16x16x32_bf16 v[136:139], v[76:79], v[52:55], v[136:139]
    v_mfma_f32_16x16x32_bf16 v[140:143], v[80:83], v[52:55], v[140:143]
    s_waitcnt vmcnt(0)
    v_or_b32 v30, v56, v60
    v_mfma_f32_16x16x32_bf16 v[144:147], v[84:87], v[52:55], v[144:147]
    v_and_b32 v30, v244, v30
    v_cmp_ne_u32 vcc, 0, v30
    v_mfma_f32_16x16x32_bf16 v[148:151], v[88:91], v[52:55], v[148:151]
    s_cbranch_vccnz L5_retry23
L5_ok23:
    s_waitcnt lgkmcnt(0)
    v_mfma_f32_16x16x32_bf16 v[112:115], v[92:95], v[56:59], v[112:115]
    v_mfma_f32_16x16x32_bf16 v[116:119], v[96:99], v[56:59], v[116:119]
    v_mfma_f32_16x16x32_bf16 v[120:123], v[100:103], v[56:59], v[120:123]
    v_mfma_f32_16x16x32_bf16 v[124:127], v[104:107], v[56:59], v[124:127]
    v_mfma_f32_16x16x32_bf16 v[128:131], v[108:111], v[56:59], v[128:131]
    v_mfma_f32_16x16x32_bf16 v[132:135], v[92:95], v[60:63], v[132:135]
    v_mfma_f32_16x16x32_bf16 v[136:139], v[96:99], v[60:63], v[136:139]
    v_mfma_f32_16x16x32_bf16 v[140:143], v[100:103], v[60:63], v[140:143]
    v_mfma_f32_16x16x32_bf16 v[144:147], v[104:107], v[60:63], v[144:147]
    v_mfma_f32_16x16x32_bf16 v[148:151], v[108:111], v[60:63], v[148:151]
    s_nop 2
    ds_write_b128 v20, v[112:115] offset:0
    ds_write_b128 v20, v[116:119] offset:64
    ds_write_b128 v20, v[120:123] offset:128
    ds_write_b128 v20, v[124:127] offset:192
    ds_write_b128 v20, v[128:131] offset:256
    ds_write_b128 v19, v[132:135] offset:0
    ds_write_b128 v19, v[136:139] offset:64
    ds_write_b128 v19, v[140:143] offset:128
    ds_write_b128 v19, v[144:147] offset:192
    ds_write_b128 v19, v[148:151] offset:256
    s_waitcnt lgkmcnt(0)
L5_red:
    s_barrier
    ds_read_b128 v[32:35], v25 offset:0
    ds_read_b128 v[36:39], v25 offset:16
    ds_read_b128 v[40:43], v25 offset:21504
    ds_read_b128 v[44:47], v25 offset:21520
    s_waitcnt lgkmcnt(0)
    v_pk_add_f32 v[32:33], v[32:33], v[40:41]
    v_pk_add_f32 v[34:35], v[34:35], v[42:43]
    v_pk_add_f32 v[36:37], v[36:37], v[44:45]
    v_pk_add_f32 v[38:39], v[38:39], v[46:47]
    v_cvt_pk_bf16_f32 v32, v32, v33
    v_cvt_pk_bf16_f32 v33, v34, v35
    v_cvt_pk_bf16_f32 v34, v36, v37
    v_cvt_pk_bf16_f32 v35, v38, v39
    buffer_store_dwordx4 v[32:35], v26, s[16:19], s51 offen
    s_sub_u32 s3, s42, 4
    s_cmp_ge_u32 s3, 2
    s_cbranch_scc1 L5_end
    ds_read_b128 v[64:67], v27 offset:0
    ds_read_b128 v[68:71], v27 offset:16
    ds_read_b128 v[72:75], v27 offset:21504
    ds_read_b128 v[76:79], v27 offset:21520
    s_waitcnt lgkmcnt(0)
    v_pk_add_f32 v[64:65], v[64:65], v[72:73]
    v_pk_add_f32 v[66:67], v[66:67], v[74:75]
    v_pk_add_f32 v[68:69], v[68:69], v[76:77]
    v_pk_add_f32 v[70:71], v[70:71], v[78:79]
    v_cvt_pk_bf16_f32 v64, v64, v65
    v_cvt_pk_bf16_f32 v65, v66, v67
    v_cvt_pk_bf16_f32 v66, v68, v69
    v_cvt_pk_bf16_f32 v67, v70, v71
    buffer_store_dwordx4 v[64:67], v28, s[16:19], s51 offen
L5_end:
    s_endpgm
L_exit:
    s_endpgm
L2_cs0:
    s_lshl_b32 s15, s2, 8
    s_add_u32 s15, s15, 11796480
    buffer_load_dword v168, v204, s[24:27], s15 offen sc1
    s_add_u32 s15, s15, 12288
    buffer_load_dword v169, v204, s[24:27], s15 offen sc1
    s_add_u32 s15, s15, 12288
    buffer_load_dword v170, v204, s[24:27], s15 offen sc1
    s_add_u32 s15, s15, 12288
    buffer_load_dword v171, v204, s[24:27], s15 offen sc1
    s_add_u32 s15, s15, 12288
    buffer_load_dword v172, v204, s[24:27], s15 offen sc1
    s_add_u32 s15, s15, 12288
    buffer_load_dword v173, v204, s[24:27], s15 offen sc1
    s_add_u32 s15, s15, 12288
    buffer_load_dword v174, v204, s[24:27], s15 offen sc1
    s_add_u32 s15, s15, 12288
    buffer_load_dword v175, v204, s[24:27], s15 offen sc1
    s_add_u32 s15, s15, 12288
    buffer_load_dword v176, v204, s[24:27], s15 offen sc1
    s_add_u32 s15, s15, 12288
    buffer_load_dword v177, v204, s[24:27], s15 offen sc1
    s_add_u32 s15, s15, 12288
    buffer_load_dword v178, v204, s[24:27], s15 offen sc1
    s_add_u32 s15, s15, 12288
    buffer_load_dword v179, v204, s[24:27], s15 offen sc1
    s_add_u32 s15, s15, 12288
    buffer_load_dword v180, v204, s[24:27], s15 offen sc1
    s_add_u32 s15, s15, 12288
    buffer_load_dword v181, v204, s[24:27], s15 offen sc1
    s_add_u32 s15, s15, 12288
    buffer_load_dword v182, v204, s[24:27], s15 offen sc1
    s_add_u32 s15, s15, 12288
    buffer_load_dword v183, v204, s[24:27], s15 offen sc1
    s_add_u32 s15, s15, 12288
    buffer_load_dword v184, v204, s[24:27], s15 offen sc1
    s_add_u32 s15, s15, 12288
    buffer_load_dword v185, v204, s[24:27], s15 offen sc1
    s_add_u32 s15, s15, 12288
    buffer_load_dword v186, v204, s[24:27], s15 offen sc1
    s_add_u32 s15, s15, 12288
    buffer_load_dword v187, v204, s[24:27], s15 offen sc1
    s_branch L2_csb0
L2_cs1:
    s_waitcnt vmcnt(9)
    v_add_f32 v168, v168, v169
    v_add_f32 v168, v168, v170
    v_add_f32 v168, v168, v171
    v_add_f32 v168, v168, v172
    v_add_f32 v168, v168, v173
    v_add_f32 v168, v168, v174
    v_add_f32 v168, v168, v175
    v_add_f32 v168, v168, v176
    v_add_f32 v168, v168, v177
    v_add_f32 v168, v168, v178
    v_add_f32 v168, v168, v179
    v_add_f32 v168, v168, v180
    v_add_f32 v168, v168, v181
    v_add_f32 v168, v168, v182
    v_add_f32 v168, v168, v183
    v_add_f32 v168, v168, v184
    v_add_f32 v168, v168, v185
    v_add_f32 v168, v168, v186
    v_add_f32 v168, v168, v187
    v_min_u32 v168, -2, v168
    s_lshl_b32 s15, s2, 8
    s_add_u32 s15, s15, 11665408
    buffer_store_dword v168, v204, s[24:27], s15 offen sc1
    s_branch L2_csb1
L2_bad:
    s_cmp_lg_u32 s45, 0
    s_cbranch_scc1 L2_done
    s_mov_b32 s45, 1
    s_waitcnt vmcnt(0)
    s_barrier
    v_mov_b32 v62, 0xff800000
    v_mov_b32 v63, 0xff800000
    s_add_u32 s15, s96, 2621440
    s_mov_b32 s46, 0
L2_mloop:
    buffer_load_dwordx4 v[24:27], v55, s[24:27], s15 offen offset:0 sc1
    buffer_load_dwordx2 v[32:33], v54, s[24:27], s15 offen offset:0 sc1
    s_waitcnt vmcnt(0)
    v_mfma_f32_32x32x4_2b_bf16 v[64:95], v[32:33], v[16:17], 0 cbsz:1 abid:0
    s_nop 15
    s_nop 1
    v_mfma_f32_32x32x16_bf16 v[64:79], v[24:27], v[8:11], v[64:79]
    v_mfma_f32_32x32x16_bf16 v[80:95], v[24:27], v[12:15], v[80:95]
    s_nop 15
    v_max3_f32 v62, v64, v65, v62
    v_max3_f32 v62, v66, v67, v62
    v_max3_f32 v62, v68, v69, v62
    v_max3_f32 v62, v70, v71, v62
    v_max3_f32 v62, v72, v73, v62
    v_max3_f32 v62, v74, v75, v62
    v_max3_f32 v62, v76, v77, v62
    v_max3_f32 v62, v78, v79, v62
    v_max3_f32 v63, v80, v81, v63
    v_max3_f32 v63, v82, v83, v63
    v_max3_f32 v63, v84, v85, v63
    v_max3_f32 v63, v86, v87, v63
    v_max3_f32 v63, v88, v89, v63
    v_max3_f32 v63, v90, v91, v63
    v_max3_f32 v63, v92, v93, v63
    v_max3_f32 v63, v94, v95, v63
    buffer_load_dwordx4 v[24:27], v55, s[24:27], s15 offen offset:512 sc1
    buffer_load_dwordx2 v[32:33], v54, s[24:27], s15 offen offset:512 sc1
    s_waitcnt vmcnt(0)
    v_mfma_f32_32x32x4_2b_bf16 v[64:95], v[32:33], v[16:17], 0 cbsz:1 abid:0
    s_nop 15
    s_nop 1
    v_mfma_f32_32x32x16_bf16 v[64:79], v[24:27], v[8:11], v[64:79]
    v_mfma_f32_32x32x16_bf16 v[80:95], v[24:27], v[12:15], v[80:95]
    s_nop 15
    v_max3_f32 v62, v64, v65, v62
    v_max3_f32 v62, v66, v67, v62
    v_max3_f32 v62, v68, v69, v62
    v_max3_f32 v62, v70, v71, v62
    v_max3_f32 v62, v72, v73, v62
    v_max3_f32 v62, v74, v75, v62
    v_max3_f32 v62, v76, v77, v62
    v_max3_f32 v62, v78, v79, v62
    v_max3_f32 v63, v80, v81, v63
    v_max3_f32 v63, v82, v83, v63
    v_max3_f32 v63, v84, v85, v63
    v_max3_f32 v63, v86, v87, v63
    v_max3_f32 v63, v88, v89, v63
    v_max3_f32 v63, v90, v91, v63
    v_max3_f32 v63, v92, v93, v63
    v_max3_f32 v63, v94, v95, v63
    buffer_load_dwordx4 v[24:27], v55, s[24:27], s15 offen offset:1024 sc1
    buffer_load_dwordx2 v[32:33], v54, s[24:27], s15 offen offset:1024 sc1
    s_waitcnt vmcnt(0)
    v_mfma_f32_32x32x4_2b_bf16 v[64:95], v[32:33], v[16:17], 0 cbsz:1 abid:0
    s_nop 15
    s_nop 1
    v_mfma_f32_32x32x16_bf16 v[64:79], v[24:27], v[8:11], v[64:79]
    v_mfma_f32_32x32x16_bf16 v[80:95], v[24:27], v[12:15], v[80:95]
    s_nop 15
    v_max3_f32 v62, v64, v65, v62
    v_max3_f32 v62, v66, v67, v62
    v_max3_f32 v62, v68, v69, v62
    v_max3_f32 v62, v70, v71, v62
    v_max3_f32 v62, v72, v73, v62
    v_max3_f32 v62, v74, v75, v62
    v_max3_f32 v62, v76, v77, v62
    v_max3_f32 v62, v78, v79, v62
    v_max3_f32 v63, v80, v81, v63
    v_max3_f32 v63, v82, v83, v63
    v_max3_f32 v63, v84, v85, v63
    v_max3_f32 v63, v86, v87, v63
    v_max3_f32 v63, v88, v89, v63
    v_max3_f32 v63, v90, v91, v63
    v_max3_f32 v63, v92, v93, v63
    v_max3_f32 v63, v94, v95, v63
    buffer_load_dwordx4 v[24:27], v55, s[24:27], s15 offen offset:1536 sc1
    buffer_load_dwordx2 v[32:33], v54, s[24:27], s15 offen offset:1536 sc1
    s_waitcnt vmcnt(0)
    v_mfma_f32_32x32x4_2b_bf16 v[64:95], v[32:33], v[16:17], 0 cbsz:1 abid:0
    s_nop 15
    s_nop 1
    v_mfma_f32_32x32x16_bf16 v[64:79], v[24:27], v[8:11], v[64:79]
    v_mfma_f32_32x32x16_bf16 v[80:95], v[24:27], v[12:15], v[80:95]
    s_nop 15
    v_max3_f32 v62, v64, v65, v62
    v_max3_f32 v62, v66, v67, v62
    v_max3_f32 v62, v68, v69, v62
    v_max3_f32 v62, v70, v71, v62
    v_max3_f32 v62, v72, v73, v62
    v_max3_f32 v62, v74, v75, v62
    v_max3_f32 v62, v76, v77, v62
    v_max3_f32 v62, v78, v79, v62
    v_max3_f32 v63, v80, v81, v63
    v_max3_f32 v63, v82, v83, v63
    v_max3_f32 v63, v84, v85, v63
    v_max3_f32 v63, v86, v87, v63
    v_max3_f32 v63, v88, v89, v63
    v_max3_f32 v63, v90, v91, v63
    v_max3_f32 v63, v92, v93, v63
    v_max3_f32 v63, v94, v95, v63
    s_add_u32 s15, s15, 163840
    s_add_u32 s46, s46, 1
    s_cmp_lt_u32 s46, 16
    s_cbranch_scc1 L2_mloop
    v_mov_b32 v61, v62
    v_mov_b32 v60, v63
    s_nop 1
    v_permlane32_swap_b32 v61, v62
    v_permlane32_swap_b32 v60, v63
    v_max_f32 v62, v62, v61
    v_max_f32 v63, v63, v60
    v_sub_f32 v168, 0, v62
    v_sub_f32 v169, 0, v62
    v_sub_f32 v170, 0, v62
    v_sub_f32 v171, 0, v62
    v_sub_f32 v172, 0, v62
    v_sub_f32 v173, 0, v62
    v_sub_f32 v174, 0, v62
    v_sub_f32 v175, 0, v62
    v_sub_f32 v176, 0, v62
    v_sub_f32 v177, 0, v62
    v_sub_f32 v178, 0, v62
    v_sub_f32 v179, 0, v62
    v_sub_f32 v180, 0, v62
    v_sub_f32 v181, 0, v62
    v_sub_f32 v182, 0, v62
    v_sub_f32 v183, 0, v62
    v_sub_f32 v184, 0, v63
    v_sub_f32 v185, 0, v63
    v_sub_f32 v186, 0, v63
    v_sub_f32 v187, 0, v63
    v_sub_f32 v188, 0, v63
    v_sub_f32 v189, 0, v63
    v_sub_f32 v190, 0, v63
    v_sub_f32 v191, 0, v63
    v_sub_f32 v192, 0, v63
    v_sub_f32 v193, 0, v63
    v_sub_f32 v194, 0, v63
    v_sub_f32 v195, 0, v63
    v_sub_f32 v196, 0, v63
    v_sub_f32 v197, 0, v63
    v_sub_f32 v198, 0, v63
    v_sub_f32 v199, 0, v63
    v_mov_b32 v128, 0
    v_mov_b32 v129, 0
    v_mov_b32 v130, 0
    v_mov_b32 v131, 0
    v_mov_b32 v132, 0
    v_mov_b32 v133, 0
    v_mov_b32 v134, 0
    v_mov_b32 v135, 0
    v_mov_b32 v136, 0
    v_mov_b32 v137, 0
    v_mov_b32 v138, 0
    v_mov_b32 v139, 0
    v_mov_b32 v140, 0
    v_mov_b32 v141, 0
    v_mov_b32 v142, 0
    v_mov_b32 v143, 0
    v_mov_b32 v144, 0
    v_mov_b32 v145, 0
    v_mov_b32 v146, 0
    v_mov_b32 v147, 0
    v_mov_b32 v148, 0
    v_mov_b32 v149, 0
    v_mov_b32 v150, 0
    v_mov_b32 v151, 0
    v_mov_b32 v152, 0
    v_mov_b32 v153, 0
    v_mov_b32 v154, 0
    v_mov_b32 v155, 0
    v_mov_b32 v156, 0
    v_mov_b32 v157, 0
    v_mov_b32 v158, 0
    v_mov_b32 v159, 0
    s_mul_i32 s14, s44, 1310720
    s_add_u32 s15, s96, 2621440
    s_add_u32 s15, s15, s14
    s_mul_i32 s3, s40, 320
    s_add_u32 s14, s14, s3
    s_add_u32 s14, s14, 5242880
    v_mul_u32_u24 v60, 10240, v53
    v_lshl_add_u32 v60, v52, 4, v60
    v_add_u32 v61, 20480, v60
    s_mov_b32 s46, 0
L2_floop:
    buffer_load_dwordx4 v[24:27], v55, s[24:27], s15 offen sc1
    buffer_load_dwordx2 v[32:33], v54, s[24:27], s15 offen sc1
    s_mov_b64 exec, s[48:49]
    buffer_load_dwordx4 v[36:39], v60, s[24:27], s14 offen sc1
    buffer_load_dwordx4 v[40:43], v61, s[24:27], s14 offen sc1
    s_mov_b64 exec, -1
    s_waitcnt vmcnt(0)
    v_mfma_f32_32x32x4_2b_bf16 v[64:95], v[32:33], v[16:17], v[168:199] cbsz:1 abid:0
    s_nop 15
    s_nop 1
    v_mfma_f32_32x32x16_bf16 v[64:79], v[24:27], v[8:11], v[64:79]
    v_mfma_f32_32x32x16_bf16 v[80:95], v[24:27], v[12:15], v[80:95]
    s_nop 15
    v_exp_f32 v64, v64
    v_exp_f32 v65, v65
    v_exp_f32 v66, v66
    v_exp_f32 v67, v67
    v_exp_f32 v68, v68
    v_exp_f32 v69, v69
    v_exp_f32 v70, v70
    v_exp_f32 v71, v71
    v_exp_f32 v72, v72
    v_exp_f32 v73, v73
    v_exp_f32 v74, v74
    v_exp_f32 v75, v75
    v_exp_f32 v76, v76
    v_exp_f32 v77, v77
    v_exp_f32 v78, v78
    v_exp_f32 v79, v79
    v_exp_f32 v80, v80
    v_exp_f32 v81, v81
    v_exp_f32 v82, v82
    v_exp_f32 v83, v83
    v_exp_f32 v84, v84
    v_exp_f32 v85, v85
    v_exp_f32 v86, v86
    v_exp_f32 v87, v87
    v_exp_f32 v88, v88
    v_exp_f32 v89, v89
    v_exp_f32 v90, v90
    v_exp_f32 v91, v91
    v_exp_f32 v92, v92
    v_exp_f32 v93, v93
    v_exp_f32 v94, v94
    v_exp_f32 v95, v95
    s_nop 1
    v_smfmac_f32_32x32x32_bf16 v[128:143], v[36:39], v[64:71], v7
    v_smfmac_f32_32x32x32_bf16 v[128:143], v[40:43], v[72:79], v7
    v_smfmac_f32_32x32x32_bf16 v[144:159], v[36:39], v[80:87], v7
    v_smfmac_f32_32x32x32_bf16 v[144:159], v[40:43], v[88:95], v7
    s_add_u32 s14, s14, 40960
    s_add_u32 s15, s15, 512
    s_add_u32 s46, s46, 1
    s_and_b32 s3, s46, 3
    s_cmp_eq_u32 s3, 0
    s_cselect_b32 s3, 161792, 0
    s_add_u32 s15, s15, s3
    s_cmp_lt_u32 s46, 32
    s_cbranch_scc1 L2_floop
    s_branch L2_epi
L2_kvwait:
    s_mov_b32 s14, 400000
    s_mov_b32 exec_lo, 0xffffffff
    s_mov_b32 exec_hi, 0xffffffff
Lpoll2:
    buffer_load_dword v236, v235, s[24:27], 0 offen sc1
    s_waitcnt vmcnt(0)
    v_cmp_ne_u32 vcc, 0, v236
    s_sub_u32 s14, s14, 1
    s_cmp_eq_u32 s14, 0
    s_cbranch_scc1 Lpolld2
    s_cmp_eq_u64 vcc, exec
    s_cbranch_scc0 Lpoll2
Lpolld2:
    s_mov_b64 exec, -1
    s_branch L2_kvback
L2_cpwait:
    s_and_b32 s15, s2, 7
    s_lshl_b32 s15, s15, 3
    s_add_u32 s15, s15, 264
    s_lshl_b32 s3, s15, 8
    s_add_u32 s3, s3, 18776064
    v_lshl_add_u32 v200, v0, 8, s3
    s_mov_b32 s14, 400000
    s_mov_b64 exec, 255
Lpoll3:
    buffer_load_dword v201, v200, s[24:27], 0 offen sc1
    s_waitcnt vmcnt(0)
    v_cmp_le_u32 vcc, 1, v201
    s_sub_u32 s14, s14, 1
    s_cmp_eq_u32 s14, 0
    s_cbranch_scc1 Lpolld3
    s_cmp_eq_u64 vcc, exec
    s_cbranch_scc0 Lpoll3
Lpolld3:
    s_mov_b64 exec, -1
    s_branch L2_cpback
L3_retry0:
    s_waitcnt vmcnt(0)
    buffer_load_dwordx4 v[80:83], v230, s[24:27], 0 offen offset:0 sc1
    v_cmp_eq_u32 vcc, -1, v84
    s_cbranch_vccz L3_keep0_1
    buffer_load_dwordx4 v[84:87], v230, s[24:27], 0 offen offset:1024 sc1
L3_keep0_1:
    v_cmp_eq_u32 vcc, -1, v88
    s_cbranch_vccz L3_keep0_2
    buffer_load_dwordx4 v[88:91], v230, s[24:27], 0 offen offset:2048 sc1
L3_keep0_2:
    v_cmp_eq_u32 vcc, -1, v92
    s_cbranch_vccz L3_keep0_3
    buffer_load_dwordx4 v[92:95], v230, s[24:27], 0 offen offset:3072 sc1
L3_keep0_3:
    v_cmp_eq_u32 vcc, -1, v96
    s_cbranch_vccz L3_keep0_4
    buffer_load_dwordx4 v[96:99], v231, s[24:27], 0 offen offset:0 sc1
L3_keep0_4:
    v_cmp_eq_u32 vcc, -1, v100
    s_cbranch_vccz L3_keep0_5
    buffer_load_dwordx4 v[100:103], v231, s[24:27], 0 offen offset:1024 sc1
L3_keep0_5:
    v_cmp_eq_u32 vcc, -1, v104
    s_cbranch_vccz L3_keep0_6
    buffer_load_dwordx4 v[104:107], v231, s[24:27], 0 offen offset:2048 sc1
L3_keep0_6:
    v_cmp_eq_u32 vcc, -1, v108
    s_cbranch_vccz L3_keep0_7
    buffer_load_dwordx4 v[108:111], v231, s[24:27], 0 offen offset:3072 sc1
L3_keep0_7:
    v_max_u32 v158, v112, v114
    v_cmp_eq_u32 vcc, -1, v158
    s_cbranch_vccz L3_keep0_8
    buffer_load_dwordx2 v[112:113], v232, s[24:27], 0 offen offset:0 sc1
    buffer_load_dwordx2 v[114:115], v232, s[24:27], 0 offen offset:128 sc1
L3_keep0_8:
    v_max_u32 v158, v116, v118
    v_cmp_eq_u32 vcc, -1, v158
    s_cbranch_vccz L3_keep0_9
    buffer_load_dwordx2 v[116:117], v232, s[24:27], 0 offen offset:1024 sc1
    buffer_load_dwordx2 v[118:119], v232, s[24:27], 0 offen offset:1152 sc1
L3_keep0_9:
    s_waitcnt vmcnt(0)
    v_cmp_eq_u32 vcc, -1, v80
    s_cmp_eq_u32 s14, 0
    s_cbranch_scc1 L3_ok0
    s_sub_u32 s14, s14, 1
    s_cbranch_vccnz L3_retry0
    s_branch L3_ok0
L3_retry1:
    s_waitcnt vmcnt(0)
    buffer_load_dwordx4 v[84:87], v230, s[24:27], 0 offen offset:1024 sc1
    v_cmp_eq_u32 vcc, -1, v88
    s_cbranch_vccz L3_keep1_2
    buffer_load_dwordx4 v[88:91], v230, s[24:27], 0 offen offset:2048 sc1
L3_keep1_2:
    v_cmp_eq_u32 vcc, -1, v92
    s_cbranch_vccz L3_keep1_3
    buffer_load_dwordx4 v[92:95], v230, s[24:27], 0 offen offset:3072 sc1
L3_keep1_3:
    v_cmp_eq_u32 vcc, -1, v96
    s_cbranch_vccz L3_keep1_4
    buffer_load_dwordx4 v[96:99], v231, s[24:27], 0 offen offset:0 sc1
L3_keep1_4:
    v_cmp_eq_u32 vcc, -1, v100
    s_cbranch_vccz L3_keep1_5
    buffer_load_dwordx4 v[100:103], v231, s[24:27], 0 offen offset:1024 sc1
L3_keep1_5:
    v_cmp_eq_u32 vcc, -1, v104
    s_cbranch_vccz L3_keep1_6
    buffer_load_dwordx4 v[104:107], v231, s[24:27], 0 offen offset:2048 sc1
L3_keep1_6:
    v_cmp_eq_u32 vcc, -1, v108
    s_cbranch_vccz L3_keep1_7
    buffer_load_dwordx4 v[108:111], v231, s[24:27], 0 offen offset:3072 sc1
L3_keep1_7:
    v_max_u32 v158, v112, v114
    v_cmp_eq_u32 vcc, -1, v158
    s_cbranch_vccz L3_keep1_8
    buffer_load_dwordx2 v[112:113], v232, s[24:27], 0 offen offset:0 sc1
    buffer_load_dwordx2 v[114:115], v232, s[24:27], 0 offen offset:128 sc1
L3_keep1_8:
    v_max_u32 v158, v116, v118
    v_cmp_eq_u32 vcc, -1, v158
    s_cbranch_vccz L3_keep1_9
    buffer_load_dwordx2 v[116:117], v232, s[24:27], 0 offen offset:1024 sc1
    buffer_load_dwordx2 v[118:119], v232, s[24:27], 0 offen offset:1152 sc1
L3_keep1_9:
    s_waitcnt vmcnt(0)
    v_cmp_eq_u32 vcc, -1, v84
    s_cmp_eq_u32 s14, 0
    s_cbranch_scc1 L3_ok1
    s_sub_u32 s14, s14, 1
    s_cbranch_vccnz L3_retry1
    s_branch L3_ok1
L3_retry2:
    s_waitcnt vmcnt(0)
    buffer_load_dwordx4 v[88:91], v230, s[24:27], 0 offen offset:2048 sc1
    v_cmp_eq_u32 vcc, -1, v92
    s_cbranch_vccz L3_keep2_3
    buffer_load_dwordx4 v[92:95], v230, s[24:27], 0 offen offset:3072 sc1
L3_keep2_3:
    v_cmp_eq_u32 vcc, -1, v96
    s_cbranch_vccz L3_keep2_4
    buffer_load_dwordx4 v[96:99], v231, s[24:27], 0 offen offset:0 sc1
L3_keep2_4:
    v_cmp_eq_u32 vcc, -1, v100
    s_cbranch_vccz L3_keep2_5
    buffer_load_dwordx4 v[100:103], v231, s[24:27], 0 offen offset:1024 sc1
L3_keep2_5:
    v_cmp_eq_u32 vcc, -1, v104
    s_cbranch_vccz L3_keep2_6
    buffer_load_dwordx4 v[104:107], v231, s[24:27], 0 offen offset:2048 sc1
L3_keep2_6:
    v_cmp_eq_u32 vcc, -1, v108
    s_cbranch_vccz L3_keep2_7
    buffer_load_dwordx4 v[108:111], v231, s[24:27], 0 offen offset:3072 sc1
L3_keep2_7:
    v_max_u32 v158, v112, v114
    v_cmp_eq_u32 vcc, -1, v158
    s_cbranch_vccz L3_keep2_8
    buffer_load_dwordx2 v[112:113], v232, s[24:27], 0 offen offset:0 sc1
    buffer_load_dwordx2 v[114:115], v232, s[24:27], 0 offen offset:128 sc1
L3_keep2_8:
    v_max_u32 v158, v116, v118
    v_cmp_eq_u32 vcc, -1, v158
    s_cbranch_vccz L3_keep2_9
    buffer_load_dwordx2 v[116:117], v232, s[24:27], 0 offen offset:1024 sc1
    buffer_load_dwordx2 v[118:119], v232, s[24:27], 0 offen offset:1152 sc1
L3_keep2_9:
    s_waitcnt vmcnt(0)
    v_cmp_eq_u32 vcc, -1, v88
    s_cmp_eq_u32 s14, 0
    s_cbranch_scc1 L3_ok2
    s_sub_u32 s14, s14, 1
    s_cbranch_vccnz L3_retry2
    s_branch L3_ok2
L3_retry3:
    s_waitcnt vmcnt(0)
    buffer_load_dwordx4 v[92:95], v230, s[24:27], 0 offen offset:3072 sc1
    v_cmp_eq_u32 vcc, -1, v96
    s_cbranch_vccz L3_keep3_4
    buffer_load_dwordx4 v[96:99], v231, s[24:27], 0 offen offset:0 sc1
L3_keep3_4:
    v_cmp_eq_u32 vcc, -1, v100
    s_cbranch_vccz L3_keep3_5
    buffer_load_dwordx4 v[100:103], v231, s[24:27], 0 offen offset:1024 sc1
L3_keep3_5:
    v_cmp_eq_u32 vcc, -1, v104
    s_cbranch_vccz L3_keep3_6
    buffer_load_dwordx4 v[104:107], v231, s[24:27], 0 offen offset:2048 sc1
L3_keep3_6:
    v_cmp_eq_u32 vcc, -1, v108
    s_cbranch_vccz L3_keep3_7
    buffer_load_dwordx4 v[108:111], v231, s[24:27], 0 offen offset:3072 sc1
L3_keep3_7:
    v_max_u32 v158, v112, v114
    v_cmp_eq_u32 vcc, -1, v158
    s_cbranch_vccz L3_keep3_8
    buffer_load_dwordx2 v[112:113], v232, s[24:27], 0 offen offset:0 sc1
    buffer_load_dwordx2 v[114:115], v232, s[24:27], 0 offen offset:128 sc1
L3_keep3_8:
    v_max_u32 v158, v116, v118
    v_cmp_eq_u32 vcc, -1, v158
    s_cbranch_vccz L3_keep3_9
    buffer_load_dwordx2 v[116:117], v232, s[24:27], 0 offen offset:1024 sc1
    buffer_load_dwordx2 v[118:119], v232, s[24:27], 0 offen offset:1152 sc1
L3_keep3_9:
    s_waitcnt vmcnt(0)
    v_cmp_eq_u32 vcc, -1, v92
    s_cmp_eq_u32 s14, 0
    s_cbranch_scc1 L3_ok3
    s_sub_u32 s14, s14, 1
    s_cbranch_vccnz L3_retry3
    s_branch L3_ok3
L3_retry4:
    s_waitcnt vmcnt(0)
    buffer_load_dwordx4 v[96:99], v231, s[24:27], 0 offen offset:0 sc1
    v_cmp_eq_u32 vcc, -1, v100
    s_cbranch_vccz L3_keep4_5
    buffer_load_dwordx4 v[100:103], v231, s[24:27], 0 offen offset:1024 sc1
L3_keep4_5:
    v_cmp_eq_u32 vcc, -1, v104
    s_cbranch_vccz L3_keep4_6
    buffer_load_dwordx4 v[104:107], v231, s[24:27], 0 offen offset:2048 sc1
L3_keep4_6:
    v_cmp_eq_u32 vcc, -1, v108
    s_cbranch_vccz L3_keep4_7
    buffer_load_dwordx4 v[108:111], v231, s[24:27], 0 offen offset:3072 sc1
L3_keep4_7:
    v_max_u32 v158, v112, v114
    v_cmp_eq_u32 vcc, -1, v158
    s_cbranch_vccz L3_keep4_8
    buffer_load_dwordx2 v[112:113], v232, s[24:27], 0 offen offset:0 sc1
    buffer_load_dwordx2 v[114:115], v232, s[24:27], 0 offen offset:128 sc1
L3_keep4_8:
    v_max_u32 v158, v116, v118
    v_cmp_eq_u32 vcc, -1, v158
    s_cbranch_vccz L3_keep4_9
    buffer_load_dwordx2 v[116:117], v232, s[24:27], 0 offen offset:1024 sc1
    buffer_load_dwordx2 v[118:119], v232, s[24:27], 0 offen offset:1152 sc1
L3_keep4_9:
    s_waitcnt vmcnt(0)
    v_cmp_eq_u32 vcc, -1, v96
    s_cmp_eq_u32 s14, 0
    s_cbranch_scc1 L3_ok4
    s_sub_u32 s14, s14, 1
    s_cbranch_vccnz L3_retry4
    s_branch L3_ok4
L3_retry5:
    s_waitcnt vmcnt(0)
    buffer_load_dwordx4 v[100:103], v231, s[24:27], 0 offen offset:1024 sc1
    v_cmp_eq_u32 vcc, -1, v104
    s_cbranch_vccz L3_keep5_6
    buffer_load_dwordx4 v[104:107], v231, s[24:27], 0 offen offset:2048 sc1
L3_keep5_6:
    v_cmp_eq_u32 vcc, -1, v108
    s_cbranch_vccz L3_keep5_7
    buffer_load_dwordx4 v[108:111], v231, s[24:27], 0 offen offset:3072 sc1
L3_keep5_7:
    v_max_u32 v158, v112, v114
    v_cmp_eq_u32 vcc, -1, v158
    s_cbranch_vccz L3_keep5_8
    buffer_load_dwordx2 v[112:113], v232, s[24:27], 0 offen offset:0 sc1
    buffer_load_dwordx2 v[114:115], v232, s[24:27], 0 offen offset:128 sc1
L3_keep5_8:
    v_max_u32 v158, v116, v118
    v_cmp_eq_u32 vcc, -1, v158
    s_cbranch_vccz L3_keep5_9
    buffer_load_dwordx2 v[116:117], v232, s[24:27], 0 offen offset:1024 sc1
    buffer_load_dwordx2 v[118:119], v232, s[24:27], 0 offen offset:1152 sc1
L3_keep5_9:
    s_waitcnt vmcnt(0)
    v_cmp_eq_u32 vcc, -1, v100
    s_cmp_eq_u32 s14, 0
    s_cbranch_scc1 L3_ok5
    s_sub_u32 s14, s14, 1
    s_cbranch_vccnz L3_retry5
    s_branch L3_ok5
L3_retry6:
    s_waitcnt vmcnt(0)
    buffer_load_dwordx4 v[104:107], v231, s[24:27], 0 offen offset:2048 sc1
    v_cmp_eq_u32 vcc, -1, v108
    s_cbranch_vccz L3_keep6_7
    buffer_load_dwordx4 v[108:111], v231, s[24:27], 0 offen offset:3072 sc1
L3_keep6_7:
    v_max_u32 v158, v112, v114
    v_cmp_eq_u32 vcc, -1, v158
    s_cbranch_vccz L3_keep6_8
    buffer_load_dwordx2 v[112:113], v232, s[24:27], 0 offen offset:0 sc1
    buffer_load_dwordx2 v[114:115], v232, s[24:27], 0 offen offset:128 sc1
L3_keep6_8:
    v_max_u32 v158, v116, v118
    v_cmp_eq_u32 vcc, -1, v158
    s_cbranch_vccz L3_keep6_9
    buffer_load_dwordx2 v[116:117], v232, s[24:27], 0 offen offset:1024 sc1
    buffer_load_dwordx2 v[118:119], v232, s[24:27], 0 offen offset:1152 sc1
L3_keep6_9:
    s_waitcnt vmcnt(0)
    v_cmp_eq_u32 vcc, -1, v104
    s_cmp_eq_u32 s14, 0
    s_cbranch_scc1 L3_ok6
    s_sub_u32 s14, s14, 1
    s_cbranch_vccnz L3_retry6
    s_branch L3_ok6
L3_retry7:
    s_waitcnt vmcnt(0)
    buffer_load_dwordx4 v[108:111], v231, s[24:27], 0 offen offset:3072 sc1
    v_max_u32 v158, v112, v114
    v_cmp_eq_u32 vcc, -1, v158
    s_cbranch_vccz L3_keep7_8
    buffer_load_dwordx2 v[112:113], v232, s[24:27], 0 offen offset:0 sc1
    buffer_load_dwordx2 v[114:115], v232, s[24:27], 0 offen offset:128 sc1
L3_keep7_8:
    v_max_u32 v158, v116, v118
    v_cmp_eq_u32 vcc, -1, v158
    s_cbranch_vccz L3_keep7_9
    buffer_load_dwordx2 v[116:117], v232, s[24:27], 0 offen offset:1024 sc1
    buffer_load_dwordx2 v[118:119], v232, s[24:27], 0 offen offset:1152 sc1
L3_keep7_9:
    s_waitcnt vmcnt(0)
    v_cmp_eq_u32 vcc, -1, v108
    s_cmp_eq_u32 s14, 0
    s_cbranch_scc1 L3_ok7
    s_sub_u32 s14, s14, 1
    s_cbranch_vccnz L3_retry7
    s_branch L3_ok7
L3_retry8:
    s_waitcnt vmcnt(0)
    buffer_load_dwordx2 v[112:113], v232, s[24:27], 0 offen offset:0 sc1
    buffer_load_dwordx2 v[114:115], v232, s[24:27], 0 offen offset:128 sc1
    v_max_u32 v158, v116, v118
    v_cmp_eq_u32 vcc, -1, v158
    s_cbranch_vccz L3_keep8_9
    buffer_load_dwordx2 v[116:117], v232, s[24:27], 0 offen offset:1024 sc1
    buffer_load_dwordx2 v[118:119], v232, s[24:27], 0 offen offset:1152 sc1
L3_keep8_9:
    s_waitcnt vmcnt(0)
    v_max_u32 v158, v112, v114
    v_cmp_eq_u32 vcc, -1, v158
    s_cmp_eq_u32 s14, 0
    s_cbranch_scc1 L3_ok8
    s_sub_u32 s14, s14, 1
    s_cbranch_vccnz L3_retry8
    s_branch L3_ok8
L3_retry9:
    s_waitcnt vmcnt(0)
    buffer_load_dwordx2 v[116:117], v232, s[24:27], 0 offen offset:1024 sc1
    buffer_load_dwordx2 v[118:119], v232, s[24:27], 0 offen offset:1152 sc1
    s_waitcnt vmcnt(0)
    v_max_u32 v158, v116, v118
    v_cmp_eq_u32 vcc, -1, v158
    s_cmp_eq_u32 s14, 0
    s_cbranch_scc1 L3_ok9
    s_sub_u32 s14, s14, 1
    s_cbranch_vccnz L3_retry9
    s_branch L3_ok9
L4_retry0:
    s_add_u32 m0, s47, 0
    s_add_u32 s3, s58, 0
    buffer_load_dwordx4 v5, s[24:27], s3 offen sc1 lds
    s_add_u32 m0, s47, 1024
    s_add_u32 s3, s58, 20480
    buffer_load_dwordx4 v5, s[24:27], s3 offen sc1 lds
    s_add_u32 m0, s47, 8192
    s_add_u32 s3, s58, 1024
    buffer_load_dwordx4 v5, s[24:27], s3 offen sc1 lds
    s_add_u32 m0, s47, 9216
    s_add_u32 s3, s58, 21504
    buffer_load_dwordx4 v5, s[24:27], s3 offen sc1 lds
    s_waitcnt vmcnt(0)
    ds_read_b32 v12, v7 offset:0
    ds_read_b32 v13, v7 offset:1024
    ds_read_b32 v14, v7 offset:8192
    ds_read_b32 v15, v7 offset:9216
    s_waitcnt lgkmcnt(0)
    v_or3_b32 v12, v12, v13, v14
    v_or_b32 v12, v12, v15
    v_and_b32 v12, v244, v12
    v_cmp_ne_u32 vcc, 0, v12
    s_cmp_eq_u32 s14, 0
    s_cbranch_scc1 L4_ok0
    s_sub_u32 s14, s14, 1
    s_cbranch_vccnz L4_retry0
    s_branch L4_ok0
L4_retry1:
    s_add_u32 m0, s47, 40960
    s_add_u32 s3, s59, 0
    buffer_load_dwordx4 v5, s[24:27], s3 offen sc1 lds
    s_add_u32 m0, s47, 41984
    s_add_u32 s3, s59, 20480
    buffer_load_dwordx4 v5, s[24:27], s3 offen sc1 lds
    s_add_u32 m0, s47, 49152
    s_add_u32 s3, s59, 1024
    buffer_load_dwordx4 v5, s[24:27], s3 offen sc1 lds
    s_add_u32 m0, s47, 50176
    s_add_u32 s3, s59, 21504
    buffer_load_dwordx4 v5, s[24:27], s3 offen sc1 lds
    s_waitcnt vmcnt(0)
    ds_read_b32 v12, v7 offset:40960
    ds_read_b32 v13, v7 offset:41984
    ds_read_b32 v14, v7 offset:49152
    ds_read_b32 v15, v7 offset:50176
    s_waitcnt lgkmcnt(0)
    v_or3_b32 v12, v12, v13, v14
    v_or_b32 v12, v12, v15
    v_and_b32 v12, v244, v12
    v_cmp_ne_u32 vcc, 0, v12
    s_cmp_eq_u32 s14, 0
    s_cbranch_scc1 L4_ok1
    s_sub_u32 s14, s14, 1
    s_cbranch_vccnz L4_retry1
    s_branch L4_ok1
L4_retry2:
    s_add_u32 m0, s47, 81920
    s_add_u32 s3, s60, 0
    buffer_load_dwordx4 v5, s[24:27], s3 offen sc1 lds
    s_add_u32 m0, s47, 82944
    s_add_u32 s3, s60, 20480
    buffer_load_dwordx4 v5, s[24:27], s3 offen sc1 lds
    s_add_u32 m0, s47, 90112
    s_add_u32 s3, s60, 1024
    buffer_load_dwordx4 v5, s[24:27], s3 offen sc1 lds
    s_add_u32 m0, s47, 91136
    s_add_u32 s3, s60, 21504
    buffer_load_dwordx4 v5, s[24:27], s3 offen sc1 lds
    s_waitcnt vmcnt(0)
    ds_read_b32 v12, v8 offset:0
    ds_read_b32 v13, v8 offset:1024
    ds_read_b32 v14, v8 offset:8192
    ds_read_b32 v15, v8 offset:9216
    s_waitcnt lgkmcnt(0)
    v_or3_b32 v12, v12, v13, v14
    v_or_b32 v12, v12, v15
    v_and_b32 v12, v244, v12
    v_cmp_ne_u32 vcc, 0, v12
    s_cmp_eq_u32 s14, 0
    s_cbranch_scc1 L4_ok2
    s_sub_u32 s14, s14, 1
    s_cbranch_vccnz L4_retry2
    s_branch L4_ok2
L4_retry3:
    s_add_u32 m0, s47, 122880
    s_add_u32 s3, s61, 0
    buffer_load_dwordx4 v5, s[24:27], s3 offen sc1 lds
    s_add_u32 m0, s47, 123904
    s_add_u32 s3, s61, 20480
    buffer_load_dwordx4 v5, s[24:27], s3 offen sc1 lds
    s_add_u32 m0, s47, 131072
    s_add_u32 s3, s61, 1024
    buffer_load_dwordx4 v5, s[24:27], s3 offen sc1 lds
    s_add_u32 m0, s47, 132096
    s_add_u32 s3, s61, 21504
    buffer_load_dwordx4 v5, s[24:27], s3 offen sc1 lds
    s_waitcnt vmcnt(0)
    ds_read_b32 v12, v8 offset:40960
    ds_read_b32 v13, v8 offset:41984
    ds_read_b32 v14, v8 offset:49152
    ds_read_b32 v15, v8 offset:50176
    s_waitcnt lgkmcnt(0)
    v_or3_b32 v12, v12, v13, v14
    v_or_b32 v12, v12, v15
    v_and_b32 v12, v244, v12
    v_cmp_ne_u32 vcc, 0, v12
    s_cmp_eq_u32 s14, 0
    s_cbranch_scc1 L4_ok3
    s_sub_u32 s14, s14, 1
    s_cbranch_vccnz L4_retry3
    s_branch L4_ok3
L4_retry4:
    s_add_u32 m0, s47, 0
    s_add_u32 s3, s58, 0
    buffer_load_dwordx4 v5, s[24:27], s3 offen sc1 lds
    s_add_u32 m0, s47, 1024
    s_add_u32 s3, s58, 20480
    buffer_load_dwordx4 v5, s[24:27], s3 offen sc1 lds
    s_add_u32 m0, s47, 8192
    s_add_u32 s3, s58, 1024
    buffer_load_dwordx4 v5, s[24:27], s3 offen sc1 lds
    s_add_u32 m0, s47, 9216
    s_add_u32 s3, s58, 21504
    buffer_load_dwordx4 v5, s[24:27], s3 offen sc1 lds
    s_waitcnt vmcnt(0)
    ds_read_b32 v12, v7 offset:0
    ds_read_b32 v13, v7 offset:1024
    ds_read_b32 v14, v7 offset:8192
    ds_read_b32 v15, v7 offset:9216
    s_waitcnt lgkmcnt(0)
    v_or3_b32 v12, v12, v13, v14
    v_or_b32 v12, v12, v15
    v_and_b32 v12, v244, v12
    v_cmp_ne_u32 vcc, 0, v12
    s_cmp_eq_u32 s14, 0
    s_cbranch_scc1 L4_ok4
    s_sub_u32 s14, s14, 1
    s_cbranch_vccnz L4_retry4
    s_branch L4_ok4
L4_retry5:
    s_add_u32 m0, s47, 40960
    s_add_u32 s3, s59, 0
    buffer_load_dwordx4 v5, s[24:27], s3 offen sc1 lds
    s_add_u32 m0, s47, 41984
    s_add_u32 s3, s59, 20480
    buffer_load_dwordx4 v5, s[24:27], s3 offen sc1 lds
    s_add_u32 m0, s47, 49152
    s_add_u32 s3, s59, 1024
    buffer_load_dwordx4 v5, s[24:27], s3 offen sc1 lds
    s_add_u32 m0, s47, 50176
    s_add_u32 s3, s59, 21504
    buffer_load_dwordx4 v5, s[24:27], s3 offen sc1 lds
    s_waitcnt vmcnt(0)
    ds_read_b32 v12, v7 offset:40960
    ds_read_b32 v13, v7 offset:41984
    ds_read_b32 v14, v7 offset:49152
    ds_read_b32 v15, v7 offset:50176
    s_waitcnt lgkmcnt(0)
    v_or3_b32 v12, v12, v13, v14
    v_or_b32 v12, v12, v15
    v_and_b32 v12, v244, v12
    v_cmp_ne_u32 vcc, 0, v12
    s_cmp_eq_u32 s14, 0
    s_cbranch_scc1 L4_ok5
    s_sub_u32 s14, s14, 1
    s_cbranch_vccnz L4_retry5
    s_branch L4_ok5
L4_retry6:
    s_add_u32 m0, s47, 81920
    s_add_u32 s3, s60, 0
    buffer_load_dwordx4 v5, s[24:27], s3 offen sc1 lds
    s_add_u32 m0, s47, 82944
    s_add_u32 s3, s60, 20480
    buffer_load_dwordx4 v5, s[24:27], s3 offen sc1 lds
    s_add_u32 m0, s47, 90112
    s_add_u32 s3, s60, 1024
    buffer_load_dwordx4 v5, s[24:27], s3 offen sc1 lds
    s_add_u32 m0, s47, 91136
    s_add_u32 s3, s60, 21504
    buffer_load_dwordx4 v5, s[24:27], s3 offen sc1 lds
    s_waitcnt vmcnt(0)
    ds_read_b32 v12, v8 offset:0
    ds_read_b32 v13, v8 offset:1024
    ds_read_b32 v14, v8 offset:8192
    ds_read_b32 v15, v8 offset:9216
    s_waitcnt lgkmcnt(0)
    v_or3_b32 v12, v12, v13, v14
    v_or_b32 v12, v12, v15
    v_and_b32 v12, v244, v12
    v_cmp_ne_u32 vcc, 0, v12
    s_cmp_eq_u32 s14, 0
    s_cbranch_scc1 L4_ok6
    s_sub_u32 s14, s14, 1
    s_cbranch_vccnz L4_retry6
    s_branch L4_ok6
L4_retry7:
    s_add_u32 m0, s47, 122880
    s_add_u32 s3, s61, 0
    buffer_load_dwordx4 v5, s[24:27], s3 offen sc1 lds
    s_add_u32 m0, s47, 123904
    s_add_u32 s3, s61, 20480
    buffer_load_dwordx4 v5, s[24:27], s3 offen sc1 lds
    s_add_u32 m0, s47, 131072
    s_add_u32 s3, s61, 1024
    buffer_load_dwordx4 v5, s[24:27], s3 offen sc1 lds
    s_add_u32 m0, s47, 132096
    s_add_u32 s3, s61, 21504
    buffer_load_dwordx4 v5, s[24:27], s3 offen sc1 lds
    s_waitcnt vmcnt(0)
    ds_read_b32 v12, v8 offset:40960
    ds_read_b32 v13, v8 offset:41984
    ds_read_b32 v14, v8 offset:49152
    ds_read_b32 v15, v8 offset:50176
    s_waitcnt lgkmcnt(0)
    v_or3_b32 v12, v12, v13, v14
    v_or_b32 v12, v12, v15
    v_and_b32 v12, v244, v12
    v_cmp_ne_u32 vcc, 0, v12
    s_cmp_eq_u32 s14, 0
    s_cbranch_scc1 L4_ok7
    s_sub_u32 s14, s14, 1
    s_cbranch_vccnz L4_retry7
    s_branch L4_ok7
L4_retry8:
    s_add_u32 m0, s47, 0
    s_add_u32 s3, s58, 0
    buffer_load_dwordx4 v5, s[24:27], s3 offen sc1 lds
    s_add_u32 m0, s47, 1024
    s_add_u32 s3, s58, 20480
    buffer_load_dwordx4 v5, s[24:27], s3 offen sc1 lds
    s_add_u32 m0, s47, 8192
    s_add_u32 s3, s58, 1024
    buffer_load_dwordx4 v5, s[24:27], s3 offen sc1 lds
    s_add_u32 m0, s47, 9216
    s_add_u32 s3, s58, 21504
    buffer_load_dwordx4 v5, s[24:27], s3 offen sc1 lds
    s_waitcnt vmcnt(0)
    ds_read_b32 v12, v7 offset:0
    ds_read_b32 v13, v7 offset:1024
    ds_read_b32 v14, v7 offset:8192
    ds_read_b32 v15, v7 offset:9216
    s_waitcnt lgkmcnt(0)
    v_or3_b32 v12, v12, v13, v14
    v_or_b32 v12, v12, v15
    v_and_b32 v12, v244, v12
    v_cmp_ne_u32 vcc, 0, v12
    s_cmp_eq_u32 s14, 0
    s_cbranch_scc1 L4_ok8
    s_sub_u32 s14, s14, 1
    s_cbranch_vccnz L4_retry8
    s_branch L4_ok8
L4_retry9:
    s_add_u32 m0, s47, 40960
    s_add_u32 s3, s59, 0
    buffer_load_dwordx4 v5, s[24:27], s3 offen sc1 lds
    s_add_u32 m0, s47, 41984
    s_add_u32 s3, s59, 20480
    buffer_load_dwordx4 v5, s[24:27], s3 offen sc1 lds
    s_add_u32 m0, s47, 49152
    s_add_u32 s3, s59, 1024
    buffer_load_dwordx4 v5, s[24:27], s3 offen sc1 lds
    s_add_u32 m0, s47, 50176
    s_add_u32 s3, s59, 21504
    buffer_load_dwordx4 v5, s[24:27], s3 offen sc1 lds
    s_waitcnt vmcnt(0)
    ds_read_b32 v12, v7 offset:40960
    ds_read_b32 v13, v7 offset:41984
    ds_read_b32 v14, v7 offset:49152
    ds_read_b32 v15, v7 offset:50176
    s_waitcnt lgkmcnt(0)
    v_or3_b32 v12, v12, v13, v14
    v_or_b32 v12, v12, v15
    v_and_b32 v12, v244, v12
    v_cmp_ne_u32 vcc, 0, v12
    s_cmp_eq_u32 s14, 0
    s_cbranch_scc1 L4_ok9
    s_sub_u32 s14, s14, 1
    s_cbranch_vccnz L4_retry9
    s_branch L4_ok9
L4_cawait:
    s_mov_b32 s55, s14
    s_and_b32 s15, s2, 7
    s_lshl_b32 s15, s15, 3
    s_add_u32 s15, s15, 336
    s_lshl_b32 s3, s15, 8
    s_add_u32 s3, s3, 18776064
    v_lshl_add_u32 v200, v0, 8, s3
    s_mov_b32 s14, 400000
    s_mov_b64 exec, 255
Lpoll4:
    buffer_load_dword v201, v200, s[24:27], 0 offen sc1
    s_waitcnt vmcnt(0)
    v_cmp_le_u32 vcc, 1, v201
    s_sub_u32 s14, s14, 1
    s_cmp_eq_u32 s14, 0
    s_cbranch_scc1 Lpolld4
    s_cmp_eq_u64 vcc, exec
    s_cbranch_scc0 Lpoll4
Lpolld4:
    s_mov_b64 exec, -1
    s_mov_b32 s14, s55
    s_branch L4_caback
L4_retryst:
    buffer_load_dwordx4 v[16:19], v2, s[24:27], s51 offen offset:0 sc1
    buffer_load_dwordx4 v[20:23], v2, s[24:27], s51 offen offset:1024 sc1
    s_waitcnt vmcnt(0)
    v_or3_b32 v10, v16, v18, v20
    v_or_b32 v10, v10, v22
    v_and_b32 v10, 1, v10
    v_cmp_ne_u32 vcc, 0, v10
    s_cmp_eq_u32 s14, 0
    s_cbranch_scc1 L4_okst
    s_sub_u32 s14, s14, 1
    s_cbranch_vccnz L4_retryst
    s_branch L4_okst
L4_retrycs:
    buffer_load_dwordx4 v[216:219], v9, s[24:27], s50 offen offset:0 sc1
    buffer_load_dwordx4 v[220:223], v9, s[24:27], s50 offen offset:128 sc1
    buffer_load_dwordx4 v[224:227], v9, s[24:27], s50 offen offset:256 sc1
    buffer_load_dwordx4 v[228:231], v9, s[24:27], s51 offen offset:0 sc1
    buffer_load_dwordx4 v[232:235], v9, s[24:27], s51 offen offset:128 sc1
    buffer_load_dwordx4 v[236:239], v9, s[24:27], s51 offen offset:256 sc1
    s_waitcnt vmcnt(0)
    v_max3_u32 v15, v216, v220, v224
    v_max3_u32 v8, v228, v232, v236
    v_max_u32 v15, v15, v8
    v_cmp_eq_u32 vcc, -1, v15
    s_cmp_eq_u32 s14, 0
    s_cbranch_scc1 L4_okcs
    s_sub_u32 s14, s14, 1
    s_cbranch_vccnz L4_retrycs
    s_branch L4_okcs
L5_retry0:
    s_waitcnt vmcnt(0)
    buffer_load_dwordx4 v[32:35], v2, s[24:27], s58 offen offset:0 sc1
    buffer_load_dwordx4 v[36:39], v2, s[24:27], s96 offen offset:0 sc1
    buffer_load_dwordx4 v[40:43], v2, s[24:27], s58 offen offset:3072 sc1
    buffer_load_dwordx4 v[44:47], v2, s[24:27], s96 offen offset:3072 sc1
    buffer_load_dwordx4 v[48:51], v2, s[24:27], s59 offen offset:2048 sc1
    buffer_load_dwordx4 v[52:55], v2, s[24:27], s97 offen offset:2048 sc1
    buffer_load_dwordx4 v[56:59], v2, s[24:27], s60 offen offset:1024 sc1
    buffer_load_dwordx4 v[60:63], v2, s[24:27], s98 offen offset:1024 sc1
    s_waitcnt vmcnt(6)
    v_or_b32 v30, v32, v36
    v_and_b32 v30, v244, v30
    v_cmp_ne_u32 vcc, 0, v30
    s_cmp_eq_u32 s14, 0
    s_cbranch_scc1 L5_ok0
    s_sub_u32 s14, s14, 1
    s_cbranch_vccnz L5_retry0
    s_branch L5_ok0
L5_retry1:
    s_waitcnt vmcnt(0)
    buffer_load_dwordx4 v[40:43], v2, s[24:27], s58 offen offset:3072 sc1
    buffer_load_dwordx4 v[44:47], v2, s[24:27], s96 offen offset:3072 sc1
    buffer_load_dwordx4 v[48:51], v2, s[24:27], s59 offen offset:2048 sc1
    buffer_load_dwordx4 v[52:55], v2, s[24:27], s97 offen offset:2048 sc1
    buffer_load_dwordx4 v[56:59], v2, s[24:27], s60 offen offset:1024 sc1
    buffer_load_dwordx4 v[60:63], v2, s[24:27], s98 offen offset:1024 sc1
    buffer_load_dwordx4 v[64:67], v2, s[24:27], s61 offen offset:0 sc1
    buffer_load_dwordx4 v[68:71], v2, s[24:27], s99 offen offset:0 sc1
    s_waitcnt vmcnt(6)
    v_or_b32 v30, v40, v44
    v_and_b32 v30, v244, v30
    v_cmp_ne_u32 vcc, 0, v30
    s_cmp_eq_u32 s14, 0
    s_cbranch_scc1 L5_ok1
    s_sub_u32 s14, s14, 1
    s_cbranch_vccnz L5_retry1
    s_branch L5_ok1
L5_retry2:
    s_waitcnt vmcnt(0)
    buffer_load_dwordx4 v[48:51], v2, s[24:27], s59 offen offset:2048 sc1
    buffer_load_dwordx4 v[52:55], v2, s[24:27], s97 offen offset:2048 sc1
    buffer_load_dwordx4 v[56:59], v2, s[24:27], s60 offen offset:1024 sc1
    buffer_load_dwordx4 v[60:63], v2, s[24:27], s98 offen offset:1024 sc1
    buffer_load_dwordx4 v[64:67], v2, s[24:27], s61 offen offset:0 sc1
    buffer_load_dwordx4 v[68:71], v2, s[24:27], s99 offen offset:0 sc1
    buffer_load_dwordx4 v[32:35], v2, s[24:27], s61 offen offset:3072 sc1
    buffer_load_dwordx4 v[36:39], v2, s[24:27], s99 offen offset:3072 sc1
    s_waitcnt vmcnt(6)
    v_or_b32 v30, v48, v52
    v_and_b32 v30, v244, v30
    v_cmp_ne_u32 vcc, 0, v30
    s_cmp_eq_u32 s14, 0
    s_cbranch_scc1 L5_ok2
    s_sub_u32 s14, s14, 1
    s_cbranch_vccnz L5_retry2
    s_branch L5_ok2
L5_retry3:
    s_waitcnt vmcnt(0)
    buffer_load_dwordx4 v[56:59], v2, s[24:27], s60 offen offset:1024 sc1
    buffer_load_dwordx4 v[60:63], v2, s[24:27], s98 offen offset:1024 sc1
    buffer_load_dwordx4 v[64:67], v2, s[24:27], s61 offen offset:0 sc1
    buffer_load_dwordx4 v[68:71], v2, s[24:27], s99 offen offset:0 sc1
    buffer_load_dwordx4 v[32:35], v2, s[24:27], s61 offen offset:3072 sc1
    buffer_load_dwordx4 v[36:39], v2, s[24:27], s99 offen offset:3072 sc1
    buffer_load_dwordx4 v[40:43], v2, s[24:27], s62 offen offset:2048 sc1
    buffer_load_dwordx4 v[44:47], v2, s[24:27], s100 offen offset:2048 sc1
    s_waitcnt vmcnt(6)
    v_or_b32 v30, v56, v60
    v_and_b32 v30, v244, v30
    v_cmp_ne_u32 vcc, 0, v30
    s_cmp_eq_u32 s14, 0
    s_cbranch_scc1 L5_ok3
    s_sub_u32 s14, s14, 1
    s_cbranch_vccnz L5_retry3
    s_branch L5_ok3
L5_retry4:
    s_waitcnt vmcnt(0)
    buffer_load_dwordx4 v[64:67], v2, s[24:27], s61 offen offset:0 sc1
    buffer_load_dwordx4 v[68:71], v2, s[24:27], s99 offen offset:0 sc1
    buffer_load_dwordx4 v[32:35], v2, s[24:27], s61 offen offset:3072 sc1
    buffer_load_dwordx4 v[36:39], v2, s[24:27], s99 offen offset:3072 sc1
    buffer_load_dwordx4 v[40:43], v2, s[24:27], s62 offen offset:2048 sc1
    buffer_load_dwordx4 v[44:47], v2, s[24:27], s100 offen offset:2048 sc1
    buffer_load_dwordx4 v[48:51], v2, s[24:27], s63 offen offset:1024 sc1
    buffer_load_dwordx4 v[52:55], v2, s[24:27], s101 offen offset:1024 sc1
    s_waitcnt vmcnt(6)
    v_or_b32 v30, v64, v68
    v_and_b32 v30, v244, v30
    v_cmp_ne_u32 vcc, 0, v30
    s_cmp_eq_u32 s14, 0
    s_cbranch_scc1 L5_ok4
    s_sub_u32 s14, s14, 1
    s_cbranch_vccnz L5_retry4
    s_branch L5_ok4
L5_retry5:
    s_waitcnt vmcnt(0)
    buffer_load_dwordx4 v[32:35], v2, s[24:27], s61 offen offset:3072 sc1
    buffer_load_dwordx4 v[36:39], v2, s[24:27], s99 offen offset:3072 sc1
    buffer_load_dwordx4 v[40:43], v2, s[24:27], s62 offen offset:2048 sc1
    buffer_load_dwordx4 v[44:47], v2, s[24:27], s100 offen offset:2048 sc1
    buffer_load_dwordx4 v[48:51], v2, s[24:27], s63 offen offset:1024 sc1
    buffer_load_dwordx4 v[52:55], v2, s[24:27], s101 offen offset:1024 sc1
    buffer_load_dwordx4 v[56:59], v2, s[24:27], s58 offen offset:1024 sc1
    buffer_load_dwordx4 v[60:63], v2, s[24:27], s96 offen offset:1024 sc1
    s_waitcnt vmcnt(6)
    v_or_b32 v30, v32, v36
    v_and_b32 v30, v244, v30
    v_cmp_ne_u32 vcc, 0, v30
    s_cmp_eq_u32 s14, 0
    s_cbranch_scc1 L5_ok5
    s_sub_u32 s14, s14, 1
    s_cbranch_vccnz L5_retry5
    s_branch L5_ok5
L5_retry6:
    s_waitcnt vmcnt(0)
    buffer_load_dwordx4 v[40:43], v2, s[24:27], s62 offen offset:2048 sc1
    buffer_load_dwordx4 v[44:47], v2, s[24:27], s100 offen offset:2048 sc1
    buffer_load_dwordx4 v[48:51], v2, s[24:27], s63 offen offset:1024 sc1
    buffer_load_dwordx4 v[52:55], v2, s[24:27], s101 offen offset:1024 sc1
    buffer_load_dwordx4 v[56:59], v2, s[24:27], s58 offen offset:1024 sc1
    buffer_load_dwordx4 v[60:63], v2, s[24:27], s96 offen offset:1024 sc1
    buffer_load_dwordx4 v[64:67], v2, s[24:27], s59 offen offset:0 sc1
    buffer_load_dwordx4 v[68:71], v2, s[24:27], s97 offen offset:0 sc1
    s_waitcnt vmcnt(6)
    v_or_b32 v30, v40, v44
    v_and_b32 v30, v244, v30
    v_cmp_ne_u32 vcc, 0, v30
    s_cmp_eq_u32 s14, 0
    s_cbranch_scc1 L5_ok6
    s_sub_u32 s14, s14, 1
    s_cbranch_vccnz L5_retry6
    s_branch L5_ok6
L5_retry7:
    s_waitcnt vmcnt(0)
    buffer_load_dwordx4 v[48:51], v2, s[24:27], s63 offen offset:1024 sc1
    buffer_load_dwordx4 v[52:55], v2, s[24:27], s101 offen offset:1024 sc1
    buffer_load_dwordx4 v[56:59], v2, s[24:27], s58 offen offset:1024 sc1
    buffer_load_dwordx4 v[60:63], v2, s[24:27], s96 offen offset:1024 sc1
    buffer_load_dwordx4 v[64:67], v2, s[24:27], s59 offen offset:0 sc1
    buffer_load_dwordx4 v[68:71], v2, s[24:27], s97 offen offset:0 sc1
    buffer_load_dwordx4 v[32:35], v2, s[24:27], s59 offen offset:3072 sc1
    buffer_load_dwordx4 v[36:39], v2, s[24:27], s97 offen offset:3072 sc1
    s_waitcnt vmcnt(6)
    v_or_b32 v30, v48, v52
    v_and_b32 v30, v244, v30
    v_cmp_ne_u32 vcc, 0, v30
    s_cmp_eq_u32 s14, 0
    s_cbranch_scc1 L5_ok7
    s_sub_u32 s14, s14, 1
    s_cbranch_vccnz L5_retry7
    s_branch L5_ok7
L5_retry8:
    s_waitcnt vmcnt(0)
    buffer_load_dwordx4 v[56:59], v2, s[24:27], s58 offen offset:1024 sc1
    buffer_load_dwordx4 v[60:63], v2, s[24:27], s96 offen offset:1024 sc1
    buffer_load_dwordx4 v[64:67], v2, s[24:27], s59 offen offset:0 sc1
    buffer_load_dwordx4 v[68:71], v2, s[24:27], s97 offen offset:0 sc1
    buffer_load_dwordx4 v[32:35], v2, s[24:27], s59 offen offset:3072 sc1
    buffer_load_dwordx4 v[36:39], v2, s[24:27], s97 offen offset:3072 sc1
    buffer_load_dwordx4 v[40:43], v2, s[24:27], s60 offen offset:2048 sc1
    buffer_load_dwordx4 v[44:47], v2, s[24:27], s98 offen offset:2048 sc1
    s_waitcnt vmcnt(6)
    v_or_b32 v30, v56, v60
    v_and_b32 v30, v244, v30
    v_cmp_ne_u32 vcc, 0, v30
    s_cmp_eq_u32 s14, 0
    s_cbranch_scc1 L5_ok8
    s_sub_u32 s14, s14, 1
    s_cbranch_vccnz L5_retry8
    s_branch L5_ok8
L5_retry9:
    s_waitcnt vmcnt(0)
    buffer_load_dwordx4 v[64:67], v2, s[24:27], s59 offen offset:0 sc1
    buffer_load_dwordx4 v[68:71], v2, s[24:27], s97 offen offset:0 sc1
    buffer_load_dwordx4 v[32:35], v2, s[24:27], s59 offen offset:3072 sc1
    buffer_load_dwordx4 v[36:39], v2, s[24:27], s97 offen offset:3072 sc1
    buffer_load_dwordx4 v[40:43], v2, s[24:27], s60 offen offset:2048 sc1
    buffer_load_dwordx4 v[44:47], v2, s[24:27], s98 offen offset:2048 sc1
    buffer_load_dwordx4 v[48:51], v2, s[24:27], s61 offen offset:1024 sc1
    buffer_load_dwordx4 v[52:55], v2, s[24:27], s99 offen offset:1024 sc1
    s_waitcnt vmcnt(6)
    v_or_b32 v30, v64, v68
    v_and_b32 v30, v244, v30
    v_cmp_ne_u32 vcc, 0, v30
    s_cmp_eq_u32 s14, 0
    s_cbranch_scc1 L5_ok9
    s_sub_u32 s14, s14, 1
    s_cbranch_vccnz L5_retry9
    s_branch L5_ok9
L5_retry10:
    s_waitcnt vmcnt(0)
    buffer_load_dwordx4 v[32:35], v2, s[24:27], s59 offen offset:3072 sc1
    buffer_load_dwordx4 v[36:39], v2, s[24:27], s97 offen offset:3072 sc1
    buffer_load_dwordx4 v[40:43], v2, s[24:27], s60 offen offset:2048 sc1
    buffer_load_dwordx4 v[44:47], v2, s[24:27], s98 offen offset:2048 sc1
    buffer_load_dwordx4 v[48:51], v2, s[24:27], s61 offen offset:1024 sc1
    buffer_load_dwordx4 v[52:55], v2, s[24:27], s99 offen offset:1024 sc1
    buffer_load_dwordx4 v[56:59], v2, s[24:27], s62 offen offset:0 sc1
    buffer_load_dwordx4 v[60:63], v2, s[24:27], s100 offen offset:0 sc1
    s_waitcnt vmcnt(6)
    v_or_b32 v30, v32, v36
    v_and_b32 v30, v244, v30
    v_cmp_ne_u32 vcc, 0, v30
    s_cmp_eq_u32 s14, 0
    s_cbranch_scc1 L5_ok10
    s_sub_u32 s14, s14, 1
    s_cbranch_vccnz L5_retry10
    s_branch L5_ok10
L5_retry11:
    s_waitcnt vmcnt(0)
    buffer_load_dwordx4 v[40:43], v2, s[24:27], s60 offen offset:2048 sc1
    buffer_load_dwordx4 v[44:47], v2, s[24:27], s98 offen offset:2048 sc1
    buffer_load_dwordx4 v[48:51], v2, s[24:27], s61 offen offset:1024 sc1
    buffer_load_dwordx4 v[52:55], v2, s[24:27], s99 offen offset:1024 sc1
    buffer_load_dwordx4 v[56:59], v2, s[24:27], s62 offen offset:0 sc1
    buffer_load_dwordx4 v[60:63], v2, s[24:27], s100 offen offset:0 sc1
    buffer_load_dwordx4 v[64:67], v2, s[24:27], s62 offen offset:3072 sc1
    buffer_load_dwordx4 v[68:71], v2, s[24:27], s100 offen offset:3072 sc1
    s_waitcnt vmcnt(6)
    v_or_b32 v30, v40, v44
    v_and_b32 v30, v244, v30
    v_cmp_ne_u32 vcc, 0, v30
    s_cmp_eq_u32 s14, 0
    s_cbranch_scc1 L5_ok11
    s_sub_u32 s14, s14, 1
    s_cbranch_vccnz L5_retry11
    s_branch L5_ok11
L5_retry12:
    s_waitcnt vmcnt(0)
    buffer_load_dwordx4 v[48:51], v2, s[24:27], s61 offen offset:1024 sc1
    buffer_load_dwordx4 v[52:55], v2, s[24:27], s99 offen offset:1024 sc1
    buffer_load_dwordx4 v[56:59], v2, s[24:27], s62 offen offset:0 sc1
    buffer_load_dwordx4 v[60:63], v2, s[24:27], s100 offen offset:0 sc1
    buffer_load_dwordx4 v[64:67], v2, s[24:27], s62 offen offset:3072 sc1
    buffer_load_dwordx4 v[68:71], v2, s[24:27], s100 offen offset:3072 sc1
    buffer_load_dwordx4 v[32:35], v2, s[24:27], s63 offen offset:2048 sc1
    buffer_load_dwordx4 v[36:39], v2, s[24:27], s101 offen offset:2048 sc1
    s_waitcnt vmcnt(6)
    v_or_b32 v30, v48, v52
    v_and_b32 v30, v244, v30
    v_cmp_ne_u32 vcc, 0, v30
    s_cmp_eq_u32 s14, 0
    s_cbranch_scc1 L5_ok12
    s_sub_u32 s14, s14, 1
    s_cbranch_vccnz L5_retry12
    s_branch L5_ok12
L5_retry13:
    s_waitcnt vmcnt(0)
    buffer_load_dwordx4 v[56:59], v2, s[24:27], s62 offen offset:0 sc1
    buffer_load_dwordx4 v[60:63], v2, s[24:27], s100 offen offset:0 sc1
    buffer_load_dwordx4 v[64:67], v2, s[24:27], s62 offen offset:3072 sc1
    buffer_load_dwordx4 v[68:71], v2, s[24:27], s100 offen offset:3072 sc1
    buffer_load_dwordx4 v[32:35], v2, s[24:27], s63 offen offset:2048 sc1
    buffer_load_dwordx4 v[36:39], v2, s[24:27], s101 offen offset:2048 sc1
    buffer_load_dwordx4 v[40:43], v2, s[24:27], s58 offen offset:2048 sc1
    buffer_load_dwordx4 v[44:47], v2, s[24:27], s96 offen offset:2048 sc1
    s_waitcnt vmcnt(6)
    v_or_b32 v30, v56, v60
    v_and_b32 v30, v244, v30
    v_cmp_ne_u32 vcc, 0, v30
    s_cmp_eq_u32 s14, 0
    s_cbranch_scc1 L5_ok13
    s_sub_u32 s14, s14, 1
    s_cbranch_vccnz L5_retry13
    s_branch L5_ok13
L5_retry14:
    s_waitcnt vmcnt(0)
    buffer_load_dwordx4 v[64:67], v2, s[24:27], s62 offen offset:3072 sc1
    buffer_load_dwordx4 v[68:71], v2, s[24:27], s100 offen offset:3072 sc1
    buffer_load_dwordx4 v[32:35], v2, s[24:27], s63 offen offset:2048 sc1
    buffer_load_dwordx4 v[36:39], v2, s[24:27], s101 offen offset:2048 sc1
    buffer_load_dwordx4 v[40:43], v2, s[24:27], s58 offen offset:2048 sc1
    buffer_load_dwordx4 v[44:47], v2, s[24:27], s96 offen offset:2048 sc1
    buffer_load_dwordx4 v[48:51], v2, s[24:27], s59 offen offset:1024 sc1
    buffer_load_dwordx4 v[52:55], v2, s[24:27], s97 offen offset:1024 sc1
    s_waitcnt vmcnt(6)
    v_or_b32 v30, v64, v68
    v_and_b32 v30, v244, v30
    v_cmp_ne_u32 vcc, 0, v30
    s_cmp_eq_u32 s14, 0
    s_cbranch_scc1 L5_ok14
    s_sub_u32 s14, s14, 1
    s_cbranch_vccnz L5_retry14
    s_branch L5_ok14
L5_retry15:
    s_waitcnt vmcnt(0)
    buffer_load_dwordx4 v[32:35], v2, s[24:27], s63 offen offset:2048 sc1
    buffer_load_dwordx4 v[36:39], v2, s[24:27], s101 offen offset:2048 sc1
    buffer_load_dwordx4 v[40:43], v2, s[24:27], s58 offen offset:2048 sc1
    buffer_load_dwordx4 v[44:47], v2, s[24:27], s96 offen offset:2048 sc1
    buffer_load_dwordx4 v[48:51], v2, s[24:27], s59 offen offset:1024 sc1
    buffer_load_dwordx4 v[52:55], v2, s[24:27], s97 offen offset:1024 sc1
    buffer_load_dwordx4 v[56:59], v2, s[24:27], s60 offen offset:0 sc1
    buffer_load_dwordx4 v[60:63], v2, s[24:27], s98 offen offset:0 sc1
    s_waitcnt vmcnt(6)
    v_or_b32 v30, v32, v36
    v_and_b32 v30, v244, v30
    v_cmp_ne_u32 vcc, 0, v30
    s_cmp_eq_u32 s14, 0
    s_cbranch_scc1 L5_ok15
    s_sub_u32 s14, s14, 1
    s_cbranch_vccnz L5_retry15
    s_branch L5_ok15
L5_retry16:
    s_waitcnt vmcnt(0)
    buffer_load_dwordx4 v[40:43], v2, s[24:27], s58 offen offset:2048 sc1
    buffer_load_dwordx4 v[44:47], v2, s[24:27], s96 offen offset:2048 sc1
    buffer_load_dwordx4 v[48:51], v2, s[24:27], s59 offen offset:1024 sc1
    buffer_load_dwordx4 v[52:55], v2, s[24:27], s97 offen offset:1024 sc1
    buffer_load_dwordx4 v[56:59], v2, s[24:27], s60 offen offset:0 sc1
    buffer_load_dwordx4 v[60:63], v2, s[24:27], s98 offen offset:0 sc1
    buffer_load_dwordx4 v[64:67], v2, s[24:27], s60 offen offset:3072 sc1
    buffer_load_dwordx4 v[68:71], v2, s[24:27], s98 offen offset:3072 sc1
    s_waitcnt vmcnt(6)
    v_or_b32 v30, v40, v44
    v_and_b32 v30, v244, v30
    v_cmp_ne_u32 vcc, 0, v30
    s_cmp_eq_u32 s14, 0
    s_cbranch_scc1 L5_ok16
    s_sub_u32 s14, s14, 1
    s_cbranch_vccnz L5_retry16
    s_branch L5_ok16
L5_retry17:
    s_waitcnt vmcnt(0)
    buffer_load_dwordx4 v[48:51], v2, s[24:27], s59 offen offset:1024 sc1
    buffer_load_dwordx4 v[52:55], v2, s[24:27], s97 offen offset:1024 sc1
    buffer_load_dwordx4 v[56:59], v2, s[24:27], s60 offen offset:0 sc1
    buffer_load_dwordx4 v[60:63], v2, s[24:27], s98 offen offset:0 sc1
    buffer_load_dwordx4 v[64:67], v2, s[24:27], s60 offen offset:3072 sc1
    buffer_load_dwordx4 v[68:71], v2, s[24:27], s98 offen offset:3072 sc1
    buffer_load_dwordx4 v[32:35], v2, s[24:27], s61 offen offset:2048 sc1
    buffer_load_dwordx4 v[36:39], v2, s[24:27], s99 offen offset:2048 sc1
    s_waitcnt vmcnt(6)
    v_or_b32 v30, v48, v52
    v_and_b32 v30, v244, v30
    v_cmp_ne_u32 vcc, 0, v30
    s_cmp_eq_u32 s14, 0
    s_cbranch_scc1 L5_ok17
    s_sub_u32 s14, s14, 1
    s_cbranch_vccnz L5_retry17
    s_branch L5_ok17
L5_retry18:
    s_waitcnt vmcnt(0)
    buffer_load_dwordx4 v[56:59], v2, s[24:27], s60 offen offset:0 sc1
    buffer_load_dwordx4 v[60:63], v2, s[24:27], s98 offen offset:0 sc1
    buffer_load_dwordx4 v[64:67], v2, s[24:27], s60 offen offset:3072 sc1
    buffer_load_dwordx4 v[68:71], v2, s[24:27], s98 offen offset:3072 sc1
    buffer_load_dwordx4 v[32:35], v2, s[24:27], s61 offen offset:2048 sc1
    buffer_load_dwordx4 v[36:39], v2, s[24:27], s99 offen offset:2048 sc1
    buffer_load_dwordx4 v[40:43], v2, s[24:27], s62 offen offset:1024 sc1
    buffer_load_dwordx4 v[44:47], v2, s[24:27], s100 offen offset:1024 sc1
    s_waitcnt vmcnt(6)
    v_or_b32 v30, v56, v60
    v_and_b32 v30, v244, v30
    v_cmp_ne_u32 vcc, 0, v30
    s_cmp_eq_u32 s14, 0
    s_cbranch_scc1 L5_ok18
    s_sub_u32 s14, s14, 1
    s_cbranch_vccnz L5_retry18
    s_branch L5_ok18
L5_retry19:
    s_waitcnt vmcnt(0)
    buffer_load_dwordx4 v[64:67], v2, s[24:27], s60 offen offset:3072 sc1
    buffer_load_dwordx4 v[68:71], v2, s[24:27], s98 offen offset:3072 sc1
    buffer_load_dwordx4 v[32:35], v2, s[24:27], s61 offen offset:2048 sc1
    buffer_load_dwordx4 v[36:39], v2, s[24:27], s99 offen offset:2048 sc1
    buffer_load_dwordx4 v[40:43], v2, s[24:27], s62 offen offset:1024 sc1
    buffer_load_dwordx4 v[44:47], v2, s[24:27], s100 offen offset:1024 sc1
    buffer_load_dwordx4 v[48:51], v2, s[24:27], s63 offen offset:0 sc1
    buffer_load_dwordx4 v[52:55], v2, s[24:27], s101 offen offset:0 sc1
    s_waitcnt vmcnt(6)
    v_or_b32 v30, v64, v68
    v_and_b32 v30, v244, v30
    v_cmp_ne_u32 vcc, 0, v30
    s_cmp_eq_u32 s14, 0
    s_cbranch_scc1 L5_ok19
    s_sub_u32 s14, s14, 1
    s_cbranch_vccnz L5_retry19
    s_branch L5_ok19
L5_retry20:
    s_waitcnt vmcnt(0)
    buffer_load_dwordx4 v[32:35], v2, s[24:27], s61 offen offset:2048 sc1
    buffer_load_dwordx4 v[36:39], v2, s[24:27], s99 offen offset:2048 sc1
    buffer_load_dwordx4 v[40:43], v2, s[24:27], s62 offen offset:1024 sc1
    buffer_load_dwordx4 v[44:47], v2, s[24:27], s100 offen offset:1024 sc1
    buffer_load_dwordx4 v[48:51], v2, s[24:27], s63 offen offset:0 sc1
    buffer_load_dwordx4 v[52:55], v2, s[24:27], s101 offen offset:0 sc1
    buffer_load_dwordx4 v[56:59], v2, s[24:27], s63 offen offset:3072 sc1
    buffer_load_dwordx4 v[60:63], v2, s[24:27], s101 offen offset:3072 sc1
    s_waitcnt vmcnt(6)
    v_or_b32 v30, v32, v36
    v_and_b32 v30, v244, v30
    v_cmp_ne_u32 vcc, 0, v30
    s_cmp_eq_u32 s14, 0
    s_cbranch_scc1 L5_ok20
    s_sub_u32 s14, s14, 1
    s_cbranch_vccnz L5_retry20
    s_branch L5_ok20
L5_retry21:
    s_waitcnt vmcnt(0)
    buffer_load_dwordx4 v[40:43], v2, s[24:27], s62 offen offset:1024 sc1
    buffer_load_dwordx4 v[44:47], v2, s[24:27], s100 offen offset:1024 sc1
    buffer_load_dwordx4 v[48:51], v2, s[24:27], s63 offen offset:0 sc1
    buffer_load_dwordx4 v[52:55], v2, s[24:27], s101 offen offset:0 sc1
    buffer_load_dwordx4 v[56:59], v2, s[24:27], s63 offen offset:3072 sc1
    buffer_load_dwordx4 v[60:63], v2, s[24:27], s101 offen offset:3072 sc1
    s_waitcnt vmcnt(4)
    v_or_b32 v30, v40, v44
    v_and_b32 v30, v244, v30
    v_cmp_ne_u32 vcc, 0, v30
    s_cmp_eq_u32 s14, 0
    s_cbranch_scc1 L5_ok21
    s_sub_u32 s14, s14, 1
    s_cbranch_vccnz L5_retry21
    s_branch L5_ok21
L5_retry22:
    s_waitcnt vmcnt(0)
    buffer_load_dwordx4 v[48:51], v2, s[24:27], s63 offen offset:0 sc1
    buffer_load_dwordx4 v[52:55], v2, s[24:27], s101 offen offset:0 sc1
    buffer_load_dwordx4 v[56:59], v2, s[24:27], s63 offen offset:3072 sc1
    buffer_load_dwordx4 v[60:63], v2, s[24:27], s101 offen offset:3072 sc1
    s_waitcnt vmcnt(2)
    v_or_b32 v30, v48, v52
    v_and_b32 v30, v244, v30
    v_cmp_ne_u32 vcc, 0, v30
    s_cmp_eq_u32 s14, 0
    s_cbranch_scc1 L5_ok22
    s_sub_u32 s14, s14, 1
    s_cbranch_vccnz L5_retry22
    s_branch L5_ok22
L5_retry23:
    s_waitcnt vmcnt(0)
    buffer_load_dwordx4 v[56:59], v2, s[24:27], s63 offen offset:3072 sc1
    buffer_load_dwordx4 v[60:63], v2, s[24:27], s101 offen offset:3072 sc1
    s_waitcnt vmcnt(0)
    v_or_b32 v30, v56, v60
    v_and_b32 v30, v244, v30
    v_cmp_ne_u32 vcc, 0, v30
    s_cmp_eq_u32 s14, 0
    s_cbranch_scc1 L5_ok23
    s_sub_u32 s14, s14, 1
    s_cbranch_vccnz L5_retry23
    s_branch L5_ok23
L_codeend:
.section .rodata,"a"
.p2align 6
.amdhsa_kernel sequential_preLN__softmax_full_mha__glu_gated_reglu__prompt_kernel
  .amdhsa_next_free_vgpr 256
  .amdhsa_next_free_sgpr 102
  .amdhsa_accum_offset 256
  .amdhsa_group_segment_fixed_size 0
  .amdhsa_kernarg_size 80
  .amdhsa_user_sgpr_count 2
  .amdhsa_user_sgpr_kernarg_segment_ptr 1
  .amdhsa_system_sgpr_workgroup_id_x 1
.end_amdhsa_kernel
```
